```python
import torch

def _softmax(x, axis=-1):
    return torch.softmax(x, dim=axis)
def _gelu(x):
    return torch.nn.functional.gelu(x, approximate="tanh")
def _silu(x):
    return torch.nn.functional.silu(x)
def _sigmoid(x):
    return torch.sigmoid(x)
def _layernorm(x, axis=-1, eps=1e-5):
    m = x.mean(dim=axis, keepdim=True)
    v = x.var(dim=axis, keepdim=True, unbiased=False)
    return (x - m) / torch.sqrt(v + eps)
def _scatter_add(tgt, idx, src, axis=0):
    return tgt.clone().index_add_(axis, idx, src)
def _segment_sum(src, seg, n):
    out = torch.zeros((n,) + src.shape[1:], dtype=src.dtype)
    return out.index_add_(0, seg, src)
def _pad(x, pw):
    flat = tuple(v for pair in reversed(pw) for v in pair)
    return torch.nn.functional.pad(x, flat)

kernel_name = 'gated_mix__mha_block__swiglu_ffn__prompt'

def setup_inputs():

    _w = (lambda a: (lambda t: t.to(torch.bfloat16) if t.is_floating_point() else t)(torch.as_tensor(a)))
    def _A_setup():
        B, S, D, H = 1, 2048, 512, 32
        return {
            "x": _w((lambda *s: torch.randn(*s, dtype=torch.bfloat16) * 0.05)(B, S, D)),
            "wqkv": _w((lambda *s: torch.randn(*s, dtype=torch.bfloat16) * 0.8)(D, 3 * D)),
            "wo": _w((lambda *s: torch.randn(*s, dtype=torch.bfloat16) * 0.05)(D, D)),
        }
    _A_in = _A_setup()

    def _B_setup():
        B, S, D, F = 1, 2048, 512, 1376
        return {
            "x": _w((lambda *s: torch.randn(*s, dtype=torch.bfloat16) * 0.05)(B, S, D)),
            "w_gate": _w((lambda *s: torch.randn(*s, dtype=torch.bfloat16) * 0.1)(D, F)),
            "w_up": _w((lambda *s: torch.randn(*s, dtype=torch.bfloat16) * 0.1)(D, F)),
            "w_down": _w((lambda *s: torch.randn(*s, dtype=torch.bfloat16) * 0.1)(F, D)),
        }
    _B_in = _B_setup()

    return {
        "A_x": _A_in["x"],
        "A_wqkv": _A_in["wqkv"],
        "A_wo": _A_in["wo"],
        "B_x": _B_in["x"],
        "B_w_gate": _B_in["w_gate"],
        "B_w_up": _B_in["w_up"],
        "B_w_down": _B_in["w_down"],
        "gate_w": _w((lambda *s: torch.randn(*s, dtype=torch.bfloat16) * 0.05)(512) * 16.0),
    }

def reference(A_x, A_wqkv, A_wo, B_x, B_w_gate, B_w_up, B_w_down, gate_w):
    def _A_ref(x, wqkv, wo):
        B, S, D = x.shape
        H = 32
        Dh = D // H
        qkv = (lambda x, *d: x.permute(*d))((x @ wqkv).reshape(B, S, 3, H, Dh), 2, 0, 3, 1, 4)
        q, k, v = qkv[0], qkv[1], qkv[2]
        scores = torch.einsum("bhqd,bhkd->bhqk", q, k) * (Dh ** -0.5)
        p = _softmax(scores, axis=-1)
        o = torch.einsum("bhqk,bhkd->bhqd", p, v)
        return (lambda x, *d: x.permute(*d))(o, 0, 2, 1, 3).reshape(B, S, D) @ wo

    def _B_ref(x, w_gate, w_up, w_down):
        g = _silu(x @ w_gate)
        u = x @ w_up
        return (g * u) @ w_down

    x = A_x
    g = _sigmoid((x * gate_w).sum(-1, keepdims=True))
    a = _A_ref(x, A_wqkv, A_wo)
    b = _B_ref(x, B_w_gate, B_w_up, B_w_down)
    return g * a + (1 - g) * b
```

```asm
; @launch grid=(256,1,1) block=(512,1,1) lds=163840
.amdgcn_target "amdgcn-amd-amdhsa--gfx950"
.text
.globl gated_mix__mha_block__swiglu_ffn__prompt_kernel
.p2align 8
.type gated_mix__mha_block__swiglu_ffn__prompt_kernel,@function
gated_mix__mha_block__swiglu_ffn__prompt_kernel:

  s_cmp_ge_u32 s2, 256
  s_cbranch_scc1 gated_mix__mha_block__swiglu_ffn__prompt_kernel_end
  s_load_dwordx4 s[4:7], s[0:1], 0
  s_load_dwordx4 s[52:55], s[0:1], 32
  s_load_dwordx2 s[8:9], s[0:1], 80
  s_load_dwordx2 s[10:11], s[0:1], 56
  s_load_dwordx2 s[56:57], s[0:1], 48
  s_load_dwordx2 s[58:59], s[0:1], 16
  v_lshrrev_b32 v1, 6, v0
  v_and_b32 v0, 63, v0
  s_and_b32 s25, s2, 7
  s_lshr_b32 s27, s2, 3
  v_readfirstlane_b32 s24, v1

  s_and_b32 s26, s25, 1
  s_lshl_b32 s26, s26, 3
  s_and_b32 s27, s27, 7
  s_add_u32 s26, s26, s27
  s_lshr_b32 s28, s2, 6
  s_and_b32 s27, s28, 1
  s_lshr_b32 s30, s25, 1
  s_lshl_b32 s30, s30, 1
  s_add_u32 s27, s27, s30
  s_lshr_b32 s62, s28, 1
  s_lshl_b32 s30, s62, 3
  s_add_u32 s27, s27, s30

  s_lshl_b32 s29, s26, 4
  s_add_u32 s29, s29, s27
  s_and_b32 s30, s27, 7
  s_mul_i32 s31, s30, 9
  s_add_u32 s31, s31, 16
  s_cmp_eq_u32 s30, 7
  s_cselect_b32 s28, 1, 0
  s_sub_u32 s31, s31, s28
  s_cmp_ge_u32 s30, 6
  s_cselect_b32 s61, 8, 9
  s_lshl_b32 s30, s30, 1
  s_cmp_eq_u32 s62, 0
  s_cselect_b32 s63, s30, s31
  s_cselect_b32 s61, 2, s61
  s_waitcnt lgkmcnt(0)
  s_load_dword s3, s[8:9], 0

  s_cmp_lt_u32 s24, 4
  s_cbranch_scc1 gated_mix__mha_block__swiglu_ffn__prompt_kernel_compute
  s_mov_b32 s20, s8
  s_mov_b32 s21, s9
  s_mov_b32 s22, 0x1500000
  s_mov_b32 s23, 0x20000

  s_sub_u32 s24, s24, 4
  v_lshrrev_b32 v3, 3, v0
  v_lshrrev_b32 v4, 4, v0
  s_and_b32 s32, s24, 1
  s_lshl_b32 s32, s32, 2
  v_add_u32 v4, s32, v4
  v_and_b32 v5, 7, v0
  v_xor_b32 v5, v5, v4
  v_lshlrev_b32 v5, 4, v5
  v_lshl_add_u32 v8, v3, 10, v5
  s_lshl_b32 s35, s24, 13
  s_lshl_b32 s34, s26, 17
  s_add_u32 s34, s34, s35
  s_lshl_b32 s36, s24, 10
  s_and_b32 s28, s26, 1
  s_add_u32 s28, s28, s25
  v_lshlrev_b32 v4, 4, v0
  s_mov_b32 s12, s4
  s_mov_b32 s13, s5
  s_mov_b32 s14, 0x200000
  s_mov_b32 s15, 0x20000
  s_cmp_lg_u32 s62, 0
  s_cbranch_scc1 gated_mix__mha_block__swiglu_ffn__prompt_kernel_ldB
  s_and_b32 s49, s28, 7
  s_lshl_b32 s49, s49, 7
  s_add_u32 s49, s49, s34
  s_add_u32 m0, s36, 0
  s_add_u32 s38, s49, 0
  buffer_load_dwordx4 v8, s[12:15], s38 offen lds
  s_add_u32 m0, s36, 4096
  s_add_u32 s38, s49, 32768
  buffer_load_dwordx4 v8, s[12:15], s38 offen lds
  s_add_u32 m0, s36, 8192
  s_add_u32 s38, s49, 65536
  buffer_load_dwordx4 v8, s[12:15], s38 offen lds
  s_add_u32 m0, s36, 12288
  s_add_u32 s38, s49, 98304
  buffer_load_dwordx4 v8, s[12:15], s38 offen lds
  s_mov_b32 s16, s6
  s_mov_b32 s17, s7
  s_mov_b32 s18, 0x180000
  s_mov_b32 s19, 0x20000
  s_mov_b32 s40, s52
  s_mov_b32 s41, s53
  s_mov_b32 s42, 0x158000
  s_mov_b32 s43, 0x20000
  s_mov_b32 s44, s54
  s_mov_b32 s45, s55
  s_mov_b32 s46, 0x158000
  s_mov_b32 s47, 0x20000

  s_lshl_b32 s32, s27, 7
  s_mul_i32 s35, s24, 49152
  s_mul_i32 s48, s24, 44032
  s_mul_i32 s37, s24, 6144
  s_add_u32 s37, s37, 16384
  s_lshl_b32 s60, s24, 10
  s_add_u32 s49, s28, 0
  s_and_b32 s49, s49, 7
  s_mul_i32 s50, s49, 196608
  s_mul_i32 s33, s49, 176128
  s_lshl_b32 s49, s49, 7
  s_add_u32 s49, s49, s34
  s_add_u32 s50, s50, s35
  s_add_u32 s51, s50, 24576
  s_add_u32 s33, s33, s48

  v_add_u32 v5, 0, v4
  v_lshrrev_b32 v6, 7, v5
  v_mul_u32_u24 v7, 171, v6
  v_lshrrev_b32 v7, 9, v7
  v_mul_u32_u24 v18, 3, v7
  v_sub_u32 v6, v6, v18
  v_and_b32 v5, 127, v5
  v_lshrrev_b32 v18, 1, v7
  v_and_b32 v18, 1, v18
  v_lshlrev_b32 v18, 6, v18
  v_xor_b32 v5, v5, v18
  v_mul_u32_u24 v18, 3072, v7
  v_lshl_add_u32 v18, v6, 10, v18
  v_add3_u32 v9, v18, v5, s32
  s_add_u32 m0, s37, 0
  s_nop 0
  buffer_load_dwordx4 v9, s[16:19], s50 offen lds
  s_add_u32 m0, s37, 3072
  s_nop 0
  buffer_load_dwordx4 v9, s[16:19], s51 offen lds

  v_add_u32 v5, 1024, v4
  v_lshrrev_b32 v6, 7, v5
  v_mul_u32_u24 v7, 171, v6
  v_lshrrev_b32 v7, 9, v7
  v_mul_u32_u24 v18, 3, v7
  v_sub_u32 v6, v6, v18
  v_and_b32 v5, 127, v5
  v_lshrrev_b32 v18, 1, v7
  v_and_b32 v18, 1, v18
  v_lshlrev_b32 v18, 6, v18
  v_xor_b32 v5, v5, v18
  v_mul_u32_u24 v18, 3072, v7
  v_lshl_add_u32 v18, v6, 10, v18
  v_add3_u32 v10, v18, v5, s32
  s_add_u32 m0, s37, 1024
  s_nop 0
  buffer_load_dwordx4 v10, s[16:19], s50 offen lds
  s_add_u32 m0, s37, 4096
  s_nop 0
  buffer_load_dwordx4 v10, s[16:19], s51 offen lds

  v_add_u32 v5, 2048, v4
  v_lshrrev_b32 v6, 7, v5
  v_mul_u32_u24 v7, 171, v6
  v_lshrrev_b32 v7, 9, v7
  v_mul_u32_u24 v18, 3, v7
  v_sub_u32 v6, v6, v18
  v_and_b32 v5, 127, v5
  v_lshrrev_b32 v18, 1, v7
  v_and_b32 v18, 1, v18
  v_lshlrev_b32 v18, 6, v18
  v_xor_b32 v5, v5, v18
  v_mul_u32_u24 v18, 3072, v7
  v_lshl_add_u32 v18, v6, 10, v18
  v_add3_u32 v11, v18, v5, s32
  s_add_u32 m0, s37, 2048
  s_nop 0
  buffer_load_dwordx4 v11, s[16:19], s50 offen lds
  s_add_u32 m0, s37, 5120
  s_nop 0
  buffer_load_dwordx4 v11, s[16:19], s51 offen lds

  v_lshrrev_b32 v5, 2, v0
  v_mul_u32_u24 v5, 2752, v5
  v_and_b32 v6, 3, v0
  v_lshlrev_b32 v6, 4, v6
  s_lshl_b32 s32, s63, 5
  v_add_u32 v5, s32, v5
  v_add_u32 v12, v5, v6
  v_xor_b32 v6, 32, v6
  v_add_u32 v13, v5, v6
  s_add_u32 m0, s60, 40960
  s_nop 0
  buffer_load_dwordx4 v12, s[40:43], s33 offen lds
  s_add_u32 m0, s60, 45056
  s_nop 0
  buffer_load_dwordx4 v13, s[44:47], s33 offen lds

  s_lshl_b32 s30, s26, 7
  s_lshl_b32 s31, s27, 3
  s_add_u32 s30, s30, s31
  s_lshl_b32 s31, s24, 1
  s_add_u32 s88, s30, s31
  s_lshl_b32 s31, s88, 10
  v_lshlrev_b32 v2, 4, v0
  buffer_load_dwordx4 v[20:23], v2, s[12:15], s31 offen
  buffer_load_dwordx4 v[24:27], v2, s[12:15], s31 offen offset:1024
  global_load_dwordx4 v[28:31], v2, s[10:11]
  s_add_u32 s49, s28, 1
  s_and_b32 s49, s49, 7
  s_mul_i32 s50, s49, 196608
  s_mul_i32 s33, s49, 176128
  s_lshl_b32 s49, s49, 7
  s_add_u32 s49, s49, s34
  s_add_u32 s50, s50, s35
  s_add_u32 s51, s50, 24576
  s_add_u32 s33, s33, s48
  s_add_u32 m0, s36, 53376
  s_add_u32 s38, s49, 0
  buffer_load_dwordx4 v8, s[12:15], s38 offen lds
  s_add_u32 m0, s36, 57472
  s_add_u32 s38, s49, 32768
  buffer_load_dwordx4 v8, s[12:15], s38 offen lds
  s_add_u32 m0, s36, 61568
  s_add_u32 s38, s49, 65536
  buffer_load_dwordx4 v8, s[12:15], s38 offen lds
  s_add_u32 m0, s36, 65664
  s_add_u32 s38, s49, 98304
  buffer_load_dwordx4 v8, s[12:15], s38 offen lds
  s_add_u32 m0, s37, 53376
  s_nop 0
  buffer_load_dwordx4 v9, s[16:19], s50 offen lds
  s_add_u32 m0, s37, 54400
  s_nop 0
  buffer_load_dwordx4 v10, s[16:19], s50 offen lds
  s_add_u32 m0, s37, 55424
  s_nop 0
  buffer_load_dwordx4 v11, s[16:19], s50 offen lds
  s_add_u32 m0, s37, 56448
  s_nop 0
  buffer_load_dwordx4 v9, s[16:19], s51 offen lds
  s_add_u32 m0, s37, 57472
  s_nop 0
  buffer_load_dwordx4 v10, s[16:19], s51 offen lds
  s_add_u32 m0, s37, 58496
  s_nop 0
  buffer_load_dwordx4 v11, s[16:19], s51 offen lds
  s_add_u32 m0, s60, 94336
  s_nop 0
  buffer_load_dwordx4 v12, s[40:43], s33 offen lds
  s_add_u32 m0, s60, 98432
  s_nop 0
  buffer_load_dwordx4 v13, s[44:47], s33 offen lds
  s_waitcnt vmcnt(15)
  s_barrier
  s_add_u32 s49, s28, 2
  s_and_b32 s49, s49, 7
  s_mul_i32 s50, s49, 196608
  s_mul_i32 s33, s49, 176128
  s_lshl_b32 s49, s49, 7
  s_add_u32 s49, s49, s34
  s_add_u32 s50, s50, s35
  s_add_u32 s51, s50, 24576
  s_add_u32 s33, s33, s48
  s_add_u32 m0, s36, 106752
  s_add_u32 s38, s49, 0
  buffer_load_dwordx4 v8, s[12:15], s38 offen lds
  s_add_u32 m0, s36, 110848
  s_add_u32 s38, s49, 32768
  buffer_load_dwordx4 v8, s[12:15], s38 offen lds
  s_add_u32 m0, s36, 114944
  s_add_u32 s38, s49, 65536
  buffer_load_dwordx4 v8, s[12:15], s38 offen lds
  s_add_u32 m0, s36, 119040
  s_add_u32 s38, s49, 98304
  buffer_load_dwordx4 v8, s[12:15], s38 offen lds
  s_add_u32 m0, s37, 106752
  s_nop 0
  buffer_load_dwordx4 v9, s[16:19], s50 offen lds
  s_add_u32 m0, s37, 107776
  s_nop 0
  buffer_load_dwordx4 v10, s[16:19], s50 offen lds
  s_add_u32 m0, s37, 108800
  s_nop 0
  buffer_load_dwordx4 v11, s[16:19], s50 offen lds
  s_add_u32 m0, s37, 109824
  s_nop 0
  buffer_load_dwordx4 v9, s[16:19], s51 offen lds
  s_add_u32 m0, s37, 110848
  s_nop 0
  buffer_load_dwordx4 v10, s[16:19], s51 offen lds
  s_add_u32 m0, s37, 111872
  s_nop 0
  buffer_load_dwordx4 v11, s[16:19], s51 offen lds
  s_add_u32 m0, s60, 147712
  s_nop 0
  buffer_load_dwordx4 v12, s[40:43], s33 offen lds
  s_add_u32 m0, s60, 151808
  s_nop 0
  buffer_load_dwordx4 v13, s[44:47], s33 offen lds
  s_waitcnt vmcnt(12)
  s_barrier

  v_lshlrev_b32 v32, 16, v28
  v_and_b32 v33, 0xffff0000, v28
  v_lshlrev_b32 v34, 16, v29
  v_and_b32 v35, 0xffff0000, v29
  v_lshlrev_b32 v36, 16, v30
  v_and_b32 v37, 0xffff0000, v30
  v_lshlrev_b32 v38, 16, v31
  v_and_b32 v39, 0xffff0000, v31
  v_lshlrev_b32 v42, 16, v20
  v_and_b32 v43, 0xffff0000, v20
  v_mul_f32 v40, v42, v32
  v_fmac_f32 v40, v43, v33
  v_lshlrev_b32 v42, 16, v21
  v_and_b32 v43, 0xffff0000, v21
  v_fmac_f32 v40, v42, v34
  v_fmac_f32 v40, v43, v35
  v_lshlrev_b32 v42, 16, v22
  v_and_b32 v43, 0xffff0000, v22
  v_fmac_f32 v40, v42, v36
  v_fmac_f32 v40, v43, v37
  v_lshlrev_b32 v42, 16, v23
  v_and_b32 v43, 0xffff0000, v23
  v_fmac_f32 v40, v42, v38
  v_fmac_f32 v40, v43, v39
  v_lshlrev_b32 v42, 16, v24
  v_and_b32 v43, 0xffff0000, v24
  v_mul_f32 v41, v42, v32
  v_fmac_f32 v41, v43, v33
  v_lshlrev_b32 v42, 16, v25
  v_and_b32 v43, 0xffff0000, v25
  v_fmac_f32 v41, v42, v34
  v_fmac_f32 v41, v43, v35
  v_lshlrev_b32 v42, 16, v26
  v_and_b32 v43, 0xffff0000, v26
  v_fmac_f32 v41, v42, v36
  v_fmac_f32 v41, v43, v37
  v_lshlrev_b32 v42, 16, v27
  v_and_b32 v43, 0xffff0000, v27
  v_fmac_f32 v41, v42, v38
  v_fmac_f32 v41, v43, v39
  s_nop 1
  v_add_f32_dpp v40, v40, v40 row_shr:1 row_mask:0xf bank_mask:0xf bound_ctrl:0
  v_add_f32_dpp v41, v41, v41 row_shr:1 row_mask:0xf bank_mask:0xf bound_ctrl:0
  s_nop 1
  v_add_f32_dpp v40, v40, v40 row_shr:2 row_mask:0xf bank_mask:0xf bound_ctrl:0
  v_add_f32_dpp v41, v41, v41 row_shr:2 row_mask:0xf bank_mask:0xf bound_ctrl:0
  s_nop 1
  v_add_f32_dpp v40, v40, v40 row_shr:4 row_mask:0xf bank_mask:0xf bound_ctrl:0
  v_add_f32_dpp v41, v41, v41 row_shr:4 row_mask:0xf bank_mask:0xf bound_ctrl:0
  s_nop 1
  v_add_f32_dpp v40, v40, v40 row_shr:8 row_mask:0xf bank_mask:0xf bound_ctrl:0
  v_add_f32_dpp v41, v41, v41 row_shr:8 row_mask:0xf bank_mask:0xf bound_ctrl:0
  s_nop 1
  v_readlane_b32 s82, v40, 15
  v_readlane_b32 s83, v40, 31
  v_readlane_b32 s84, v40, 47
  v_readlane_b32 s85, v40, 63
  v_readlane_b32 s39, v41, 15
  v_readlane_b32 s31, v41, 31
  v_readlane_b32 s32, v41, 47
  v_readlane_b32 s86, v41, 63
  s_nop 1
  v_mov_b32 v44, s82
  v_add_f32 v44, s83, v44
  v_add_f32 v44, s84, v44
  v_add_f32 v44, s85, v44
  v_mov_b32 v45, s39
  v_add_f32 v45, s31, v45
  v_add_f32 v45, s32, v45
  v_add_f32 v45, s86, v45
  v_cmp_eq_u32 vcc, 1, v0
  s_nop 1
  v_cndmask_b32 v44, v44, v45, vcc
  v_mul_f32 v44, 0xbfb8aa3b, v44
  v_exp_f32 v44, v44
  s_nop 0
  v_add_f32 v44, 1.0, v44
  v_rcp_f32 v44, v44
  s_lshl_b32 s82, s88, 2
  v_lshlrev_b32 v45, 2, v0
  v_add_u32 v45, s82, v45
  v_add_u32 v45, 0x10000, v45
  v_cmp_gt_u32 vcc, 2, v0
  s_and_saveexec_b64 s[82:83], vcc
  buffer_store_dword v44, v45, s[20:23], 0 offen sc1
  s_mov_b64 exec, s[82:83]
  s_add_u32 s49, s28, 3
  s_and_b32 s49, s49, 7
  s_mul_i32 s50, s49, 196608
  s_mul_i32 s33, s49, 176128
  s_lshl_b32 s49, s49, 7
  s_add_u32 s49, s49, s34
  s_add_u32 s50, s50, s35
  s_add_u32 s51, s50, 24576
  s_add_u32 s33, s33, s48
  s_add_u32 m0, s36, 0
  s_add_u32 s38, s49, 0
  buffer_load_dwordx4 v8, s[12:15], s38 offen lds
  s_add_u32 m0, s36, 4096
  s_add_u32 s38, s49, 32768
  buffer_load_dwordx4 v8, s[12:15], s38 offen lds
  s_add_u32 m0, s36, 8192
  s_add_u32 s38, s49, 65536
  buffer_load_dwordx4 v8, s[12:15], s38 offen lds
  s_add_u32 m0, s36, 12288
  s_add_u32 s38, s49, 98304
  buffer_load_dwordx4 v8, s[12:15], s38 offen lds
  s_add_u32 m0, s37, 0
  s_nop 0
  buffer_load_dwordx4 v9, s[16:19], s50 offen lds
  s_add_u32 m0, s37, 1024
  s_nop 0
  buffer_load_dwordx4 v10, s[16:19], s50 offen lds
  s_add_u32 m0, s37, 2048
  s_nop 0
  buffer_load_dwordx4 v11, s[16:19], s50 offen lds
  s_add_u32 m0, s37, 3072
  s_nop 0
  buffer_load_dwordx4 v9, s[16:19], s51 offen lds
  s_add_u32 m0, s37, 4096
  s_nop 0
  buffer_load_dwordx4 v10, s[16:19], s51 offen lds
  s_add_u32 m0, s37, 5120
  s_nop 0
  buffer_load_dwordx4 v11, s[16:19], s51 offen lds
  s_add_u32 m0, s60, 40960
  s_nop 0
  buffer_load_dwordx4 v12, s[40:43], s33 offen lds
  s_add_u32 m0, s60, 45056
  s_nop 0
  buffer_load_dwordx4 v13, s[44:47], s33 offen lds
  s_waitcnt vmcnt(13)
  s_barrier
  s_add_u32 s49, s28, 4
  s_and_b32 s49, s49, 7
  s_mul_i32 s50, s49, 196608
  s_mul_i32 s33, s49, 176128
  s_lshl_b32 s49, s49, 7
  s_add_u32 s49, s49, s34
  s_add_u32 s50, s50, s35
  s_add_u32 s51, s50, 24576
  s_add_u32 s33, s33, s48
  s_add_u32 m0, s36, 53376
  s_add_u32 s38, s49, 0
  buffer_load_dwordx4 v8, s[12:15], s38 offen lds
  s_add_u32 m0, s36, 57472
  s_add_u32 s38, s49, 32768
  buffer_load_dwordx4 v8, s[12:15], s38 offen lds
  s_add_u32 m0, s36, 61568
  s_add_u32 s38, s49, 65536
  buffer_load_dwordx4 v8, s[12:15], s38 offen lds
  s_add_u32 m0, s36, 65664
  s_add_u32 s38, s49, 98304
  buffer_load_dwordx4 v8, s[12:15], s38 offen lds
  s_add_u32 m0, s37, 53376
  s_nop 0
  buffer_load_dwordx4 v9, s[16:19], s50 offen lds
  s_add_u32 m0, s37, 54400
  s_nop 0
  buffer_load_dwordx4 v10, s[16:19], s50 offen lds
  s_add_u32 m0, s37, 55424
  s_nop 0
  buffer_load_dwordx4 v11, s[16:19], s50 offen lds
  s_add_u32 m0, s37, 56448
  s_nop 0
  buffer_load_dwordx4 v9, s[16:19], s51 offen lds
  s_add_u32 m0, s37, 57472
  s_nop 0
  buffer_load_dwordx4 v10, s[16:19], s51 offen lds
  s_add_u32 m0, s37, 58496
  s_nop 0
  buffer_load_dwordx4 v11, s[16:19], s51 offen lds
  s_add_u32 m0, s60, 94336
  s_nop 0
  buffer_load_dwordx4 v12, s[40:43], s33 offen lds
  s_add_u32 m0, s60, 98432
  s_nop 0
  buffer_load_dwordx4 v13, s[44:47], s33 offen lds
  s_waitcnt vmcnt(12)
  s_barrier
  s_add_u32 s49, s28, 5
  s_and_b32 s49, s49, 7
  s_mul_i32 s50, s49, 196608
  s_mul_i32 s33, s49, 176128
  s_lshl_b32 s49, s49, 7
  s_add_u32 s49, s49, s34
  s_add_u32 s50, s50, s35
  s_add_u32 s51, s50, 24576
  s_add_u32 s33, s33, s48
  s_add_u32 m0, s36, 106752
  s_add_u32 s38, s49, 0
  buffer_load_dwordx4 v8, s[12:15], s38 offen lds
  s_add_u32 m0, s36, 110848
  s_add_u32 s38, s49, 32768
  buffer_load_dwordx4 v8, s[12:15], s38 offen lds
  s_add_u32 m0, s36, 114944
  s_add_u32 s38, s49, 65536
  buffer_load_dwordx4 v8, s[12:15], s38 offen lds
  s_add_u32 m0, s36, 119040
  s_add_u32 s38, s49, 98304
  buffer_load_dwordx4 v8, s[12:15], s38 offen lds
  s_add_u32 m0, s37, 106752
  s_nop 0
  buffer_load_dwordx4 v9, s[16:19], s50 offen lds
  s_add_u32 m0, s37, 107776
  s_nop 0
  buffer_load_dwordx4 v10, s[16:19], s50 offen lds
  s_add_u32 m0, s37, 108800
  s_nop 0
  buffer_load_dwordx4 v11, s[16:19], s50 offen lds
  s_add_u32 m0, s37, 109824
  s_nop 0
  buffer_load_dwordx4 v9, s[16:19], s51 offen lds
  s_add_u32 m0, s37, 110848
  s_nop 0
  buffer_load_dwordx4 v10, s[16:19], s51 offen lds
  s_add_u32 m0, s37, 111872
  s_nop 0
  buffer_load_dwordx4 v11, s[16:19], s51 offen lds
  s_add_u32 m0, s60, 147712
  s_nop 0
  buffer_load_dwordx4 v12, s[40:43], s33 offen lds
  s_add_u32 m0, s60, 151808
  s_nop 0
  buffer_load_dwordx4 v13, s[44:47], s33 offen lds
  s_waitcnt vmcnt(12)
  s_barrier
  s_add_u32 s49, s28, 6
  s_and_b32 s49, s49, 7
  s_mul_i32 s50, s49, 196608
  s_mul_i32 s33, s49, 176128
  s_lshl_b32 s49, s49, 7
  s_add_u32 s49, s49, s34
  s_add_u32 s50, s50, s35
  s_add_u32 s51, s50, 24576
  s_add_u32 s33, s33, s48
  s_add_u32 m0, s36, 0
  s_add_u32 s38, s49, 0
  buffer_load_dwordx4 v8, s[12:15], s38 offen lds
  s_add_u32 m0, s36, 4096
  s_add_u32 s38, s49, 32768
  buffer_load_dwordx4 v8, s[12:15], s38 offen lds
  s_add_u32 m0, s36, 8192
  s_add_u32 s38, s49, 65536
  buffer_load_dwordx4 v8, s[12:15], s38 offen lds
  s_add_u32 m0, s36, 12288
  s_add_u32 s38, s49, 98304
  buffer_load_dwordx4 v8, s[12:15], s38 offen lds
  s_add_u32 m0, s37, 0
  s_nop 0
  buffer_load_dwordx4 v9, s[16:19], s50 offen lds
  s_add_u32 m0, s37, 1024
  s_nop 0
  buffer_load_dwordx4 v10, s[16:19], s50 offen lds
  s_add_u32 m0, s37, 2048
  s_nop 0
  buffer_load_dwordx4 v11, s[16:19], s50 offen lds
  s_add_u32 m0, s37, 3072
  s_nop 0
  buffer_load_dwordx4 v9, s[16:19], s51 offen lds
  s_add_u32 m0, s37, 4096
  s_nop 0
  buffer_load_dwordx4 v10, s[16:19], s51 offen lds
  s_add_u32 m0, s37, 5120
  s_nop 0
  buffer_load_dwordx4 v11, s[16:19], s51 offen lds
  s_add_u32 m0, s60, 40960
  s_nop 0
  buffer_load_dwordx4 v12, s[40:43], s33 offen lds
  s_add_u32 m0, s60, 45056
  s_nop 0
  buffer_load_dwordx4 v13, s[44:47], s33 offen lds
  s_waitcnt vmcnt(12)
  s_barrier
  s_add_u32 s49, s28, 7
  s_and_b32 s49, s49, 7
  s_mul_i32 s50, s49, 196608
  s_mul_i32 s33, s49, 176128
  s_lshl_b32 s49, s49, 7
  s_add_u32 s49, s49, s34
  s_add_u32 s50, s50, s35
  s_add_u32 s51, s50, 24576
  s_add_u32 s33, s33, s48
  s_add_u32 m0, s36, 53376
  s_add_u32 s38, s49, 0
  buffer_load_dwordx4 v8, s[12:15], s38 offen lds
  s_add_u32 m0, s36, 57472
  s_add_u32 s38, s49, 32768
  buffer_load_dwordx4 v8, s[12:15], s38 offen lds
  s_add_u32 m0, s36, 61568
  s_add_u32 s38, s49, 65536
  buffer_load_dwordx4 v8, s[12:15], s38 offen lds
  s_add_u32 m0, s36, 65664
  s_add_u32 s38, s49, 98304
  buffer_load_dwordx4 v8, s[12:15], s38 offen lds
  s_add_u32 m0, s37, 53376
  s_nop 0
  buffer_load_dwordx4 v9, s[16:19], s50 offen lds
  s_add_u32 m0, s37, 54400
  s_nop 0
  buffer_load_dwordx4 v10, s[16:19], s50 offen lds
  s_add_u32 m0, s37, 55424
  s_nop 0
  buffer_load_dwordx4 v11, s[16:19], s50 offen lds
  s_add_u32 m0, s37, 56448
  s_nop 0
  buffer_load_dwordx4 v9, s[16:19], s51 offen lds
  s_add_u32 m0, s37, 57472
  s_nop 0
  buffer_load_dwordx4 v10, s[16:19], s51 offen lds
  s_add_u32 m0, s37, 58496
  s_nop 0
  buffer_load_dwordx4 v11, s[16:19], s51 offen lds
  s_add_u32 m0, s60, 94336
  s_nop 0
  buffer_load_dwordx4 v12, s[40:43], s33 offen lds
  s_add_u32 m0, s60, 98432
  s_nop 0
  buffer_load_dwordx4 v13, s[44:47], s33 offen lds
  s_waitcnt vmcnt(12)
  s_barrier
  s_waitcnt vmcnt(0)
  s_barrier
  s_branch gated_mix__mha_block__swiglu_ffn__prompt_kernel_ldone
gated_mix__mha_block__swiglu_ffn__prompt_kernel_ldB:
  s_and_b32 s49, s28, 7
  s_lshl_b32 s49, s49, 7
  s_add_u32 s49, s49, s34
  s_add_u32 m0, s36, 0
  s_add_u32 s38, s49, 0
  buffer_load_dwordx4 v8, s[12:15], s38 offen lds
  s_add_u32 m0, s36, 4096
  s_add_u32 s38, s49, 32768
  buffer_load_dwordx4 v8, s[12:15], s38 offen lds
  s_add_u32 m0, s36, 8192
  s_add_u32 s38, s49, 65536
  buffer_load_dwordx4 v8, s[12:15], s38 offen lds
  s_add_u32 m0, s36, 12288
  s_add_u32 s38, s49, 98304
  buffer_load_dwordx4 v8, s[12:15], s38 offen lds

  s_lshr_b32 s30, s24, 1
  s_cmp_eq_u32 s30, 0
  s_cselect_b32 s40, s52, s54
  s_cselect_b32 s41, s53, s55
  s_mov_b32 s42, 0x158000
  s_mov_b32 s43, 0x20000
  s_and_b32 s31, s24, 1
  s_mul_i32 s48, s31, 88064
  s_mul_i32 s37, s30, 18560
  s_mul_i32 s31, s31, 9216
  s_add_u32 s37, s37, s31
  s_add_u32 s37, s37, 16384
  s_lshl_b32 s32, s63, 5
  s_lshl_b32 s33, s61, 5
  s_mov_b32 s30, 3641
  s_add_u32 s49, s28, 0
  s_and_b32 s49, s49, 7
  s_mul_i32 s50, s49, 176128
  s_lshl_b32 s49, s49, 7
  s_add_u32 s49, s49, s34
  s_add_u32 s50, s50, s48

  v_lshrrev_b32 v5, 4, v4
  v_add_u32 v5, 0, v5
  v_mul_u32_u24 v6, s30, v5
  v_lshrrev_b32 v6, 16, v6
  v_mul_u32_u24 v7, 18, v6
  v_sub_u32 v5, v5, v7
  v_lshlrev_b32 v5, 4, v5
  v_cmp_le_u32 vcc, s33, v5
  v_mul_u32_u24 v6, 2752, v6
  v_add3_u32 v6, v6, v5, s32
  v_add_u32 v7, 0x40000000, v6
  v_cndmask_b32 v9, v6, v7, vcc
  s_add_u32 m0, s37, 0
  s_nop 0
  buffer_load_dwordx4 v9, s[40:43], s50 offen lds

  v_lshrrev_b32 v5, 4, v4
  v_add_u32 v5, 64, v5
  v_mul_u32_u24 v6, s30, v5
  v_lshrrev_b32 v6, 16, v6
  v_mul_u32_u24 v7, 18, v6
  v_sub_u32 v5, v5, v7
  v_lshlrev_b32 v5, 4, v5
  v_cmp_le_u32 vcc, s33, v5
  v_mul_u32_u24 v6, 2752, v6
  v_add3_u32 v6, v6, v5, s32
  v_add_u32 v7, 0x40000000, v6
  v_cndmask_b32 v10, v6, v7, vcc
  s_add_u32 m0, s37, 1024
  s_nop 0
  buffer_load_dwordx4 v10, s[40:43], s50 offen lds

  v_lshrrev_b32 v5, 4, v4
  v_add_u32 v5, 128, v5
  v_mul_u32_u24 v6, s30, v5
  v_lshrrev_b32 v6, 16, v6
  v_mul_u32_u24 v7, 18, v6
  v_sub_u32 v5, v5, v7
  v_lshlrev_b32 v5, 4, v5
  v_cmp_le_u32 vcc, s33, v5
  v_mul_u32_u24 v6, 2752, v6
  v_add3_u32 v6, v6, v5, s32
  v_add_u32 v7, 0x40000000, v6
  v_cndmask_b32 v11, v6, v7, vcc
  s_add_u32 m0, s37, 2048
  s_nop 0
  buffer_load_dwordx4 v11, s[40:43], s50 offen lds

  v_lshrrev_b32 v5, 4, v4
  v_add_u32 v5, 192, v5
  v_mul_u32_u24 v6, s30, v5
  v_lshrrev_b32 v6, 16, v6
  v_mul_u32_u24 v7, 18, v6
  v_sub_u32 v5, v5, v7
  v_lshlrev_b32 v5, 4, v5
  v_cmp_le_u32 vcc, s33, v5
  v_mul_u32_u24 v6, 2752, v6
  v_add3_u32 v6, v6, v5, s32
  v_add_u32 v7, 0x40000000, v6
  v_cndmask_b32 v12, v6, v7, vcc
  s_add_u32 m0, s37, 3072
  s_nop 0
  buffer_load_dwordx4 v12, s[40:43], s50 offen lds

  v_lshrrev_b32 v5, 4, v4
  v_add_u32 v5, 256, v5
  v_mul_u32_u24 v6, s30, v5
  v_lshrrev_b32 v6, 16, v6
  v_mul_u32_u24 v7, 18, v6
  v_sub_u32 v5, v5, v7
  v_lshlrev_b32 v5, 4, v5
  v_cmp_le_u32 vcc, s33, v5
  v_mul_u32_u24 v6, 2752, v6
  v_add3_u32 v6, v6, v5, s32
  v_add_u32 v7, 0x40000000, v6
  v_cndmask_b32 v13, v6, v7, vcc
  s_add_u32 m0, s37, 4096
  s_nop 0
  buffer_load_dwordx4 v13, s[40:43], s50 offen lds

  v_lshrrev_b32 v5, 4, v4
  v_add_u32 v5, 320, v5
  v_mul_u32_u24 v6, s30, v5
  v_lshrrev_b32 v6, 16, v6
  v_mul_u32_u24 v7, 18, v6
  v_sub_u32 v5, v5, v7
  v_lshlrev_b32 v5, 4, v5
  v_cmp_le_u32 vcc, s33, v5
  v_mul_u32_u24 v6, 2752, v6
  v_add3_u32 v6, v6, v5, s32
  v_add_u32 v7, 0x40000000, v6
  v_cndmask_b32 v14, v6, v7, vcc
  s_add_u32 m0, s37, 5120
  s_nop 0
  buffer_load_dwordx4 v14, s[40:43], s50 offen lds

  v_lshrrev_b32 v5, 4, v4
  v_add_u32 v5, 384, v5
  v_mul_u32_u24 v6, s30, v5
  v_lshrrev_b32 v6, 16, v6
  v_mul_u32_u24 v7, 18, v6
  v_sub_u32 v5, v5, v7
  v_lshlrev_b32 v5, 4, v5
  v_cmp_le_u32 vcc, s33, v5
  v_mul_u32_u24 v6, 2752, v6
  v_add3_u32 v6, v6, v5, s32
  v_add_u32 v7, 0x40000000, v6
  v_cndmask_b32 v15, v6, v7, vcc
  s_add_u32 m0, s37, 6144
  s_nop 0
  buffer_load_dwordx4 v15, s[40:43], s50 offen lds

  v_lshrrev_b32 v5, 4, v4
  v_add_u32 v5, 448, v5
  v_mul_u32_u24 v6, s30, v5
  v_lshrrev_b32 v6, 16, v6
  v_mul_u32_u24 v7, 18, v6
  v_sub_u32 v5, v5, v7
  v_lshlrev_b32 v5, 4, v5
  v_cmp_le_u32 vcc, s33, v5
  v_mul_u32_u24 v6, 2752, v6
  v_add3_u32 v6, v6, v5, s32
  v_add_u32 v7, 0x40000000, v6
  v_cndmask_b32 v16, v6, v7, vcc
  s_add_u32 m0, s37, 7168
  s_nop 0
  buffer_load_dwordx4 v16, s[40:43], s50 offen lds

  v_lshrrev_b32 v5, 4, v4
  v_add_u32 v5, 512, v5
  v_mul_u32_u24 v6, s30, v5
  v_lshrrev_b32 v6, 16, v6
  v_mul_u32_u24 v7, 18, v6
  v_sub_u32 v5, v5, v7
  v_lshlrev_b32 v5, 4, v5
  v_cmp_le_u32 vcc, s33, v5
  v_mul_u32_u24 v6, 2752, v6
  v_add3_u32 v6, v6, v5, s32
  v_add_u32 v7, 0x40000000, v6
  v_cndmask_b32 v17, v6, v7, vcc
  s_add_u32 m0, s37, 8192
  s_nop 0
  buffer_load_dwordx4 v17, s[40:43], s50 offen lds

  s_lshl_b32 s30, s26, 7
  s_lshl_b32 s31, s27, 3
  s_add_u32 s30, s30, s31
  s_lshl_b32 s31, s24, 1
  s_add_u32 s88, s30, s31
  s_lshl_b32 s31, s88, 10
  v_lshlrev_b32 v2, 4, v0
  buffer_load_dwordx4 v[20:23], v2, s[12:15], s31 offen
  buffer_load_dwordx4 v[24:27], v2, s[12:15], s31 offen offset:1024
  global_load_dwordx4 v[28:31], v2, s[10:11]
  s_add_u32 s49, s28, 1
  s_and_b32 s49, s49, 7
  s_mul_i32 s50, s49, 176128
  s_lshl_b32 s49, s49, 7
  s_add_u32 s49, s49, s34
  s_add_u32 s50, s50, s48
  s_add_u32 m0, s36, 53376
  s_add_u32 s38, s49, 0
  buffer_load_dwordx4 v8, s[12:15], s38 offen lds
  s_add_u32 m0, s36, 57472
  s_add_u32 s38, s49, 32768
  buffer_load_dwordx4 v8, s[12:15], s38 offen lds
  s_add_u32 m0, s36, 61568
  s_add_u32 s38, s49, 65536
  buffer_load_dwordx4 v8, s[12:15], s38 offen lds
  s_add_u32 m0, s36, 65664
  s_add_u32 s38, s49, 98304
  buffer_load_dwordx4 v8, s[12:15], s38 offen lds
  s_add_u32 m0, s37, 53376
  s_nop 0
  buffer_load_dwordx4 v9, s[40:43], s50 offen lds
  s_add_u32 m0, s37, 54400
  s_nop 0
  buffer_load_dwordx4 v10, s[40:43], s50 offen lds
  s_add_u32 m0, s37, 55424
  s_nop 0
  buffer_load_dwordx4 v11, s[40:43], s50 offen lds
  s_add_u32 m0, s37, 56448
  s_nop 0
  buffer_load_dwordx4 v12, s[40:43], s50 offen lds
  s_add_u32 m0, s37, 57472
  s_nop 0
  buffer_load_dwordx4 v13, s[40:43], s50 offen lds
  s_add_u32 m0, s37, 58496
  s_nop 0
  buffer_load_dwordx4 v14, s[40:43], s50 offen lds
  s_add_u32 m0, s37, 59520
  s_nop 0
  buffer_load_dwordx4 v15, s[40:43], s50 offen lds
  s_add_u32 m0, s37, 60544
  s_nop 0
  buffer_load_dwordx4 v16, s[40:43], s50 offen lds
  s_add_u32 m0, s37, 61568
  s_nop 0
  buffer_load_dwordx4 v17, s[40:43], s50 offen lds
  s_waitcnt vmcnt(16)
  s_barrier
  s_add_u32 s49, s28, 2
  s_and_b32 s49, s49, 7
  s_mul_i32 s50, s49, 176128
  s_lshl_b32 s49, s49, 7
  s_add_u32 s49, s49, s34
  s_add_u32 s50, s50, s48
  s_add_u32 m0, s36, 106752
  s_add_u32 s38, s49, 0
  buffer_load_dwordx4 v8, s[12:15], s38 offen lds
  s_add_u32 m0, s36, 110848
  s_add_u32 s38, s49, 32768
  buffer_load_dwordx4 v8, s[12:15], s38 offen lds
  s_add_u32 m0, s36, 114944
  s_add_u32 s38, s49, 65536
  buffer_load_dwordx4 v8, s[12:15], s38 offen lds
  s_add_u32 m0, s36, 119040
  s_add_u32 s38, s49, 98304
  buffer_load_dwordx4 v8, s[12:15], s38 offen lds
  s_add_u32 m0, s37, 106752
  s_nop 0
  buffer_load_dwordx4 v9, s[40:43], s50 offen lds
  s_add_u32 m0, s37, 107776
  s_nop 0
  buffer_load_dwordx4 v10, s[40:43], s50 offen lds
  s_add_u32 m0, s37, 108800
  s_nop 0
  buffer_load_dwordx4 v11, s[40:43], s50 offen lds
  s_add_u32 m0, s37, 109824
  s_nop 0
  buffer_load_dwordx4 v12, s[40:43], s50 offen lds
  s_add_u32 m0, s37, 110848
  s_nop 0
  buffer_load_dwordx4 v13, s[40:43], s50 offen lds
  s_add_u32 m0, s37, 111872
  s_nop 0
  buffer_load_dwordx4 v14, s[40:43], s50 offen lds
  s_add_u32 m0, s37, 112896
  s_nop 0
  buffer_load_dwordx4 v15, s[40:43], s50 offen lds
  s_add_u32 m0, s37, 113920
  s_nop 0
  buffer_load_dwordx4 v16, s[40:43], s50 offen lds
  s_add_u32 m0, s37, 114944
  s_nop 0
  buffer_load_dwordx4 v17, s[40:43], s50 offen lds
  s_waitcnt vmcnt(13)
  s_barrier

  v_lshlrev_b32 v32, 16, v28
  v_and_b32 v33, 0xffff0000, v28
  v_lshlrev_b32 v34, 16, v29
  v_and_b32 v35, 0xffff0000, v29
  v_lshlrev_b32 v36, 16, v30
  v_and_b32 v37, 0xffff0000, v30
  v_lshlrev_b32 v38, 16, v31
  v_and_b32 v39, 0xffff0000, v31
  v_lshlrev_b32 v42, 16, v20
  v_and_b32 v43, 0xffff0000, v20
  v_mul_f32 v40, v42, v32
  v_fmac_f32 v40, v43, v33
  v_lshlrev_b32 v42, 16, v21
  v_and_b32 v43, 0xffff0000, v21
  v_fmac_f32 v40, v42, v34
  v_fmac_f32 v40, v43, v35
  v_lshlrev_b32 v42, 16, v22
  v_and_b32 v43, 0xffff0000, v22
  v_fmac_f32 v40, v42, v36
  v_fmac_f32 v40, v43, v37
  v_lshlrev_b32 v42, 16, v23
  v_and_b32 v43, 0xffff0000, v23
  v_fmac_f32 v40, v42, v38
  v_fmac_f32 v40, v43, v39
  v_lshlrev_b32 v42, 16, v24
  v_and_b32 v43, 0xffff0000, v24
  v_mul_f32 v41, v42, v32
  v_fmac_f32 v41, v43, v33
  v_lshlrev_b32 v42, 16, v25
  v_and_b32 v43, 0xffff0000, v25
  v_fmac_f32 v41, v42, v34
  v_fmac_f32 v41, v43, v35
  v_lshlrev_b32 v42, 16, v26
  v_and_b32 v43, 0xffff0000, v26
  v_fmac_f32 v41, v42, v36
  v_fmac_f32 v41, v43, v37
  v_lshlrev_b32 v42, 16, v27
  v_and_b32 v43, 0xffff0000, v27
  v_fmac_f32 v41, v42, v38
  v_fmac_f32 v41, v43, v39
  s_nop 1
  v_add_f32_dpp v40, v40, v40 row_shr:1 row_mask:0xf bank_mask:0xf bound_ctrl:0
  v_add_f32_dpp v41, v41, v41 row_shr:1 row_mask:0xf bank_mask:0xf bound_ctrl:0
  s_nop 1
  v_add_f32_dpp v40, v40, v40 row_shr:2 row_mask:0xf bank_mask:0xf bound_ctrl:0
  v_add_f32_dpp v41, v41, v41 row_shr:2 row_mask:0xf bank_mask:0xf bound_ctrl:0
  s_nop 1
  v_add_f32_dpp v40, v40, v40 row_shr:4 row_mask:0xf bank_mask:0xf bound_ctrl:0
  v_add_f32_dpp v41, v41, v41 row_shr:4 row_mask:0xf bank_mask:0xf bound_ctrl:0
  s_nop 1
  v_add_f32_dpp v40, v40, v40 row_shr:8 row_mask:0xf bank_mask:0xf bound_ctrl:0
  v_add_f32_dpp v41, v41, v41 row_shr:8 row_mask:0xf bank_mask:0xf bound_ctrl:0
  s_nop 1
  v_readlane_b32 s82, v40, 15
  v_readlane_b32 s83, v40, 31
  v_readlane_b32 s84, v40, 47
  v_readlane_b32 s85, v40, 63
  v_readlane_b32 s39, v41, 15
  v_readlane_b32 s31, v41, 31
  v_readlane_b32 s32, v41, 47
  v_readlane_b32 s86, v41, 63
  s_nop 1
  v_mov_b32 v44, s82
  v_add_f32 v44, s83, v44
  v_add_f32 v44, s84, v44
  v_add_f32 v44, s85, v44
  v_mov_b32 v45, s39
  v_add_f32 v45, s31, v45
  v_add_f32 v45, s32, v45
  v_add_f32 v45, s86, v45
  v_cmp_eq_u32 vcc, 1, v0
  s_nop 1
  v_cndmask_b32 v44, v44, v45, vcc
  v_mul_f32 v44, 0xbfb8aa3b, v44
  v_exp_f32 v44, v44
  s_nop 0
  v_add_f32 v44, 1.0, v44
  v_rcp_f32 v44, v44
  s_lshl_b32 s82, s88, 2
  v_lshlrev_b32 v45, 2, v0
  v_add_u32 v45, s82, v45
  v_add_u32 v45, 0x10000, v45
  v_cmp_gt_u32 vcc, 2, v0
  s_and_saveexec_b64 s[82:83], vcc
  buffer_store_dword v44, v45, s[20:23], 0 offen sc1
  s_mov_b64 exec, s[82:83]
  s_add_u32 s49, s28, 3
  s_and_b32 s49, s49, 7
  s_mul_i32 s50, s49, 176128
  s_lshl_b32 s49, s49, 7
  s_add_u32 s49, s49, s34
  s_add_u32 s50, s50, s48
  s_add_u32 m0, s36, 0
  s_add_u32 s38, s49, 0
  buffer_load_dwordx4 v8, s[12:15], s38 offen lds
  s_add_u32 m0, s36, 4096
  s_add_u32 s38, s49, 32768
  buffer_load_dwordx4 v8, s[12:15], s38 offen lds
  s_add_u32 m0, s36, 8192
  s_add_u32 s38, s49, 65536
  buffer_load_dwordx4 v8, s[12:15], s38 offen lds
  s_add_u32 m0, s36, 12288
  s_add_u32 s38, s49, 98304
  buffer_load_dwordx4 v8, s[12:15], s38 offen lds
  s_add_u32 m0, s37, 0
  s_nop 0
  buffer_load_dwordx4 v9, s[40:43], s50 offen lds
  s_add_u32 m0, s37, 1024
  s_nop 0
  buffer_load_dwordx4 v10, s[40:43], s50 offen lds
  s_add_u32 m0, s37, 2048
  s_nop 0
  buffer_load_dwordx4 v11, s[40:43], s50 offen lds
  s_add_u32 m0, s37, 3072
  s_nop 0
  buffer_load_dwordx4 v12, s[40:43], s50 offen lds
  s_add_u32 m0, s37, 4096
  s_nop 0
  buffer_load_dwordx4 v13, s[40:43], s50 offen lds
  s_add_u32 m0, s37, 5120
  s_nop 0
  buffer_load_dwordx4 v14, s[40:43], s50 offen lds
  s_add_u32 m0, s37, 6144
  s_nop 0
  buffer_load_dwordx4 v15, s[40:43], s50 offen lds
  s_add_u32 m0, s37, 7168
  s_nop 0
  buffer_load_dwordx4 v16, s[40:43], s50 offen lds
  s_add_u32 m0, s37, 8192
  s_nop 0
  buffer_load_dwordx4 v17, s[40:43], s50 offen lds
  s_waitcnt vmcnt(14)
  s_barrier
  s_add_u32 s49, s28, 4
  s_and_b32 s49, s49, 7
  s_mul_i32 s50, s49, 176128
  s_lshl_b32 s49, s49, 7
  s_add_u32 s49, s49, s34
  s_add_u32 s50, s50, s48
  s_add_u32 m0, s36, 53376
  s_add_u32 s38, s49, 0
  buffer_load_dwordx4 v8, s[12:15], s38 offen lds
  s_add_u32 m0, s36, 57472
  s_add_u32 s38, s49, 32768
  buffer_load_dwordx4 v8, s[12:15], s38 offen lds
  s_add_u32 m0, s36, 61568
  s_add_u32 s38, s49, 65536
  buffer_load_dwordx4 v8, s[12:15], s38 offen lds
  s_add_u32 m0, s36, 65664
  s_add_u32 s38, s49, 98304
  buffer_load_dwordx4 v8, s[12:15], s38 offen lds
  s_add_u32 m0, s37, 53376
  s_nop 0
  buffer_load_dwordx4 v9, s[40:43], s50 offen lds
  s_add_u32 m0, s37, 54400
  s_nop 0
  buffer_load_dwordx4 v10, s[40:43], s50 offen lds
  s_add_u32 m0, s37, 55424
  s_nop 0
  buffer_load_dwordx4 v11, s[40:43], s50 offen lds
  s_add_u32 m0, s37, 56448
  s_nop 0
  buffer_load_dwordx4 v12, s[40:43], s50 offen lds
  s_add_u32 m0, s37, 57472
  s_nop 0
  buffer_load_dwordx4 v13, s[40:43], s50 offen lds
  s_add_u32 m0, s37, 58496
  s_nop 0
  buffer_load_dwordx4 v14, s[40:43], s50 offen lds
  s_add_u32 m0, s37, 59520
  s_nop 0
  buffer_load_dwordx4 v15, s[40:43], s50 offen lds
  s_add_u32 m0, s37, 60544
  s_nop 0
  buffer_load_dwordx4 v16, s[40:43], s50 offen lds
  s_add_u32 m0, s37, 61568
  s_nop 0
  buffer_load_dwordx4 v17, s[40:43], s50 offen lds
  s_waitcnt vmcnt(13)
  s_barrier
  s_add_u32 s49, s28, 5
  s_and_b32 s49, s49, 7
  s_mul_i32 s50, s49, 176128
  s_lshl_b32 s49, s49, 7
  s_add_u32 s49, s49, s34
  s_add_u32 s50, s50, s48
  s_add_u32 m0, s36, 106752
  s_add_u32 s38, s49, 0
  buffer_load_dwordx4 v8, s[12:15], s38 offen lds
  s_add_u32 m0, s36, 110848
  s_add_u32 s38, s49, 32768
  buffer_load_dwordx4 v8, s[12:15], s38 offen lds
  s_add_u32 m0, s36, 114944
  s_add_u32 s38, s49, 65536
  buffer_load_dwordx4 v8, s[12:15], s38 offen lds
  s_add_u32 m0, s36, 119040
  s_add_u32 s38, s49, 98304
  buffer_load_dwordx4 v8, s[12:15], s38 offen lds
  s_add_u32 m0, s37, 106752
  s_nop 0
  buffer_load_dwordx4 v9, s[40:43], s50 offen lds
  s_add_u32 m0, s37, 107776
  s_nop 0
  buffer_load_dwordx4 v10, s[40:43], s50 offen lds
  s_add_u32 m0, s37, 108800
  s_nop 0
  buffer_load_dwordx4 v11, s[40:43], s50 offen lds
  s_add_u32 m0, s37, 109824
  s_nop 0
  buffer_load_dwordx4 v12, s[40:43], s50 offen lds
  s_add_u32 m0, s37, 110848
  s_nop 0
  buffer_load_dwordx4 v13, s[40:43], s50 offen lds
  s_add_u32 m0, s37, 111872
  s_nop 0
  buffer_load_dwordx4 v14, s[40:43], s50 offen lds
  s_add_u32 m0, s37, 112896
  s_nop 0
  buffer_load_dwordx4 v15, s[40:43], s50 offen lds
  s_add_u32 m0, s37, 113920
  s_nop 0
  buffer_load_dwordx4 v16, s[40:43], s50 offen lds
  s_add_u32 m0, s37, 114944
  s_nop 0
  buffer_load_dwordx4 v17, s[40:43], s50 offen lds
  s_waitcnt vmcnt(13)
  s_barrier
  s_add_u32 s49, s28, 6
  s_and_b32 s49, s49, 7
  s_mul_i32 s50, s49, 176128
  s_lshl_b32 s49, s49, 7
  s_add_u32 s49, s49, s34
  s_add_u32 s50, s50, s48
  s_add_u32 m0, s36, 0
  s_add_u32 s38, s49, 0
  buffer_load_dwordx4 v8, s[12:15], s38 offen lds
  s_add_u32 m0, s36, 4096
  s_add_u32 s38, s49, 32768
  buffer_load_dwordx4 v8, s[12:15], s38 offen lds
  s_add_u32 m0, s36, 8192
  s_add_u32 s38, s49, 65536
  buffer_load_dwordx4 v8, s[12:15], s38 offen lds
  s_add_u32 m0, s36, 12288
  s_add_u32 s38, s49, 98304
  buffer_load_dwordx4 v8, s[12:15], s38 offen lds
  s_add_u32 m0, s37, 0
  s_nop 0
  buffer_load_dwordx4 v9, s[40:43], s50 offen lds
  s_add_u32 m0, s37, 1024
  s_nop 0
  buffer_load_dwordx4 v10, s[40:43], s50 offen lds
  s_add_u32 m0, s37, 2048
  s_nop 0
  buffer_load_dwordx4 v11, s[40:43], s50 offen lds
  s_add_u32 m0, s37, 3072
  s_nop 0
  buffer_load_dwordx4 v12, s[40:43], s50 offen lds
  s_add_u32 m0, s37, 4096
  s_nop 0
  buffer_load_dwordx4 v13, s[40:43], s50 offen lds
  s_add_u32 m0, s37, 5120
  s_nop 0
  buffer_load_dwordx4 v14, s[40:43], s50 offen lds
  s_add_u32 m0, s37, 6144
  s_nop 0
  buffer_load_dwordx4 v15, s[40:43], s50 offen lds
  s_add_u32 m0, s37, 7168
  s_nop 0
  buffer_load_dwordx4 v16, s[40:43], s50 offen lds
  s_add_u32 m0, s37, 8192
  s_nop 0
  buffer_load_dwordx4 v17, s[40:43], s50 offen lds
  s_waitcnt vmcnt(13)
  s_barrier
  s_add_u32 s49, s28, 7
  s_and_b32 s49, s49, 7
  s_mul_i32 s50, s49, 176128
  s_lshl_b32 s49, s49, 7
  s_add_u32 s49, s49, s34
  s_add_u32 s50, s50, s48
  s_add_u32 m0, s36, 53376
  s_add_u32 s38, s49, 0
  buffer_load_dwordx4 v8, s[12:15], s38 offen lds
  s_add_u32 m0, s36, 57472
  s_add_u32 s38, s49, 32768
  buffer_load_dwordx4 v8, s[12:15], s38 offen lds
  s_add_u32 m0, s36, 61568
  s_add_u32 s38, s49, 65536
  buffer_load_dwordx4 v8, s[12:15], s38 offen lds
  s_add_u32 m0, s36, 65664
  s_add_u32 s38, s49, 98304
  buffer_load_dwordx4 v8, s[12:15], s38 offen lds
  s_add_u32 m0, s37, 53376
  s_nop 0
  buffer_load_dwordx4 v9, s[40:43], s50 offen lds
  s_add_u32 m0, s37, 54400
  s_nop 0
  buffer_load_dwordx4 v10, s[40:43], s50 offen lds
  s_add_u32 m0, s37, 55424
  s_nop 0
  buffer_load_dwordx4 v11, s[40:43], s50 offen lds
  s_add_u32 m0, s37, 56448
  s_nop 0
  buffer_load_dwordx4 v12, s[40:43], s50 offen lds
  s_add_u32 m0, s37, 57472
  s_nop 0
  buffer_load_dwordx4 v13, s[40:43], s50 offen lds
  s_add_u32 m0, s37, 58496
  s_nop 0
  buffer_load_dwordx4 v14, s[40:43], s50 offen lds
  s_add_u32 m0, s37, 59520
  s_nop 0
  buffer_load_dwordx4 v15, s[40:43], s50 offen lds
  s_add_u32 m0, s37, 60544
  s_nop 0
  buffer_load_dwordx4 v16, s[40:43], s50 offen lds
  s_add_u32 m0, s37, 61568
  s_nop 0
  buffer_load_dwordx4 v17, s[40:43], s50 offen lds
  s_waitcnt vmcnt(13)
  s_barrier
  s_waitcnt vmcnt(0)
  s_barrier

gated_mix__mha_block__swiglu_ffn__prompt_kernel_ldone:
  s_waitcnt lgkmcnt(0)
  s_mul_i32 s3, s3, 1664525
  s_add_u32 s3, s3, 1013904223
  s_barrier
  s_mov_b32 s20, s8
  s_mov_b32 s21, s9
  s_mov_b32 s22, 0x1500000
  s_mov_b32 s23, 0x20000
  s_mov_b32 s12, s56
  s_mov_b32 s13, s57
  s_mov_b32 s14, 0x158000
  s_mov_b32 s15, 0x20000

  s_lshr_b32 s26, s25, 1
  s_lshl_b32 s26, s26, 3
  s_lshr_b32 s28, s2, 3
  s_and_b32 s28, s28, 7
  s_add_u32 s26, s26, s28
  s_and_b32 s28, s25, 1
  s_lshl_b32 s28, s28, 2
  s_lshr_b32 s30, s2, 6
  s_add_u32 s28, s28, s30

  s_mul_i32 s33, s24, 22
  s_cmp_eq_u32 s24, 3
  s_cselect_b32 s30, 1, 0
  s_sub_u32 s33, s33, s30
  s_cmp_ge_u32 s24, 2
  s_cselect_b32 s34, 21, 22
  s_lshl_b32 s35, s33, 14
  s_lshl_b32 s36, s28, 7
  s_add_u32 s35, s35, s36
  s_mul_i32 s36, s26, 172
  s_add_u32 s36, s36, s33
  s_lshl_b32 s36, s36, 10
  s_add_u32 s36, s36, 0x900000
  s_mov_b32 s37, 88064
  s_lshl_b32 s38, s24, 14
  s_mov_b32 s42, 0x40000000
  v_lshrrev_b32 v2, 3, v0
  v_lshrrev_b32 v3, 4, v0
  v_and_b32 v3, 1, v3
  v_lshlrev_b32 v3, 2, v3
  v_and_b32 v5, 7, v0
  v_xor_b32 v3, v3, v5
  v_lshlrev_b32 v3, 4, v3
  v_lshl_add_u32 v2, v2, 10, v3
  v_lshlrev_b32 v3, 4, v0
  v_lshrrev_b32 v4, 5, v0
  v_and_b32 v5, 15, v0
  v_lshrrev_b32 v6, 2, v5
  v_lshl_add_u32 v4, v4, 2, v6
  v_lshrrev_b32 v7, 1, v6
  v_and_b32 v7, 1, v7
  v_lshlrev_b32 v4, 7, v4
  v_lshl_add_u32 v4, v7, 6, v4
  v_lshrrev_b32 v6, 4, v0
  v_and_b32 v6, 1, v6
  v_lshl_add_u32 v4, v6, 5, v4
  v_and_b32 v6, 3, v5
  v_lshl_add_u32 v4, v6, 3, v4
  v_xor_b32 v7, 64, v4
  v_add_u32 v4, s38, v4
  v_add_u32 v7, s38, v7
  s_waitcnt vmcnt(0)

  s_lshl_b32 s30, s25, 4
  v_and_b32 v12, 15, v0
  v_add_u32 v12, s30, v12
  v_lshlrev_b32 v12, 6, v12
  v_add_u32 v12, 0x9000, v12
  s_cmp_eq_u32 s24, 1
  s_cbranch_scc0 gated_mix__mha_block__swiglu_ffn__prompt_kernel_g_e0
  s_cmp_lg_u32 s62, 0
  s_cbranch_scc0 gated_mix__mha_block__swiglu_ffn__prompt_kernel_g_e0

  s_mov_b32 s87, 0
gated_mix__mha_block__swiglu_ffn__prompt_kernel_pollB:
  buffer_load_dword v6, v12, s[20:23], 0 offen sc1
  s_waitcnt vmcnt(0)
  v_cmp_eq_u32 vcc, s3, v6
  s_cmp_eq_u64 vcc, exec
  s_cbranch_scc1 gated_mix__mha_block__swiglu_ffn__prompt_kernel_pollB_ok
  s_add_u32 s87, s87, 1
  s_cmp_lt_u32 s87, 65536
  s_cbranch_scc0 gated_mix__mha_block__swiglu_ffn__prompt_kernel_pollB_ok
  s_sleep 2
  s_branch gated_mix__mha_block__swiglu_ffn__prompt_kernel_pollB
gated_mix__mha_block__swiglu_ffn__prompt_kernel_pollB_ok:

gated_mix__mha_block__swiglu_ffn__prompt_kernel_g_e0:
  s_barrier
  s_cmp_eq_u32 s24, 1
  s_cbranch_scc0 gated_mix__mha_block__swiglu_ffn__prompt_kernel_g_e2
  s_cmp_lg_u32 s62, 0
  s_cbranch_scc1 gated_mix__mha_block__swiglu_ffn__prompt_kernel_g_e2
  s_and_b32 s30, s29, 15
  s_lshl_b32 s30, s30, 4
  s_lshr_b32 s31, s29, 4
  s_add_u32 s30, s30, s31
  s_lshl_b32 s30, s30, 6
  s_add_u32 s30, s30, 0x9000
  v_mov_b32 v5, s30
  v_mov_b32 v6, s3
  s_mov_b64 exec, 1
  buffer_store_dword v6, v5, s[20:23], 0 offen sc1
  s_mov_b64 exec, -1

  s_mov_b32 s87, 0
gated_mix__mha_block__swiglu_ffn__prompt_kernel_pollA:
  buffer_load_dword v6, v12, s[20:23], 0 offen sc1
  s_waitcnt vmcnt(0)
  v_cmp_eq_u32 vcc, s3, v6
  s_cmp_eq_u64 vcc, exec
  s_cbranch_scc1 gated_mix__mha_block__swiglu_ffn__prompt_kernel_pollA_ok
  s_add_u32 s87, s87, 1
  s_cmp_lt_u32 s87, 65536
  s_cbranch_scc0 gated_mix__mha_block__swiglu_ffn__prompt_kernel_pollA_ok
  s_sleep 2
  s_branch gated_mix__mha_block__swiglu_ffn__prompt_kernel_pollA
gated_mix__mha_block__swiglu_ffn__prompt_kernel_pollA_ok:

gated_mix__mha_block__swiglu_ffn__prompt_kernel_g_e2:
  s_barrier
  s_barrier

  s_cmp_gt_u32 s34, 0
  s_cselect_b32 s40, s35, s42
  s_add_u32 m0, s38, 0
  s_add_u32 s44, s40, 8192
  buffer_load_dwordx4 v2, s[12:15], s40 offen lds
  s_add_u32 m0, s38, 1024
  s_add_u32 s35, s35, 16384
  buffer_load_dwordx4 v2, s[12:15], s44 offen lds
  s_cmp_gt_u32 s34, 1
  s_cselect_b32 s40, s35, s42
  s_add_u32 m0, s38, 2048
  s_add_u32 s44, s40, 8192
  buffer_load_dwordx4 v2, s[12:15], s40 offen lds
  s_add_u32 m0, s38, 3072
  s_add_u32 s35, s35, 16384
  buffer_load_dwordx4 v2, s[12:15], s44 offen lds
  s_cmp_gt_u32 s34, 2
  s_cselect_b32 s40, s35, s42
  s_add_u32 m0, s38, 4096
  s_add_u32 s44, s40, 8192
  buffer_load_dwordx4 v2, s[12:15], s40 offen lds
  s_add_u32 m0, s38, 5120
  s_add_u32 s35, s35, 16384
  buffer_load_dwordx4 v2, s[12:15], s44 offen lds
  s_cmp_gt_u32 s34, 3
  s_cselect_b32 s40, s35, s42
  s_add_u32 m0, s38, 6144
  s_add_u32 s44, s40, 8192
  buffer_load_dwordx4 v2, s[12:15], s40 offen lds
  s_add_u32 m0, s38, 7168
  s_add_u32 s35, s35, 16384
  buffer_load_dwordx4 v2, s[12:15], s44 offen lds
  s_cmp_gt_u32 s34, 4
  s_cselect_b32 s40, s35, s42
  s_add_u32 m0, s38, 8192
  s_add_u32 s44, s40, 8192
  buffer_load_dwordx4 v2, s[12:15], s40 offen lds
  s_add_u32 m0, s38, 9216
  s_add_u32 s35, s35, 16384
  buffer_load_dwordx4 v2, s[12:15], s44 offen lds
  s_cmp_gt_u32 s34, 5
  s_cselect_b32 s40, s35, s42
  s_add_u32 m0, s38, 10240
  s_add_u32 s44, s40, 8192
  buffer_load_dwordx4 v2, s[12:15], s40 offen lds
  s_add_u32 m0, s38, 11264
  s_add_u32 s35, s35, 16384
  buffer_load_dwordx4 v2, s[12:15], s44 offen lds
  s_cmp_gt_u32 s34, 6
  s_cselect_b32 s40, s35, s42
  s_add_u32 m0, s38, 12288
  s_add_u32 s44, s40, 8192
  buffer_load_dwordx4 v2, s[12:15], s40 offen lds
  s_add_u32 m0, s38, 13312
  s_add_u32 s35, s35, 16384
  buffer_load_dwordx4 v2, s[12:15], s44 offen lds
  s_cmp_gt_u32 s34, 7
  s_cselect_b32 s40, s35, s42
  s_add_u32 m0, s38, 14336
  s_add_u32 s44, s40, 8192
  buffer_load_dwordx4 v2, s[12:15], s40 offen lds
  s_add_u32 m0, s38, 15360
  s_add_u32 s35, s35, 16384
  buffer_load_dwordx4 v2, s[12:15], s44 offen lds

  s_cmp_lg_u32 s24, 0
  s_cbranch_scc1 gated_mix__mha_block__swiglu_ffn__prompt_kernel_g_nopost
  s_lshr_b32 s30, s29, 4
  s_mul_i32 s30, s30, 344
  s_add_u32 s30, s30, s63
  s_lshl_b32 s30, s30, 10
  s_add_u32 s30, s30, 0x900000
  v_add_u32 v5, 65536, v3
  s_cmp_lg_u32 s62, 0
  s_cbranch_scc1 gated_mix__mha_block__swiglu_ffn__prompt_kernel_g_hB
  ds_read_b128 v[192:195], v5 offset:0
  ds_read_b128 v[196:199], v5 offset:1024
  ds_read_b128 v[200:203], v5 offset:9216
  ds_read_b128 v[204:207], v5 offset:10240
  ds_read_b128 v[208:211], v5 offset:18432
  ds_read_b128 v[212:215], v5 offset:19456
  ds_read_b128 v[216:219], v5 offset:27648
  ds_read_b128 v[220:223], v5 offset:28672
  s_cmp_gt_u32 s61, 0
  s_cselect_b32 s41, s30, s42
  s_add_u32 s40, s41, 0
  s_waitcnt lgkmcnt(7)
  buffer_store_dwordx4 v[192:195], v3, s[20:23], s40 offen sc1
  s_cmp_gt_u32 s61, 1
  s_cselect_b32 s41, s30, s42
  s_add_u32 s40, s41, 1024
  s_waitcnt lgkmcnt(6)
  buffer_store_dwordx4 v[196:199], v3, s[20:23], s40 offen sc1
  s_cmp_gt_u32 s61, 0
  s_cselect_b32 s41, s30, s42
  s_add_u32 s40, s41, 88064
  s_waitcnt lgkmcnt(5)
  buffer_store_dwordx4 v[200:203], v3, s[20:23], s40 offen sc1
  s_cmp_gt_u32 s61, 1
  s_cselect_b32 s41, s30, s42
  s_add_u32 s40, s41, 89088
  s_waitcnt lgkmcnt(4)
  buffer_store_dwordx4 v[204:207], v3, s[20:23], s40 offen sc1
  s_cmp_gt_u32 s61, 0
  s_cselect_b32 s41, s30, s42
  s_add_u32 s40, s41, 176128
  s_waitcnt lgkmcnt(3)
  buffer_store_dwordx4 v[208:211], v3, s[20:23], s40 offen sc1
  s_cmp_gt_u32 s61, 1
  s_cselect_b32 s41, s30, s42
  s_add_u32 s40, s41, 177152
  s_waitcnt lgkmcnt(2)
  buffer_store_dwordx4 v[212:215], v3, s[20:23], s40 offen sc1
  s_cmp_gt_u32 s61, 0
  s_cselect_b32 s41, s30, s42
  s_add_u32 s40, s41, 264192
  s_waitcnt lgkmcnt(1)
  buffer_store_dwordx4 v[216:219], v3, s[20:23], s40 offen sc1
  s_cmp_gt_u32 s61, 1
  s_cselect_b32 s41, s30, s42
  s_add_u32 s40, s41, 265216
  s_waitcnt lgkmcnt(0)
  buffer_store_dwordx4 v[220:223], v3, s[20:23], s40 offen sc1
  s_nop 1
  s_branch gated_mix__mha_block__swiglu_ffn__prompt_kernel_g_hdone
gated_mix__mha_block__swiglu_ffn__prompt_kernel_g_hB:
  ds_read_b128 v[192:195], v5 offset:0
  ds_read_b128 v[196:199], v5 offset:1024
  ds_read_b128 v[200:203], v5 offset:2048
  ds_read_b128 v[204:207], v5 offset:3072
  ds_read_b128 v[208:211], v5 offset:4096
  ds_read_b128 v[212:215], v5 offset:5120
  ds_read_b128 v[216:219], v5 offset:6144
  ds_read_b128 v[220:223], v5 offset:7168
  s_cmp_gt_u32 s61, 0
  s_cselect_b32 s41, s30, s42
  s_add_u32 s40, s41, 0
  s_waitcnt lgkmcnt(7)
  buffer_store_dwordx4 v[192:195], v3, s[20:23], s40 offen sc1
  s_cmp_gt_u32 s61, 1
  s_cselect_b32 s41, s30, s42
  s_add_u32 s40, s41, 1024
  s_waitcnt lgkmcnt(6)
  buffer_store_dwordx4 v[196:199], v3, s[20:23], s40 offen sc1
  s_cmp_gt_u32 s61, 2
  s_cselect_b32 s41, s30, s42
  s_add_u32 s40, s41, 2048
  s_waitcnt lgkmcnt(5)
  buffer_store_dwordx4 v[200:203], v3, s[20:23], s40 offen sc1
  s_cmp_gt_u32 s61, 3
  s_cselect_b32 s41, s30, s42
  s_add_u32 s40, s41, 3072
  s_waitcnt lgkmcnt(4)
  buffer_store_dwordx4 v[204:207], v3, s[20:23], s40 offen sc1
  s_cmp_gt_u32 s61, 4
  s_cselect_b32 s41, s30, s42
  s_add_u32 s40, s41, 4096
  s_waitcnt lgkmcnt(3)
  buffer_store_dwordx4 v[208:211], v3, s[20:23], s40 offen sc1
  s_cmp_gt_u32 s61, 5
  s_cselect_b32 s41, s30, s42
  s_add_u32 s40, s41, 5120
  s_waitcnt lgkmcnt(2)
  buffer_store_dwordx4 v[212:215], v3, s[20:23], s40 offen sc1
  s_cmp_gt_u32 s61, 6
  s_cselect_b32 s41, s30, s42
  s_add_u32 s40, s41, 6144
  s_waitcnt lgkmcnt(1)
  buffer_store_dwordx4 v[216:219], v3, s[20:23], s40 offen sc1
  s_cmp_gt_u32 s61, 7
  s_cselect_b32 s41, s30, s42
  s_add_u32 s40, s41, 7168
  s_waitcnt lgkmcnt(0)
  buffer_store_dwordx4 v[220:223], v3, s[20:23], s40 offen sc1
  s_nop 1
  ds_read_b128 v[192:195], v5 offset:8192
  ds_read_b128 v[196:199], v5 offset:9216
  ds_read_b128 v[200:203], v5 offset:10240
  ds_read_b128 v[204:207], v5 offset:11264
  ds_read_b128 v[208:211], v5 offset:12288
  ds_read_b128 v[212:215], v5 offset:13312
  ds_read_b128 v[216:219], v5 offset:14336
  ds_read_b128 v[220:223], v5 offset:15360
  s_cmp_gt_u32 s61, 8
  s_cselect_b32 s41, s30, s42
  s_add_u32 s40, s41, 8192
  s_waitcnt lgkmcnt(7)
  buffer_store_dwordx4 v[192:195], v3, s[20:23], s40 offen sc1
  s_cmp_gt_u32 s61, 0
  s_cselect_b32 s41, s30, s42
  s_add_u32 s40, s41, 88064
  s_waitcnt lgkmcnt(6)
  buffer_store_dwordx4 v[196:199], v3, s[20:23], s40 offen sc1
  s_cmp_gt_u32 s61, 1
  s_cselect_b32 s41, s30, s42
  s_add_u32 s40, s41, 89088
  s_waitcnt lgkmcnt(5)
  buffer_store_dwordx4 v[200:203], v3, s[20:23], s40 offen sc1
  s_cmp_gt_u32 s61, 2
  s_cselect_b32 s41, s30, s42
  s_add_u32 s40, s41, 90112
  s_waitcnt lgkmcnt(4)
  buffer_store_dwordx4 v[204:207], v3, s[20:23], s40 offen sc1
  s_cmp_gt_u32 s61, 3
  s_cselect_b32 s41, s30, s42
  s_add_u32 s40, s41, 91136
  s_waitcnt lgkmcnt(3)
  buffer_store_dwordx4 v[208:211], v3, s[20:23], s40 offen sc1
  s_cmp_gt_u32 s61, 4
  s_cselect_b32 s41, s30, s42
  s_add_u32 s40, s41, 92160
  s_waitcnt lgkmcnt(2)
  buffer_store_dwordx4 v[212:215], v3, s[20:23], s40 offen sc1
  s_cmp_gt_u32 s61, 5
  s_cselect_b32 s41, s30, s42
  s_add_u32 s40, s41, 93184
  s_waitcnt lgkmcnt(1)
  buffer_store_dwordx4 v[216:219], v3, s[20:23], s40 offen sc1
  s_cmp_gt_u32 s61, 6
  s_cselect_b32 s41, s30, s42
  s_add_u32 s40, s41, 94208
  s_waitcnt lgkmcnt(0)
  buffer_store_dwordx4 v[220:223], v3, s[20:23], s40 offen sc1
  s_nop 1
  ds_read_b128 v[192:195], v5 offset:16384
  ds_read_b128 v[196:199], v5 offset:17408
  ds_read_b128 v[200:203], v5 offset:18432
  ds_read_b128 v[204:207], v5 offset:19456
  ds_read_b128 v[208:211], v5 offset:20480
  ds_read_b128 v[212:215], v5 offset:21504
  ds_read_b128 v[216:219], v5 offset:22528
  ds_read_b128 v[220:223], v5 offset:23552
  s_cmp_gt_u32 s61, 7
  s_cselect_b32 s41, s30, s42
  s_add_u32 s40, s41, 95232
  s_waitcnt lgkmcnt(7)
  buffer_store_dwordx4 v[192:195], v3, s[20:23], s40 offen sc1
  s_cmp_gt_u32 s61, 8
  s_cselect_b32 s41, s30, s42
  s_add_u32 s40, s41, 96256
  s_waitcnt lgkmcnt(6)
  buffer_store_dwordx4 v[196:199], v3, s[20:23], s40 offen sc1
  s_cmp_gt_u32 s61, 0
  s_cselect_b32 s41, s30, s42
  s_add_u32 s40, s41, 176128
  s_waitcnt lgkmcnt(5)
  buffer_store_dwordx4 v[200:203], v3, s[20:23], s40 offen sc1
  s_cmp_gt_u32 s61, 1
  s_cselect_b32 s41, s30, s42
  s_add_u32 s40, s41, 177152
  s_waitcnt lgkmcnt(4)
  buffer_store_dwordx4 v[204:207], v3, s[20:23], s40 offen sc1
  s_cmp_gt_u32 s61, 2
  s_cselect_b32 s41, s30, s42
  s_add_u32 s40, s41, 178176
  s_waitcnt lgkmcnt(3)
  buffer_store_dwordx4 v[208:211], v3, s[20:23], s40 offen sc1
  s_cmp_gt_u32 s61, 3
  s_cselect_b32 s41, s30, s42
  s_add_u32 s40, s41, 179200
  s_waitcnt lgkmcnt(2)
  buffer_store_dwordx4 v[212:215], v3, s[20:23], s40 offen sc1
  s_cmp_gt_u32 s61, 4
  s_cselect_b32 s41, s30, s42
  s_add_u32 s40, s41, 180224
  s_waitcnt lgkmcnt(1)
  buffer_store_dwordx4 v[216:219], v3, s[20:23], s40 offen sc1
  s_cmp_gt_u32 s61, 5
  s_cselect_b32 s41, s30, s42
  s_add_u32 s40, s41, 181248
  s_waitcnt lgkmcnt(0)
  buffer_store_dwordx4 v[220:223], v3, s[20:23], s40 offen sc1
  s_nop 1
  ds_read_b128 v[192:195], v5 offset:24576
  ds_read_b128 v[196:199], v5 offset:25600
  ds_read_b128 v[200:203], v5 offset:26624
  ds_read_b128 v[204:207], v5 offset:27648
  ds_read_b128 v[208:211], v5 offset:28672
  ds_read_b128 v[212:215], v5 offset:29696
  ds_read_b128 v[216:219], v5 offset:30720
  ds_read_b128 v[220:223], v5 offset:31744
  s_cmp_gt_u32 s61, 6
  s_cselect_b32 s41, s30, s42
  s_add_u32 s40, s41, 182272
  s_waitcnt lgkmcnt(7)
  buffer_store_dwordx4 v[192:195], v3, s[20:23], s40 offen sc1
  s_cmp_gt_u32 s61, 7
  s_cselect_b32 s41, s30, s42
  s_add_u32 s40, s41, 183296
  s_waitcnt lgkmcnt(6)
  buffer_store_dwordx4 v[196:199], v3, s[20:23], s40 offen sc1
  s_cmp_gt_u32 s61, 8
  s_cselect_b32 s41, s30, s42
  s_add_u32 s40, s41, 184320
  s_waitcnt lgkmcnt(5)
  buffer_store_dwordx4 v[200:203], v3, s[20:23], s40 offen sc1
  s_cmp_gt_u32 s61, 0
  s_cselect_b32 s41, s30, s42
  s_add_u32 s40, s41, 264192
  s_waitcnt lgkmcnt(4)
  buffer_store_dwordx4 v[204:207], v3, s[20:23], s40 offen sc1
  s_cmp_gt_u32 s61, 1
  s_cselect_b32 s41, s30, s42
  s_add_u32 s40, s41, 265216
  s_waitcnt lgkmcnt(3)
  buffer_store_dwordx4 v[208:211], v3, s[20:23], s40 offen sc1
  s_cmp_gt_u32 s61, 2
  s_cselect_b32 s41, s30, s42
  s_add_u32 s40, s41, 266240
  s_waitcnt lgkmcnt(2)
  buffer_store_dwordx4 v[212:215], v3, s[20:23], s40 offen sc1
  s_cmp_gt_u32 s61, 3
  s_cselect_b32 s41, s30, s42
  s_add_u32 s40, s41, 267264
  s_waitcnt lgkmcnt(1)
  buffer_store_dwordx4 v[216:219], v3, s[20:23], s40 offen sc1
  s_cmp_gt_u32 s61, 4
  s_cselect_b32 s41, s30, s42
  s_add_u32 s40, s41, 268288
  s_waitcnt lgkmcnt(0)
  buffer_store_dwordx4 v[220:223], v3, s[20:23], s40 offen sc1
  s_nop 1
  ds_read_b128 v[192:195], v5 offset:32768
  ds_read_b128 v[196:199], v5 offset:33792
  ds_read_b128 v[200:203], v5 offset:34816
  ds_read_b128 v[204:207], v5 offset:35840
  s_cmp_gt_u32 s61, 5
  s_cselect_b32 s41, s30, s42
  s_add_u32 s40, s41, 269312
  s_waitcnt lgkmcnt(3)
  buffer_store_dwordx4 v[192:195], v3, s[20:23], s40 offen sc1
  s_cmp_gt_u32 s61, 6
  s_cselect_b32 s41, s30, s42
  s_add_u32 s40, s41, 270336
  s_waitcnt lgkmcnt(2)
  buffer_store_dwordx4 v[196:199], v3, s[20:23], s40 offen sc1
  s_cmp_gt_u32 s61, 7
  s_cselect_b32 s41, s30, s42
  s_add_u32 s40, s41, 271360
  s_waitcnt lgkmcnt(1)
  buffer_store_dwordx4 v[200:203], v3, s[20:23], s40 offen sc1
  s_cmp_gt_u32 s61, 8
  s_cselect_b32 s41, s30, s42
  s_add_u32 s40, s41, 272384
  s_waitcnt lgkmcnt(0)
  buffer_store_dwordx4 v[204:207], v3, s[20:23], s40 offen sc1
  s_nop 1

gated_mix__mha_block__swiglu_ffn__prompt_kernel_g_hdone:
  s_waitcnt vmcnt(0)
  s_lshl_b32 s30, s29, 6
  s_add_u32 s30, s30, 0x1000
  v_mov_b32 v5, s30
  v_mov_b32 v6, s3
  s_mov_b64 exec, 1
  buffer_store_dword v6, v5, s[20:23], 0 offen sc1
  s_mov_b64 exec, -1
gated_mix__mha_block__swiglu_ffn__prompt_kernel_g_nopost:
  s_lshr_b32 s30, s26, 1
  s_lshl_b32 s30, s30, 4
  v_and_b32 v5, 15, v0
  v_add_u32 v5, s30, v5
  v_lshlrev_b32 v5, 6, v5
  v_add_u32 v5, 0x1000, v5

  s_mov_b32 s87, 0
gated_mix__mha_block__swiglu_ffn__prompt_kernel_pollH:
  buffer_load_dword v6, v5, s[20:23], 0 offen sc1
  s_waitcnt vmcnt(0)
  v_cmp_eq_u32 vcc, s3, v6
  s_cmp_eq_u64 vcc, exec
  s_cbranch_scc1 gated_mix__mha_block__swiglu_ffn__prompt_kernel_pollH_ok
  s_add_u32 s87, s87, 1
  s_cmp_lt_u32 s87, 65536
  s_cbranch_scc0 gated_mix__mha_block__swiglu_ffn__prompt_kernel_pollH_ok
  s_sleep 32
  s_branch gated_mix__mha_block__swiglu_ffn__prompt_kernel_pollH
gated_mix__mha_block__swiglu_ffn__prompt_kernel_pollH_ok:

  v_and_b32 v5, 31, v0
  v_lshlrev_b32 v5, 2, v5
  s_lshl_b32 s39, s26, 8
  s_add_u32 s39, s39, 0x10000
  buffer_load_dword v8, v5, s[20:23], s39 offen sc1
  buffer_load_dword v9, v5, s[20:23], s39 offen offset:128 sc1
  s_cmp_gt_u32 s34, 0
  s_cselect_b32 s41, s36, s42
  s_add_u32 s43, s41, s37
  buffer_load_dwordx4 v[192:195], v3, s[20:23], s41 offen sc1
  buffer_load_dwordx4 v[196:199], v3, s[20:23], s43 offen sc1
  s_add_u32 s36, s36, 1024
  s_cmp_gt_u32 s34, 1
  s_cselect_b32 s41, s36, s42
  s_add_u32 s43, s41, s37
  buffer_load_dwordx4 v[200:203], v3, s[20:23], s41 offen sc1
  buffer_load_dwordx4 v[204:207], v3, s[20:23], s43 offen sc1
  s_add_u32 s36, s36, 1024
  s_cmp_gt_u32 s34, 2
  s_cselect_b32 s41, s36, s42
  s_add_u32 s43, s41, s37
  buffer_load_dwordx4 v[208:211], v3, s[20:23], s41 offen sc1
  buffer_load_dwordx4 v[212:215], v3, s[20:23], s43 offen sc1
  s_add_u32 s36, s36, 1024
  s_cmp_gt_u32 s34, 3
  s_cselect_b32 s41, s36, s42
  s_add_u32 s43, s41, s37
  buffer_load_dwordx4 v[216:219], v3, s[20:23], s41 offen sc1
  buffer_load_dwordx4 v[220:223], v3, s[20:23], s43 offen sc1
  s_add_u32 s36, s36, 1024
  s_cmp_gt_u32 s34, 4
  s_cselect_b32 s41, s36, s42
  s_add_u32 s43, s41, s37
  buffer_load_dwordx4 v[224:227], v3, s[20:23], s41 offen sc1
  buffer_load_dwordx4 v[228:231], v3, s[20:23], s43 offen sc1
  s_add_u32 s36, s36, 1024
  s_cmp_gt_u32 s34, 5
  s_cselect_b32 s41, s36, s42
  s_add_u32 s43, s41, s37
  buffer_load_dwordx4 v[232:235], v3, s[20:23], s41 offen sc1
  buffer_load_dwordx4 v[236:239], v3, s[20:23], s43 offen sc1
  s_add_u32 s36, s36, 1024
  s_cmp_gt_u32 s34, 6
  s_cselect_b32 s41, s36, s42
  s_add_u32 s43, s41, s37
  buffer_load_dwordx4 v[240:243], v3, s[20:23], s41 offen sc1
  buffer_load_dwordx4 v[244:247], v3, s[20:23], s43 offen sc1
  s_add_u32 s36, s36, 1024
  s_cmp_gt_u32 s34, 7
  s_cselect_b32 s41, s36, s42
  s_add_u32 s43, s41, s37
  buffer_load_dwordx4 v[248:251], v3, s[20:23], s41 offen sc1
  buffer_load_dwordx4 v[252:255], v3, s[20:23], s43 offen sc1
  s_add_u32 s36, s36, 1024
  s_setprio 0
  s_waitcnt vmcnt(25)
  ds_read_b64_tr_b16 v[16:17], v4 offset:0
  ds_read_b64_tr_b16 v[18:19], v4 offset:1024
  ds_read_b64_tr_b16 v[20:21], v7 offset:0
  ds_read_b64_tr_b16 v[22:23], v7 offset:1024
  s_waitcnt vmcnt(14)
  ds_read_b64_tr_b16 v[24:25], v4 offset:2048
  ds_read_b64_tr_b16 v[26:27], v4 offset:3072
  ds_read_b64_tr_b16 v[28:29], v7 offset:2048
  ds_read_b64_tr_b16 v[30:31], v7 offset:3072
  s_waitcnt lgkmcnt(4)
  v_mfma_f32_32x32x16_bf16 v[64:79], v[16:19], v[192:195], 0
  v_mfma_f32_32x32x16_bf16 v[80:95], v[16:19], v[196:199], 0
  v_mfma_f32_32x32x16_bf16 v[96:111], v[20:23], v[192:195], 0
  v_mfma_f32_32x32x16_bf16 v[112:127], v[20:23], v[196:199], 0
  s_cmp_gt_u32 s34, 8
  s_cselect_b32 s40, s35, s42
  s_add_u32 m0, s38, 0
  s_add_u32 s44, s40, 8192
  buffer_load_dwordx4 v2, s[12:15], s40 offen lds
  s_add_u32 m0, s38, 1024
  s_add_u32 s35, s35, 16384
  buffer_load_dwordx4 v2, s[12:15], s44 offen lds
  s_cmp_gt_u32 s34, 8
  s_cselect_b32 s41, s36, s42
  s_add_u32 s43, s41, s37
  buffer_load_dwordx4 v[192:195], v3, s[20:23], s41 offen sc1
  buffer_load_dwordx4 v[196:199], v3, s[20:23], s43 offen sc1
  s_add_u32 s36, s36, 1024
  s_waitcnt vmcnt(16)
  ds_read_b64_tr_b16 v[16:17], v4 offset:4096
  ds_read_b64_tr_b16 v[18:19], v4 offset:5120
  ds_read_b64_tr_b16 v[20:21], v7 offset:4096
  ds_read_b64_tr_b16 v[22:23], v7 offset:5120
  s_waitcnt lgkmcnt(4)
  v_mfma_f32_32x32x16_bf16 v[64:79], v[24:27], v[200:203], v[64:79]
  v_mfma_f32_32x32x16_bf16 v[80:95], v[24:27], v[204:207], v[80:95]
  v_mfma_f32_32x32x16_bf16 v[96:111], v[28:31], v[200:203], v[96:111]
  v_mfma_f32_32x32x16_bf16 v[112:127], v[28:31], v[204:207], v[112:127]
  s_cmp_gt_u32 s34, 9
  s_cselect_b32 s40, s35, s42
  s_add_u32 m0, s38, 2048
  s_add_u32 s44, s40, 8192
  buffer_load_dwordx4 v2, s[12:15], s40 offen lds
  s_add_u32 m0, s38, 3072
  s_add_u32 s35, s35, 16384
  buffer_load_dwordx4 v2, s[12:15], s44 offen lds
  s_cmp_gt_u32 s34, 9
  s_cselect_b32 s41, s36, s42
  s_add_u32 s43, s41, s37
  buffer_load_dwordx4 v[200:203], v3, s[20:23], s41 offen sc1
  buffer_load_dwordx4 v[204:207], v3, s[20:23], s43 offen sc1
  s_add_u32 s36, s36, 1024
  s_waitcnt vmcnt(18)
  ds_read_b64_tr_b16 v[24:25], v4 offset:6144
  ds_read_b64_tr_b16 v[26:27], v4 offset:7168
  ds_read_b64_tr_b16 v[28:29], v7 offset:6144
  ds_read_b64_tr_b16 v[30:31], v7 offset:7168
  s_waitcnt lgkmcnt(4)
  v_mfma_f32_32x32x16_bf16 v[64:79], v[16:19], v[208:211], v[64:79]
  v_mfma_f32_32x32x16_bf16 v[80:95], v[16:19], v[212:215], v[80:95]
  v_mfma_f32_32x32x16_bf16 v[96:111], v[20:23], v[208:211], v[96:111]
  v_mfma_f32_32x32x16_bf16 v[112:127], v[20:23], v[212:215], v[112:127]
  s_cmp_gt_u32 s34, 10
  s_cselect_b32 s40, s35, s42
  s_add_u32 m0, s38, 4096
  s_add_u32 s44, s40, 8192
  buffer_load_dwordx4 v2, s[12:15], s40 offen lds
  s_add_u32 m0, s38, 5120
  s_add_u32 s35, s35, 16384
  buffer_load_dwordx4 v2, s[12:15], s44 offen lds
  s_cmp_gt_u32 s34, 10
  s_cselect_b32 s41, s36, s42
  s_add_u32 s43, s41, s37
  buffer_load_dwordx4 v[208:211], v3, s[20:23], s41 offen sc1
  buffer_load_dwordx4 v[212:215], v3, s[20:23], s43 offen sc1
  s_add_u32 s36, s36, 1024
  s_waitcnt vmcnt(20)
  ds_read_b64_tr_b16 v[16:17], v4 offset:8192
  ds_read_b64_tr_b16 v[18:19], v4 offset:9216
  ds_read_b64_tr_b16 v[20:21], v7 offset:8192
  ds_read_b64_tr_b16 v[22:23], v7 offset:9216
  s_waitcnt lgkmcnt(4)
  v_mfma_f32_32x32x16_bf16 v[64:79], v[24:27], v[216:219], v[64:79]
  v_mfma_f32_32x32x16_bf16 v[80:95], v[24:27], v[220:223], v[80:95]
  v_mfma_f32_32x32x16_bf16 v[96:111], v[28:31], v[216:219], v[96:111]
  v_mfma_f32_32x32x16_bf16 v[112:127], v[28:31], v[220:223], v[112:127]
  s_cmp_gt_u32 s34, 11
  s_cselect_b32 s40, s35, s42
  s_add_u32 m0, s38, 6144
  s_add_u32 s44, s40, 8192
  buffer_load_dwordx4 v2, s[12:15], s40 offen lds
  s_add_u32 m0, s38, 7168
  s_add_u32 s35, s35, 16384
  buffer_load_dwordx4 v2, s[12:15], s44 offen lds
  s_cmp_gt_u32 s34, 11
  s_cselect_b32 s41, s36, s42
  s_add_u32 s43, s41, s37
  buffer_load_dwordx4 v[216:219], v3, s[20:23], s41 offen sc1
  buffer_load_dwordx4 v[220:223], v3, s[20:23], s43 offen sc1
  s_add_u32 s36, s36, 1024
  s_waitcnt vmcnt(22)
  ds_read_b64_tr_b16 v[24:25], v4 offset:10240
  ds_read_b64_tr_b16 v[26:27], v4 offset:11264
  ds_read_b64_tr_b16 v[28:29], v7 offset:10240
  ds_read_b64_tr_b16 v[30:31], v7 offset:11264
  s_waitcnt lgkmcnt(4)
  v_mfma_f32_32x32x16_bf16 v[64:79], v[16:19], v[224:227], v[64:79]
  v_mfma_f32_32x32x16_bf16 v[80:95], v[16:19], v[228:231], v[80:95]
  v_mfma_f32_32x32x16_bf16 v[96:111], v[20:23], v[224:227], v[96:111]
  v_mfma_f32_32x32x16_bf16 v[112:127], v[20:23], v[228:231], v[112:127]
  s_cmp_gt_u32 s34, 12
  s_cselect_b32 s40, s35, s42
  s_add_u32 m0, s38, 8192
  s_add_u32 s44, s40, 8192
  buffer_load_dwordx4 v2, s[12:15], s40 offen lds
  s_add_u32 m0, s38, 9216
  s_add_u32 s35, s35, 16384
  buffer_load_dwordx4 v2, s[12:15], s44 offen lds
  s_cmp_gt_u32 s34, 12
  s_cselect_b32 s41, s36, s42
  s_add_u32 s43, s41, s37
  buffer_load_dwordx4 v[224:227], v3, s[20:23], s41 offen sc1
  buffer_load_dwordx4 v[228:231], v3, s[20:23], s43 offen sc1
  s_add_u32 s36, s36, 1024
  s_waitcnt vmcnt(24)
  ds_read_b64_tr_b16 v[16:17], v4 offset:12288
  ds_read_b64_tr_b16 v[18:19], v4 offset:13312
  ds_read_b64_tr_b16 v[20:21], v7 offset:12288
  ds_read_b64_tr_b16 v[22:23], v7 offset:13312
  s_waitcnt lgkmcnt(4)
  v_mfma_f32_32x32x16_bf16 v[64:79], v[24:27], v[232:235], v[64:79]
  v_mfma_f32_32x32x16_bf16 v[80:95], v[24:27], v[236:239], v[80:95]
  v_mfma_f32_32x32x16_bf16 v[96:111], v[28:31], v[232:235], v[96:111]
  v_mfma_f32_32x32x16_bf16 v[112:127], v[28:31], v[236:239], v[112:127]
  s_cmp_gt_u32 s34, 13
  s_cselect_b32 s40, s35, s42
  s_add_u32 m0, s38, 10240
  s_add_u32 s44, s40, 8192
  buffer_load_dwordx4 v2, s[12:15], s40 offen lds
  s_add_u32 m0, s38, 11264
  s_add_u32 s35, s35, 16384
  buffer_load_dwordx4 v2, s[12:15], s44 offen lds
  s_cmp_gt_u32 s34, 13
  s_cselect_b32 s41, s36, s42
  s_add_u32 s43, s41, s37
  buffer_load_dwordx4 v[232:235], v3, s[20:23], s41 offen sc1
  buffer_load_dwordx4 v[236:239], v3, s[20:23], s43 offen sc1
  s_add_u32 s36, s36, 1024
  s_waitcnt vmcnt(26)
  ds_read_b64_tr_b16 v[24:25], v4 offset:14336
  ds_read_b64_tr_b16 v[26:27], v4 offset:15360
  ds_read_b64_tr_b16 v[28:29], v7 offset:14336
  ds_read_b64_tr_b16 v[30:31], v7 offset:15360
  s_waitcnt lgkmcnt(4)
  v_mfma_f32_32x32x16_bf16 v[64:79], v[16:19], v[240:243], v[64:79]
  v_mfma_f32_32x32x16_bf16 v[80:95], v[16:19], v[244:247], v[80:95]
  v_mfma_f32_32x32x16_bf16 v[96:111], v[20:23], v[240:243], v[96:111]
  v_mfma_f32_32x32x16_bf16 v[112:127], v[20:23], v[244:247], v[112:127]
  s_cmp_gt_u32 s34, 14
  s_cselect_b32 s40, s35, s42
  s_add_u32 m0, s38, 12288
  s_add_u32 s44, s40, 8192
  buffer_load_dwordx4 v2, s[12:15], s40 offen lds
  s_add_u32 m0, s38, 13312
  s_add_u32 s35, s35, 16384
  buffer_load_dwordx4 v2, s[12:15], s44 offen lds
  s_cmp_gt_u32 s34, 14
  s_cselect_b32 s41, s36, s42
  s_add_u32 s43, s41, s37
  buffer_load_dwordx4 v[240:243], v3, s[20:23], s41 offen sc1
  buffer_load_dwordx4 v[244:247], v3, s[20:23], s43 offen sc1
  s_add_u32 s36, s36, 1024
  s_waitcnt vmcnt(26)
  ds_read_b64_tr_b16 v[16:17], v4 offset:0
  ds_read_b64_tr_b16 v[18:19], v4 offset:1024
  ds_read_b64_tr_b16 v[20:21], v7 offset:0
  ds_read_b64_tr_b16 v[22:23], v7 offset:1024
  s_waitcnt lgkmcnt(4)
  v_mfma_f32_32x32x16_bf16 v[64:79], v[24:27], v[248:251], v[64:79]
  v_mfma_f32_32x32x16_bf16 v[80:95], v[24:27], v[252:255], v[80:95]
  v_mfma_f32_32x32x16_bf16 v[96:111], v[28:31], v[248:251], v[96:111]
  v_mfma_f32_32x32x16_bf16 v[112:127], v[28:31], v[252:255], v[112:127]
  s_cmp_gt_u32 s34, 15
  s_cselect_b32 s40, s35, s42
  s_add_u32 m0, s38, 14336
  s_add_u32 s44, s40, 8192
  buffer_load_dwordx4 v2, s[12:15], s40 offen lds
  s_add_u32 m0, s38, 15360
  s_add_u32 s35, s35, 16384
  buffer_load_dwordx4 v2, s[12:15], s44 offen lds
  s_cmp_gt_u32 s34, 15
  s_cselect_b32 s41, s36, s42
  s_add_u32 s43, s41, s37
  buffer_load_dwordx4 v[248:251], v3, s[20:23], s41 offen sc1
  buffer_load_dwordx4 v[252:255], v3, s[20:23], s43 offen sc1
  s_add_u32 s36, s36, 1024
  s_waitcnt vmcnt(26)
  ds_read_b64_tr_b16 v[24:25], v4 offset:2048
  ds_read_b64_tr_b16 v[26:27], v4 offset:3072
  ds_read_b64_tr_b16 v[28:29], v7 offset:2048
  ds_read_b64_tr_b16 v[30:31], v7 offset:3072
  s_waitcnt lgkmcnt(4)
  v_mfma_f32_32x32x16_bf16 v[64:79], v[16:19], v[192:195], v[64:79]
  v_mfma_f32_32x32x16_bf16 v[80:95], v[16:19], v[196:199], v[80:95]
  v_mfma_f32_32x32x16_bf16 v[96:111], v[20:23], v[192:195], v[96:111]
  v_mfma_f32_32x32x16_bf16 v[112:127], v[20:23], v[196:199], v[112:127]
  s_cmp_gt_u32 s34, 16
  s_cselect_b32 s40, s35, s42
  s_add_u32 m0, s38, 0
  s_add_u32 s44, s40, 8192
  buffer_load_dwordx4 v2, s[12:15], s40 offen lds
  s_add_u32 m0, s38, 1024
  s_add_u32 s35, s35, 16384
  buffer_load_dwordx4 v2, s[12:15], s44 offen lds
  s_cmp_gt_u32 s34, 16
  s_cselect_b32 s41, s36, s42
  s_add_u32 s43, s41, s37
  buffer_load_dwordx4 v[192:195], v3, s[20:23], s41 offen sc1
  buffer_load_dwordx4 v[196:199], v3, s[20:23], s43 offen sc1
  s_add_u32 s36, s36, 1024
  s_waitcnt vmcnt(26)
  ds_read_b64_tr_b16 v[16:17], v4 offset:4096
  ds_read_b64_tr_b16 v[18:19], v4 offset:5120
  ds_read_b64_tr_b16 v[20:21], v7 offset:4096
  ds_read_b64_tr_b16 v[22:23], v7 offset:5120
  s_waitcnt lgkmcnt(4)
  v_mfma_f32_32x32x16_bf16 v[64:79], v[24:27], v[200:203], v[64:79]
  v_mfma_f32_32x32x16_bf16 v[80:95], v[24:27], v[204:207], v[80:95]
  v_mfma_f32_32x32x16_bf16 v[96:111], v[28:31], v[200:203], v[96:111]
  v_mfma_f32_32x32x16_bf16 v[112:127], v[28:31], v[204:207], v[112:127]
  s_cmp_gt_u32 s34, 17
  s_cselect_b32 s40, s35, s42
  s_add_u32 m0, s38, 2048
  s_add_u32 s44, s40, 8192
  buffer_load_dwordx4 v2, s[12:15], s40 offen lds
  s_add_u32 m0, s38, 3072
  s_add_u32 s35, s35, 16384
  buffer_load_dwordx4 v2, s[12:15], s44 offen lds
  s_cmp_gt_u32 s34, 17
  s_cselect_b32 s41, s36, s42
  s_add_u32 s43, s41, s37
  buffer_load_dwordx4 v[200:203], v3, s[20:23], s41 offen sc1
  buffer_load_dwordx4 v[204:207], v3, s[20:23], s43 offen sc1
  s_add_u32 s36, s36, 1024
  s_waitcnt vmcnt(26)
  ds_read_b64_tr_b16 v[24:25], v4 offset:6144
  ds_read_b64_tr_b16 v[26:27], v4 offset:7168
  ds_read_b64_tr_b16 v[28:29], v7 offset:6144
  ds_read_b64_tr_b16 v[30:31], v7 offset:7168
  s_waitcnt lgkmcnt(4)
  v_mfma_f32_32x32x16_bf16 v[64:79], v[16:19], v[208:211], v[64:79]
  v_mfma_f32_32x32x16_bf16 v[80:95], v[16:19], v[212:215], v[80:95]
  v_mfma_f32_32x32x16_bf16 v[96:111], v[20:23], v[208:211], v[96:111]
  v_mfma_f32_32x32x16_bf16 v[112:127], v[20:23], v[212:215], v[112:127]
  s_cmp_gt_u32 s34, 18
  s_cselect_b32 s40, s35, s42
  s_add_u32 m0, s38, 4096
  s_add_u32 s44, s40, 8192
  buffer_load_dwordx4 v2, s[12:15], s40 offen lds
  s_add_u32 m0, s38, 5120
  s_add_u32 s35, s35, 16384
  buffer_load_dwordx4 v2, s[12:15], s44 offen lds
  s_cmp_gt_u32 s34, 18
  s_cselect_b32 s41, s36, s42
  s_add_u32 s43, s41, s37
  buffer_load_dwordx4 v[208:211], v3, s[20:23], s41 offen sc1
  buffer_load_dwordx4 v[212:215], v3, s[20:23], s43 offen sc1
  s_add_u32 s36, s36, 1024
  s_waitcnt vmcnt(26)
  ds_read_b64_tr_b16 v[16:17], v4 offset:8192
  ds_read_b64_tr_b16 v[18:19], v4 offset:9216
  ds_read_b64_tr_b16 v[20:21], v7 offset:8192
  ds_read_b64_tr_b16 v[22:23], v7 offset:9216
  s_waitcnt lgkmcnt(4)
  v_mfma_f32_32x32x16_bf16 v[64:79], v[24:27], v[216:219], v[64:79]
  v_mfma_f32_32x32x16_bf16 v[80:95], v[24:27], v[220:223], v[80:95]
  v_mfma_f32_32x32x16_bf16 v[96:111], v[28:31], v[216:219], v[96:111]
  v_mfma_f32_32x32x16_bf16 v[112:127], v[28:31], v[220:223], v[112:127]
  s_cmp_gt_u32 s34, 19
  s_cselect_b32 s40, s35, s42
  s_add_u32 m0, s38, 6144
  s_add_u32 s44, s40, 8192
  buffer_load_dwordx4 v2, s[12:15], s40 offen lds
  s_add_u32 m0, s38, 7168
  s_add_u32 s35, s35, 16384
  buffer_load_dwordx4 v2, s[12:15], s44 offen lds
  s_cmp_gt_u32 s34, 19
  s_cselect_b32 s41, s36, s42
  s_add_u32 s43, s41, s37
  buffer_load_dwordx4 v[216:219], v3, s[20:23], s41 offen sc1
  buffer_load_dwordx4 v[220:223], v3, s[20:23], s43 offen sc1
  s_add_u32 s36, s36, 1024
  s_waitcnt vmcnt(26)
  ds_read_b64_tr_b16 v[24:25], v4 offset:10240
  ds_read_b64_tr_b16 v[26:27], v4 offset:11264
  ds_read_b64_tr_b16 v[28:29], v7 offset:10240
  ds_read_b64_tr_b16 v[30:31], v7 offset:11264
  s_waitcnt lgkmcnt(4)
  v_mfma_f32_32x32x16_bf16 v[64:79], v[16:19], v[224:227], v[64:79]
  v_mfma_f32_32x32x16_bf16 v[80:95], v[16:19], v[228:231], v[80:95]
  v_mfma_f32_32x32x16_bf16 v[96:111], v[20:23], v[224:227], v[96:111]
  v_mfma_f32_32x32x16_bf16 v[112:127], v[20:23], v[228:231], v[112:127]
  s_cmp_gt_u32 s34, 20
  s_cselect_b32 s40, s35, s42
  s_add_u32 m0, s38, 8192
  s_add_u32 s44, s40, 8192
  buffer_load_dwordx4 v2, s[12:15], s40 offen lds
  s_add_u32 m0, s38, 9216
  s_add_u32 s35, s35, 16384
  buffer_load_dwordx4 v2, s[12:15], s44 offen lds
  s_cmp_gt_u32 s34, 20
  s_cselect_b32 s41, s36, s42
  s_add_u32 s43, s41, s37
  buffer_load_dwordx4 v[224:227], v3, s[20:23], s41 offen sc1
  buffer_load_dwordx4 v[228:231], v3, s[20:23], s43 offen sc1
  s_add_u32 s36, s36, 1024
  s_waitcnt vmcnt(26)
  ds_read_b64_tr_b16 v[16:17], v4 offset:12288
  ds_read_b64_tr_b16 v[18:19], v4 offset:13312
  ds_read_b64_tr_b16 v[20:21], v7 offset:12288
  ds_read_b64_tr_b16 v[22:23], v7 offset:13312
  s_waitcnt lgkmcnt(4)
  v_mfma_f32_32x32x16_bf16 v[64:79], v[24:27], v[232:235], v[64:79]
  v_mfma_f32_32x32x16_bf16 v[80:95], v[24:27], v[236:239], v[80:95]
  v_mfma_f32_32x32x16_bf16 v[96:111], v[28:31], v[232:235], v[96:111]
  v_mfma_f32_32x32x16_bf16 v[112:127], v[28:31], v[236:239], v[112:127]
  s_cmp_gt_u32 s34, 21
  s_cselect_b32 s40, s35, s42
  s_add_u32 m0, s38, 10240
  s_add_u32 s44, s40, 8192
  buffer_load_dwordx4 v2, s[12:15], s40 offen lds
  s_add_u32 m0, s38, 11264
  s_add_u32 s35, s35, 16384
  buffer_load_dwordx4 v2, s[12:15], s44 offen lds
  s_cmp_gt_u32 s34, 21
  s_cselect_b32 s41, s36, s42
  s_add_u32 s43, s41, s37
  buffer_load_dwordx4 v[232:235], v3, s[20:23], s41 offen sc1
  buffer_load_dwordx4 v[236:239], v3, s[20:23], s43 offen sc1
  s_add_u32 s36, s36, 1024
  s_waitcnt vmcnt(26)
  ds_read_b64_tr_b16 v[24:25], v4 offset:14336
  ds_read_b64_tr_b16 v[26:27], v4 offset:15360
  ds_read_b64_tr_b16 v[28:29], v7 offset:14336
  ds_read_b64_tr_b16 v[30:31], v7 offset:15360
  s_waitcnt lgkmcnt(4)
  v_mfma_f32_32x32x16_bf16 v[64:79], v[16:19], v[240:243], v[64:79]
  v_mfma_f32_32x32x16_bf16 v[80:95], v[16:19], v[244:247], v[80:95]
  v_mfma_f32_32x32x16_bf16 v[96:111], v[20:23], v[240:243], v[96:111]
  v_mfma_f32_32x32x16_bf16 v[112:127], v[20:23], v[244:247], v[112:127]
  s_waitcnt vmcnt(22)
  ds_read_b64_tr_b16 v[16:17], v4 offset:0
  ds_read_b64_tr_b16 v[18:19], v4 offset:1024
  ds_read_b64_tr_b16 v[20:21], v7 offset:0
  ds_read_b64_tr_b16 v[22:23], v7 offset:1024
  s_waitcnt lgkmcnt(4)
  v_mfma_f32_32x32x16_bf16 v[64:79], v[24:27], v[248:251], v[64:79]
  v_mfma_f32_32x32x16_bf16 v[80:95], v[24:27], v[252:255], v[80:95]
  v_mfma_f32_32x32x16_bf16 v[96:111], v[28:31], v[248:251], v[96:111]
  v_mfma_f32_32x32x16_bf16 v[112:127], v[28:31], v[252:255], v[112:127]
  s_waitcnt vmcnt(18)
  ds_read_b64_tr_b16 v[24:25], v4 offset:2048
  ds_read_b64_tr_b16 v[26:27], v4 offset:3072
  ds_read_b64_tr_b16 v[28:29], v7 offset:2048
  ds_read_b64_tr_b16 v[30:31], v7 offset:3072
  s_waitcnt lgkmcnt(4)
  v_mfma_f32_32x32x16_bf16 v[64:79], v[16:19], v[192:195], v[64:79]
  v_mfma_f32_32x32x16_bf16 v[80:95], v[16:19], v[196:199], v[80:95]
  v_mfma_f32_32x32x16_bf16 v[96:111], v[20:23], v[192:195], v[96:111]
  v_mfma_f32_32x32x16_bf16 v[112:127], v[20:23], v[196:199], v[112:127]
  s_waitcnt vmcnt(14)
  ds_read_b64_tr_b16 v[16:17], v4 offset:4096
  ds_read_b64_tr_b16 v[18:19], v4 offset:5120
  ds_read_b64_tr_b16 v[20:21], v7 offset:4096
  ds_read_b64_tr_b16 v[22:23], v7 offset:5120
  s_waitcnt lgkmcnt(4)
  v_mfma_f32_32x32x16_bf16 v[64:79], v[24:27], v[200:203], v[64:79]
  v_mfma_f32_32x32x16_bf16 v[80:95], v[24:27], v[204:207], v[80:95]
  v_mfma_f32_32x32x16_bf16 v[96:111], v[28:31], v[200:203], v[96:111]
  v_mfma_f32_32x32x16_bf16 v[112:127], v[28:31], v[204:207], v[112:127]
  s_waitcnt vmcnt(10)
  ds_read_b64_tr_b16 v[24:25], v4 offset:6144
  ds_read_b64_tr_b16 v[26:27], v4 offset:7168
  ds_read_b64_tr_b16 v[28:29], v7 offset:6144
  ds_read_b64_tr_b16 v[30:31], v7 offset:7168
  s_waitcnt lgkmcnt(4)
  v_mfma_f32_32x32x16_bf16 v[64:79], v[16:19], v[208:211], v[64:79]
  v_mfma_f32_32x32x16_bf16 v[80:95], v[16:19], v[212:215], v[80:95]
  v_mfma_f32_32x32x16_bf16 v[96:111], v[20:23], v[208:211], v[96:111]
  v_mfma_f32_32x32x16_bf16 v[112:127], v[20:23], v[212:215], v[112:127]
  s_waitcnt vmcnt(6)
  ds_read_b64_tr_b16 v[16:17], v4 offset:8192
  ds_read_b64_tr_b16 v[18:19], v4 offset:9216
  ds_read_b64_tr_b16 v[20:21], v7 offset:8192
  ds_read_b64_tr_b16 v[22:23], v7 offset:9216
  s_waitcnt lgkmcnt(4)
  v_mfma_f32_32x32x16_bf16 v[64:79], v[24:27], v[216:219], v[64:79]
  v_mfma_f32_32x32x16_bf16 v[80:95], v[24:27], v[220:223], v[80:95]
  v_mfma_f32_32x32x16_bf16 v[96:111], v[28:31], v[216:219], v[96:111]
  v_mfma_f32_32x32x16_bf16 v[112:127], v[28:31], v[220:223], v[112:127]
  s_waitcnt vmcnt(2)
  ds_read_b64_tr_b16 v[24:25], v4 offset:10240
  ds_read_b64_tr_b16 v[26:27], v4 offset:11264
  ds_read_b64_tr_b16 v[28:29], v7 offset:10240
  ds_read_b64_tr_b16 v[30:31], v7 offset:11264
  s_waitcnt lgkmcnt(4)
  v_mfma_f32_32x32x16_bf16 v[64:79], v[16:19], v[224:227], v[64:79]
  v_mfma_f32_32x32x16_bf16 v[80:95], v[16:19], v[228:231], v[80:95]
  v_mfma_f32_32x32x16_bf16 v[96:111], v[20:23], v[224:227], v[96:111]
  v_mfma_f32_32x32x16_bf16 v[112:127], v[20:23], v[228:231], v[112:127]
  s_waitcnt vmcnt(0)
  s_waitcnt lgkmcnt(0)
  v_mfma_f32_32x32x16_bf16 v[64:79], v[24:27], v[232:235], v[64:79]
  v_mfma_f32_32x32x16_bf16 v[80:95], v[24:27], v[236:239], v[80:95]
  v_mfma_f32_32x32x16_bf16 v[96:111], v[28:31], v[232:235], v[96:111]
  v_mfma_f32_32x32x16_bf16 v[112:127], v[28:31], v[236:239], v[112:127]
  s_setprio 2
  s_nop 7
  v_sub_f32 v12, 1.0, v8
  v_sub_f32 v13, 1.0, v8
  v_sub_f32 v14, 1.0, v9
  v_sub_f32 v15, 1.0, v9
  s_nop 5
  v_pk_mul_f32 v[64:65], v[64:65], v[12:13]
  v_pk_mul_f32 v[66:67], v[66:67], v[12:13]
  v_pk_mul_f32 v[68:69], v[68:69], v[12:13]
  v_pk_mul_f32 v[70:71], v[70:71], v[12:13]
  v_pk_mul_f32 v[72:73], v[72:73], v[12:13]
  v_pk_mul_f32 v[74:75], v[74:75], v[12:13]
  v_pk_mul_f32 v[76:77], v[76:77], v[12:13]
  v_pk_mul_f32 v[78:79], v[78:79], v[12:13]
  v_pk_mul_f32 v[80:81], v[80:81], v[14:15]
  v_pk_mul_f32 v[82:83], v[82:83], v[14:15]
  v_pk_mul_f32 v[84:85], v[84:85], v[14:15]
  v_pk_mul_f32 v[86:87], v[86:87], v[14:15]
  v_pk_mul_f32 v[88:89], v[88:89], v[14:15]
  v_pk_mul_f32 v[90:91], v[90:91], v[14:15]
  v_pk_mul_f32 v[92:93], v[92:93], v[14:15]
  v_pk_mul_f32 v[94:95], v[94:95], v[14:15]
  v_pk_mul_f32 v[96:97], v[96:97], v[12:13]
  v_pk_mul_f32 v[98:99], v[98:99], v[12:13]
  v_pk_mul_f32 v[100:101], v[100:101], v[12:13]
  v_pk_mul_f32 v[102:103], v[102:103], v[12:13]
  v_pk_mul_f32 v[104:105], v[104:105], v[12:13]
  v_pk_mul_f32 v[106:107], v[106:107], v[12:13]
  v_pk_mul_f32 v[108:109], v[108:109], v[12:13]
  v_pk_mul_f32 v[110:111], v[110:111], v[12:13]
  v_pk_mul_f32 v[112:113], v[112:113], v[14:15]
  v_pk_mul_f32 v[114:115], v[114:115], v[14:15]
  v_pk_mul_f32 v[116:117], v[116:117], v[14:15]
  v_pk_mul_f32 v[118:119], v[118:119], v[14:15]
  v_pk_mul_f32 v[120:121], v[120:121], v[14:15]
  v_pk_mul_f32 v[122:123], v[122:123], v[14:15]
  v_pk_mul_f32 v[124:125], v[124:125], v[14:15]
  v_pk_mul_f32 v[126:127], v[126:127], v[14:15]
  s_or_b32 s30, s2, 0
  s_cmp_lg_u32 s30, 0
  s_cbranch_scc1 gated_mix__mha_block__swiglu_ffn__prompt_kernel_g_noepoch
  s_cmp_lg_u32 s24, 3
  s_cbranch_scc1 gated_mix__mha_block__swiglu_ffn__prompt_kernel_g_noepoch
  v_lshlrev_b32 v5, 6, v0
  v_add_u32 v5, 0x1000, v5

  s_mov_b32 s87, 0
gated_mix__mha_block__swiglu_ffn__prompt_kernel_pollE0:
  buffer_load_dword v6, v5, s[20:23], 0 offen sc1
  s_waitcnt vmcnt(0)
  v_cmp_eq_u32 vcc, s3, v6
  s_cmp_eq_u64 vcc, exec
  s_cbranch_scc1 gated_mix__mha_block__swiglu_ffn__prompt_kernel_pollE0_ok
  s_add_u32 s87, s87, 1
  s_cmp_lt_u32 s87, 65536
  s_cbranch_scc0 gated_mix__mha_block__swiglu_ffn__prompt_kernel_pollE0_ok
  s_sleep 2
  s_branch gated_mix__mha_block__swiglu_ffn__prompt_kernel_pollE0
gated_mix__mha_block__swiglu_ffn__prompt_kernel_pollE0_ok:
  v_lshlrev_b32 v5, 6, v0
  v_add_u32 v5, 0x2000, v5

  s_mov_b32 s87, 0
gated_mix__mha_block__swiglu_ffn__prompt_kernel_pollE1:
  buffer_load_dword v6, v5, s[20:23], 0 offen sc1
  s_waitcnt vmcnt(0)
  v_cmp_eq_u32 vcc, s3, v6
  s_cmp_eq_u64 vcc, exec
  s_cbranch_scc1 gated_mix__mha_block__swiglu_ffn__prompt_kernel_pollE1_ok
  s_add_u32 s87, s87, 1
  s_cmp_lt_u32 s87, 65536
  s_cbranch_scc0 gated_mix__mha_block__swiglu_ffn__prompt_kernel_pollE1_ok
  s_sleep 2
  s_branch gated_mix__mha_block__swiglu_ffn__prompt_kernel_pollE1
gated_mix__mha_block__swiglu_ffn__prompt_kernel_pollE1_ok:
  v_lshlrev_b32 v5, 6, v0
  v_add_u32 v5, 0x3000, v5

  s_mov_b32 s87, 0
gated_mix__mha_block__swiglu_ffn__prompt_kernel_pollE2:
  buffer_load_dword v6, v5, s[20:23], 0 offen sc1
  s_waitcnt vmcnt(0)
  v_cmp_eq_u32 vcc, s3, v6
  s_cmp_eq_u64 vcc, exec
  s_cbranch_scc1 gated_mix__mha_block__swiglu_ffn__prompt_kernel_pollE2_ok
  s_add_u32 s87, s87, 1
  s_cmp_lt_u32 s87, 65536
  s_cbranch_scc0 gated_mix__mha_block__swiglu_ffn__prompt_kernel_pollE2_ok
  s_sleep 2
  s_branch gated_mix__mha_block__swiglu_ffn__prompt_kernel_pollE2
gated_mix__mha_block__swiglu_ffn__prompt_kernel_pollE2_ok:
  v_lshlrev_b32 v5, 6, v0
  v_add_u32 v5, 0x4000, v5

  s_mov_b32 s87, 0
gated_mix__mha_block__swiglu_ffn__prompt_kernel_pollE3:
  buffer_load_dword v6, v5, s[20:23], 0 offen sc1
  s_waitcnt vmcnt(0)
  v_cmp_eq_u32 vcc, s3, v6
  s_cmp_eq_u64 vcc, exec
  s_cbranch_scc1 gated_mix__mha_block__swiglu_ffn__prompt_kernel_pollE3_ok
  s_add_u32 s87, s87, 1
  s_cmp_lt_u32 s87, 65536
  s_cbranch_scc0 gated_mix__mha_block__swiglu_ffn__prompt_kernel_pollE3_ok
  s_sleep 2
  s_branch gated_mix__mha_block__swiglu_ffn__prompt_kernel_pollE3
gated_mix__mha_block__swiglu_ffn__prompt_kernel_pollE3_ok:

  v_mov_b32 v5, 0
  v_mov_b32 v6, s3
  s_mov_b64 exec, 1
  buffer_store_dword v6, v5, s[20:23], 0 offen
  s_mov_b64 exec, -1
gated_mix__mha_block__swiglu_ffn__prompt_kernel_g_noepoch:
  s_mov_b32 s12, s58
  s_mov_b32 s13, s59
  s_mov_b32 s14, 0x80000
  s_mov_b32 s15, 0x20000

  s_setprio 2
  s_lshl_b32 s35, s24, 17
  s_lshl_b32 s36, s28, 7
  s_add_u32 s35, s35, s36
  s_lshl_b32 s36, s26, 6
  s_lshl_b32 s33, s24, 3
  s_add_u32 s36, s36, s33
  s_lshl_b32 s36, s36, 10
  s_add_u32 s36, s36, 0x700000
  s_mov_b32 s37, 32768
  s_waitcnt vmcnt(0)
  s_add_u32 m0, s38, 0
  s_add_u32 s44, s35, 8192
  buffer_load_dwordx4 v2, s[12:15], s35 offen lds
  s_add_u32 m0, s38, 1024
  s_add_u32 s35, s35, 16384
  buffer_load_dwordx4 v2, s[12:15], s44 offen lds
  s_add_u32 m0, s38, 2048
  s_add_u32 s44, s35, 8192
  buffer_load_dwordx4 v2, s[12:15], s35 offen lds
  s_add_u32 m0, s38, 3072
  s_add_u32 s35, s35, 16384
  buffer_load_dwordx4 v2, s[12:15], s44 offen lds
  s_add_u32 m0, s38, 4096
  s_add_u32 s44, s35, 8192
  buffer_load_dwordx4 v2, s[12:15], s35 offen lds
  s_add_u32 m0, s38, 5120
  s_add_u32 s35, s35, 16384
  buffer_load_dwordx4 v2, s[12:15], s44 offen lds
  s_add_u32 m0, s38, 6144
  s_add_u32 s44, s35, 8192
  buffer_load_dwordx4 v2, s[12:15], s35 offen lds
  s_add_u32 m0, s38, 7168
  s_add_u32 s35, s35, 16384
  buffer_load_dwordx4 v2, s[12:15], s44 offen lds
  s_add_u32 m0, s38, 8192
  s_add_u32 s44, s35, 8192
  buffer_load_dwordx4 v2, s[12:15], s35 offen lds
  s_add_u32 m0, s38, 9216
  s_add_u32 s35, s35, 16384
  buffer_load_dwordx4 v2, s[12:15], s44 offen lds
  s_add_u32 m0, s38, 10240
  s_add_u32 s44, s35, 8192
  buffer_load_dwordx4 v2, s[12:15], s35 offen lds
  s_add_u32 m0, s38, 11264
  s_add_u32 s35, s35, 16384
  buffer_load_dwordx4 v2, s[12:15], s44 offen lds
  s_add_u32 m0, s38, 12288
  s_add_u32 s44, s35, 8192
  buffer_load_dwordx4 v2, s[12:15], s35 offen lds
  s_add_u32 m0, s38, 13312
  s_add_u32 s35, s35, 16384
  buffer_load_dwordx4 v2, s[12:15], s44 offen lds
  s_add_u32 m0, s38, 14336
  s_add_u32 s44, s35, 8192
  buffer_load_dwordx4 v2, s[12:15], s35 offen lds
  s_add_u32 m0, s38, 15360
  s_add_u32 s35, s35, 16384
  buffer_load_dwordx4 v2, s[12:15], s44 offen lds

  s_lshr_b32 s30, s2, 3
  s_and_b32 s30, s30, 3
  s_lshl_b32 s31, s25, 2
  s_mov_b32 s46, s28
  s_mov_b32 s47, s29
  s_add_u32 s28, s30, s31
  s_lshr_b32 s29, s2, 5
  s_add_u32 s45, s24, 4
  v_mov_b32 v1, v3
  s_waitcnt vmcnt(0)
  s_load_dwordx2 s[60:61], s[0:1], 64
  ds_read_b64_tr_b16 v[32:33], v4 offset:0
  ds_read_b64_tr_b16 v[34:35], v4 offset:1024
  ds_read_b64_tr_b16 v[36:37], v7 offset:0
  ds_read_b64_tr_b16 v[38:39], v7 offset:1024
  ds_read_b64_tr_b16 v[40:41], v4 offset:2048
  ds_read_b64_tr_b16 v[42:43], v4 offset:3072
  ds_read_b64_tr_b16 v[44:45], v7 offset:2048
  ds_read_b64_tr_b16 v[46:47], v7 offset:3072
  ds_read_b64_tr_b16 v[48:49], v4 offset:4096
  ds_read_b64_tr_b16 v[50:51], v4 offset:5120
  ds_read_b64_tr_b16 v[52:53], v7 offset:4096
  ds_read_b64_tr_b16 v[54:55], v7 offset:5120
  s_waitcnt lgkmcnt(0)
  ds_read_b64_tr_b16 v[56:57], v4 offset:6144
  ds_read_b64_tr_b16 v[58:59], v4 offset:7168
  ds_read_b64_tr_b16 v[60:61], v7 offset:6144
  ds_read_b64_tr_b16 v[62:63], v7 offset:7168
  ds_read_b64_tr_b16 v[16:17], v4 offset:8192
  ds_read_b64_tr_b16 v[18:19], v4 offset:9216
  ds_read_b64_tr_b16 v[20:21], v7 offset:8192
  ds_read_b64_tr_b16 v[22:23], v7 offset:9216
  ds_read_b64_tr_b16 v[24:25], v4 offset:10240
  ds_read_b64_tr_b16 v[26:27], v4 offset:11264
  ds_read_b64_tr_b16 v[28:29], v7 offset:10240
  ds_read_b64_tr_b16 v[30:31], v7 offset:11264

  v_mov_b32 v12, v8
  v_mov_b32 v13, v8
  v_mov_b32 v14, v9
  v_mov_b32 v15, v9
  s_and_b32 s41, s24, 1
  s_lshr_b32 s40, s24, 1
  s_lshl_b32 s48, s26, 6
  s_lshl_b32 s41, s41, 5
  s_add_u32 s48, s48, s41
  s_lshl_b32 s48, s48, 10
  s_lshl_b32 s43, s46, 7
  s_lshl_b32 s40, s40, 6
  s_add_u32 s43, s43, s40
  s_add_u32 s48, s48, s43
  v_and_b32 v10, 31, v0
  v_lshlrev_b32 v10, 10, v10
  v_lshrrev_b32 v11, 5, v0
  v_lshl_add_u32 v10, v11, 4, v10
  v_add_u32 v11, s38, v3
  s_lshl_b32 s40, s24, 12
  v_add_u32 v2, s40, v3
  s_waitcnt lgkmcnt(0)
  s_mov_b32 s16, s60
  s_mov_b32 s17, s61
  s_mov_b32 s18, 0x200000
  s_mov_b32 s19, 0x20000
  s_barrier

  s_mul_i32 s40, s45, 2560
  s_add_u32 s40, s40, 65536
  v_add_u32 v232, s40, v1
  v_lshrrev_b32 v233, 1, v1
  v_add_u32 v233, s40, v233
  v_add_u32 v234, 40960, v232
  v_add_u32 v235, 40960, v233
  ds_read_b64 v[200:201], v233 offset:2048
  ds_read_b64 v[210:211], v233 offset:22528
  ds_read_b64 v[220:221], v235 offset:2048
  ds_read_b64 v[230:231], v235 offset:22528
  ds_read_b128 v[192:195], v232 offset:0
  ds_read_b128 v[196:199], v232 offset:1024
  ds_read_b128 v[202:205], v232 offset:20480
  ds_read_b128 v[206:209], v232 offset:21504
  ds_read_b128 v[212:215], v234 offset:0
  ds_read_b128 v[216:219], v234 offset:1024
  ds_read_b128 v[222:225], v234 offset:20480
  ds_read_b128 v[226:229], v234 offset:21504

  s_lshl_b32 s41, s29, 3
  s_add_u32 s41, s41, s45
  s_lshl_b32 s41, s41, 5
  s_add_u32 s41, s41, s28
  s_lshl_b32 s41, s41, 10
  s_add_u32 s41, s41, 0x700000
  s_waitcnt lgkmcnt(8)
  v_max3_f32 v232, v201, v211, v221
  v_max_f32 v232, v232, v231
  v_sub_f32 v233, v201, v232
  v_sub_f32 v234, v211, v232
  v_sub_f32 v235, v221, v232
  v_sub_f32 v236, v231, v232
  v_exp_f32 v233, v233
  v_exp_f32 v234, v234
  v_exp_f32 v235, v235
  v_exp_f32 v236, v236
  s_nop 0
  v_mul_f32 v237, v233, v200
  v_fmac_f32 v237, v234, v210
  v_fmac_f32 v237, v235, v220
  v_fmac_f32 v237, v236, v230
  v_rcp_f32 v237, v237
  s_nop 0
  v_mul_f32 v233, v237, v233
  v_mul_f32 v234, v237, v234
  v_mul_f32 v235, v237, v235
  v_mul_f32 v236, v237, v236
  s_waitcnt lgkmcnt(0)
  v_mul_f32 v238, v233, v192
  v_fmac_f32 v238, v234, v202
  v_fmac_f32 v238, v235, v212
  v_fmac_f32 v238, v236, v222
  v_mul_f32 v239, v233, v193
  v_fmac_f32 v239, v234, v203
  v_fmac_f32 v239, v235, v213
  v_fmac_f32 v239, v236, v223
  v_mul_f32 v240, v233, v194
  v_fmac_f32 v240, v234, v204
  v_fmac_f32 v240, v235, v214
  v_fmac_f32 v240, v236, v224
  v_mul_f32 v241, v233, v195
  v_fmac_f32 v241, v234, v205
  v_fmac_f32 v241, v235, v215
  v_fmac_f32 v241, v236, v225
  v_mul_f32 v242, v233, v196
  v_fmac_f32 v242, v234, v206
  v_fmac_f32 v242, v235, v216
  v_fmac_f32 v242, v236, v226
  v_mul_f32 v243, v233, v197
  v_fmac_f32 v243, v234, v207
  v_fmac_f32 v243, v235, v217
  v_fmac_f32 v243, v236, v227
  v_mul_f32 v244, v233, v198
  v_fmac_f32 v244, v234, v208
  v_fmac_f32 v244, v235, v218
  v_fmac_f32 v244, v236, v228
  v_mul_f32 v245, v233, v199
  v_fmac_f32 v245, v234, v209
  v_fmac_f32 v245, v235, v219
  v_fmac_f32 v245, v236, v229
  v_cvt_pk_bf16_f32 v192, v238, v239
  v_cvt_pk_bf16_f32 v193, v240, v241
  v_cvt_pk_bf16_f32 v194, v242, v243
  v_cvt_pk_bf16_f32 v195, v244, v245
  buffer_store_dwordx4 v[192:195], v1, s[20:23], s41 offen sc1

  s_mov_b32 s28, s46
  s_mov_b32 s29, s47
  s_waitcnt vmcnt(0)
  s_barrier
  s_cmp_lg_u32 s24, 0
  s_cbranch_scc1 gated_mix__mha_block__swiglu_ffn__prompt_kernel_g_nopost2
  s_lshr_b32 s30, s2, 3
  s_and_b32 s30, s30, 3
  s_lshl_b32 s31, s25, 2
  s_add_u32 s30, s30, s31
  s_lshr_b32 s31, s2, 5
  s_lshl_b32 s31, s31, 5
  s_add_u32 s30, s30, s31
  s_lshl_b32 s30, s30, 6
  s_add_u32 s30, s30, 0x5000
  v_mov_b32 v5, s30
  v_mov_b32 v6, s3
  s_mov_b64 exec, 1
  buffer_store_dword v6, v5, s[20:23], 0 offen sc1
  s_mov_b64 exec, -1
gated_mix__mha_block__swiglu_ffn__prompt_kernel_g_nopost2:

  s_lshr_b32 s30, s26, 2
  s_lshl_b32 s30, s30, 5
  s_lshl_b32 s31, s24, 3
  s_add_u32 s30, s30, s31
  v_and_b32 v5, 7, v0
  v_add_u32 v5, s30, v5
  v_lshlrev_b32 v5, 6, v5
  v_add_u32 v5, 0x5000, v5

  s_mov_b32 s87, 0
gated_mix__mha_block__swiglu_ffn__prompt_kernel_pollO:
  buffer_load_dword v6, v5, s[20:23], 0 offen sc1
  s_waitcnt vmcnt(0)
  v_cmp_eq_u32 vcc, s3, v6
  s_cmp_eq_u64 vcc, exec
  s_cbranch_scc1 gated_mix__mha_block__swiglu_ffn__prompt_kernel_pollO_ok
  s_add_u32 s87, s87, 1
  s_cmp_lt_u32 s87, 65536
  s_cbranch_scc0 gated_mix__mha_block__swiglu_ffn__prompt_kernel_pollO_ok
  s_sleep 2
  s_branch gated_mix__mha_block__swiglu_ffn__prompt_kernel_pollO
gated_mix__mha_block__swiglu_ffn__prompt_kernel_pollO_ok:
  s_add_u32 s43, s36, s37
  buffer_load_dwordx4 v[192:195], v3, s[20:23], s36 offen sc1
  buffer_load_dwordx4 v[196:199], v3, s[20:23], s43 offen sc1
  s_add_u32 s36, s36, 1024
  s_add_u32 s43, s36, s37
  buffer_load_dwordx4 v[200:203], v3, s[20:23], s36 offen sc1
  buffer_load_dwordx4 v[204:207], v3, s[20:23], s43 offen sc1
  s_add_u32 s36, s36, 1024
  s_add_u32 s43, s36, s37
  buffer_load_dwordx4 v[208:211], v3, s[20:23], s36 offen sc1
  buffer_load_dwordx4 v[212:215], v3, s[20:23], s43 offen sc1
  s_add_u32 s36, s36, 1024
  s_add_u32 s43, s36, s37
  buffer_load_dwordx4 v[216:219], v3, s[20:23], s36 offen sc1
  buffer_load_dwordx4 v[220:223], v3, s[20:23], s43 offen sc1
  s_add_u32 s36, s36, 1024
  s_add_u32 s43, s36, s37
  buffer_load_dwordx4 v[224:227], v3, s[20:23], s36 offen sc1
  buffer_load_dwordx4 v[228:231], v3, s[20:23], s43 offen sc1
  s_add_u32 s36, s36, 1024
  s_add_u32 s43, s36, s37
  buffer_load_dwordx4 v[232:235], v3, s[20:23], s36 offen sc1
  buffer_load_dwordx4 v[236:239], v3, s[20:23], s43 offen sc1
  s_add_u32 s36, s36, 1024
  s_add_u32 s43, s36, s37
  buffer_load_dwordx4 v[240:243], v3, s[20:23], s36 offen sc1
  buffer_load_dwordx4 v[244:247], v3, s[20:23], s43 offen sc1
  s_add_u32 s36, s36, 1024
  s_add_u32 s43, s36, s37
  buffer_load_dwordx4 v[248:251], v3, s[20:23], s36 offen sc1
  buffer_load_dwordx4 v[252:255], v3, s[20:23], s43 offen sc1
  s_add_u32 s36, s36, 1024
  s_waitcnt vmcnt(14)
  v_mfma_f32_32x32x16_bf16 v[128:143], v[32:35], v[192:195], 0
  v_mfma_f32_32x32x16_bf16 v[144:159], v[32:35], v[196:199], 0
  v_mfma_f32_32x32x16_bf16 v[160:175], v[36:39], v[192:195], 0
  v_mfma_f32_32x32x16_bf16 v[176:191], v[36:39], v[196:199], 0
  ds_read_b64_tr_b16 v[32:33], v4 offset:12288
  ds_read_b64_tr_b16 v[34:35], v4 offset:13312
  ds_read_b64_tr_b16 v[36:37], v7 offset:12288
  ds_read_b64_tr_b16 v[38:39], v7 offset:13312
  s_waitcnt vmcnt(12)
  v_mfma_f32_32x32x16_bf16 v[128:143], v[40:43], v[200:203], v[128:143]
  v_mfma_f32_32x32x16_bf16 v[144:159], v[40:43], v[204:207], v[144:159]
  v_mfma_f32_32x32x16_bf16 v[160:175], v[44:47], v[200:203], v[160:175]
  v_mfma_f32_32x32x16_bf16 v[176:191], v[44:47], v[204:207], v[176:191]
  ds_read_b64_tr_b16 v[40:41], v4 offset:14336
  ds_read_b64_tr_b16 v[42:43], v4 offset:15360
  ds_read_b64_tr_b16 v[44:45], v7 offset:14336
  ds_read_b64_tr_b16 v[46:47], v7 offset:15360
  s_waitcnt vmcnt(10)
  v_mfma_f32_32x32x16_bf16 v[128:143], v[48:51], v[208:211], v[128:143]
  v_mfma_f32_32x32x16_bf16 v[144:159], v[48:51], v[212:215], v[144:159]
  v_mfma_f32_32x32x16_bf16 v[160:175], v[52:55], v[208:211], v[160:175]
  v_mfma_f32_32x32x16_bf16 v[176:191], v[52:55], v[212:215], v[176:191]
  s_waitcnt vmcnt(8)
  v_mfma_f32_32x32x16_bf16 v[128:143], v[56:59], v[216:219], v[128:143]
  v_mfma_f32_32x32x16_bf16 v[144:159], v[56:59], v[220:223], v[144:159]
  v_mfma_f32_32x32x16_bf16 v[160:175], v[60:63], v[216:219], v[160:175]
  v_mfma_f32_32x32x16_bf16 v[176:191], v[60:63], v[220:223], v[176:191]
  s_waitcnt vmcnt(0)
  s_waitcnt lgkmcnt(0)
  v_mfma_f32_32x32x16_bf16 v[128:143], v[16:19], v[224:227], v[128:143]
  v_mfma_f32_32x32x16_bf16 v[128:143], v[24:27], v[232:235], v[128:143]
  v_mfma_f32_32x32x16_bf16 v[128:143], v[32:35], v[240:243], v[128:143]
  v_mfma_f32_32x32x16_bf16 v[128:143], v[40:43], v[248:251], v[128:143]
  v_mfma_f32_32x32x16_bf16 v[144:159], v[16:19], v[228:231], v[144:159]
  v_mfma_f32_32x32x16_bf16 v[144:159], v[24:27], v[236:239], v[144:159]
  v_mfma_f32_32x32x16_bf16 v[144:159], v[32:35], v[244:247], v[144:159]
  v_mfma_f32_32x32x16_bf16 v[144:159], v[40:43], v[252:255], v[144:159]
  s_nop 7
  v_pk_fma_f32 v[64:65], v[128:129], v[12:13], v[64:65]
  v_pk_fma_f32 v[66:67], v[130:131], v[12:13], v[66:67]
  v_pk_fma_f32 v[68:69], v[132:133], v[12:13], v[68:69]
  v_pk_fma_f32 v[70:71], v[134:135], v[12:13], v[70:71]
  v_pk_fma_f32 v[72:73], v[136:137], v[12:13], v[72:73]
  v_pk_fma_f32 v[74:75], v[138:139], v[12:13], v[74:75]
  v_pk_fma_f32 v[76:77], v[140:141], v[12:13], v[76:77]
  v_pk_fma_f32 v[78:79], v[142:143], v[12:13], v[78:79]
  ds_write_b128 v11, v[64:67] offset:0
  ds_write_b128 v11, v[68:71] offset:1024
  ds_write_b128 v11, v[72:75] offset:2048
  ds_write_b128 v11, v[76:79] offset:3072
  v_mfma_f32_32x32x16_bf16 v[160:175], v[20:23], v[224:227], v[160:175]
  v_mfma_f32_32x32x16_bf16 v[160:175], v[28:31], v[232:235], v[160:175]
  v_mfma_f32_32x32x16_bf16 v[160:175], v[36:39], v[240:243], v[160:175]
  v_mfma_f32_32x32x16_bf16 v[160:175], v[44:47], v[248:251], v[160:175]
  s_nop 7
  v_pk_fma_f32 v[80:81], v[144:145], v[14:15], v[80:81]
  v_pk_fma_f32 v[82:83], v[146:147], v[14:15], v[82:83]
  v_pk_fma_f32 v[84:85], v[148:149], v[14:15], v[84:85]
  v_pk_fma_f32 v[86:87], v[150:151], v[14:15], v[86:87]
  v_pk_fma_f32 v[88:89], v[152:153], v[14:15], v[88:89]
  v_pk_fma_f32 v[90:91], v[154:155], v[14:15], v[90:91]
  v_pk_fma_f32 v[92:93], v[156:157], v[14:15], v[92:93]
  v_pk_fma_f32 v[94:95], v[158:159], v[14:15], v[94:95]
  ds_write_b128 v11, v[80:83] offset:4096
  ds_write_b128 v11, v[84:87] offset:5120
  ds_write_b128 v11, v[88:91] offset:6144
  ds_write_b128 v11, v[92:95] offset:7168
  v_mfma_f32_32x32x16_bf16 v[176:191], v[20:23], v[228:231], v[176:191]
  v_mfma_f32_32x32x16_bf16 v[176:191], v[28:31], v[236:239], v[176:191]
  v_mfma_f32_32x32x16_bf16 v[176:191], v[36:39], v[244:247], v[176:191]
  v_mfma_f32_32x32x16_bf16 v[176:191], v[44:47], v[252:255], v[176:191]
  s_nop 7
  v_pk_fma_f32 v[96:97], v[160:161], v[12:13], v[96:97]
  v_pk_fma_f32 v[98:99], v[162:163], v[12:13], v[98:99]
  v_pk_fma_f32 v[100:101], v[164:165], v[12:13], v[100:101]
  v_pk_fma_f32 v[102:103], v[166:167], v[12:13], v[102:103]
  v_pk_fma_f32 v[104:105], v[168:169], v[12:13], v[104:105]
  v_pk_fma_f32 v[106:107], v[170:171], v[12:13], v[106:107]
  v_pk_fma_f32 v[108:109], v[172:173], v[12:13], v[108:109]
  v_pk_fma_f32 v[110:111], v[174:175], v[12:13], v[110:111]
  ds_write_b128 v11, v[96:99] offset:8192
  ds_write_b128 v11, v[100:103] offset:9216
  ds_write_b128 v11, v[104:107] offset:10240
  ds_write_b128 v11, v[108:111] offset:11264
  s_nop 7
  s_nop 3
  v_pk_fma_f32 v[112:113], v[176:177], v[14:15], v[112:113]
  v_pk_fma_f32 v[114:115], v[178:179], v[14:15], v[114:115]
  v_pk_fma_f32 v[116:117], v[180:181], v[14:15], v[116:117]
  v_pk_fma_f32 v[118:119], v[182:183], v[14:15], v[118:119]
  v_pk_fma_f32 v[120:121], v[184:185], v[14:15], v[120:121]
  v_pk_fma_f32 v[122:123], v[186:187], v[14:15], v[122:123]
  v_pk_fma_f32 v[124:125], v[188:189], v[14:15], v[124:125]
  v_pk_fma_f32 v[126:127], v[190:191], v[14:15], v[126:127]
  ds_write_b128 v11, v[112:115] offset:12288
  ds_write_b128 v11, v[116:119] offset:13312
  ds_write_b128 v11, v[120:123] offset:14336
  ds_write_b128 v11, v[124:127] offset:15360
  s_waitcnt lgkmcnt(0)
  s_barrier
  ds_read_b128 v[64:67], v2 offset:0
  ds_read_b128 v[68:71], v2 offset:1024
  ds_read_b128 v[72:75], v2 offset:2048
  ds_read_b128 v[76:79], v2 offset:3072
  ds_read_b128 v[80:83], v2 offset:16384
  ds_read_b128 v[84:87], v2 offset:17408
  ds_read_b128 v[88:91], v2 offset:18432
  ds_read_b128 v[92:95], v2 offset:19456
  ds_read_b128 v[96:99], v2 offset:32768
  ds_read_b128 v[100:103], v2 offset:33792
  ds_read_b128 v[104:107], v2 offset:34816
  ds_read_b128 v[108:111], v2 offset:35840
  ds_read_b128 v[112:115], v2 offset:49152
  ds_read_b128 v[116:119], v2 offset:50176
  ds_read_b128 v[120:123], v2 offset:51200
  ds_read_b128 v[124:127], v2 offset:52224
  s_waitcnt lgkmcnt(0)
  v_pk_add_f32 v[64:65], v[64:65], v[80:81]
  v_pk_add_f32 v[96:97], v[96:97], v[112:113]
  v_pk_add_f32 v[64:65], v[64:65], v[96:97]
  v_pk_add_f32 v[66:67], v[66:67], v[82:83]
  v_pk_add_f32 v[98:99], v[98:99], v[114:115]
  v_pk_add_f32 v[66:67], v[66:67], v[98:99]
  v_pk_add_f32 v[68:69], v[68:69], v[84:85]
  v_pk_add_f32 v[100:101], v[100:101], v[116:117]
  v_pk_add_f32 v[68:69], v[68:69], v[100:101]
  v_pk_add_f32 v[70:71], v[70:71], v[86:87]
  v_pk_add_f32 v[102:103], v[102:103], v[118:119]
  v_pk_add_f32 v[70:71], v[70:71], v[102:103]
  v_pk_add_f32 v[72:73], v[72:73], v[88:89]
  v_pk_add_f32 v[104:105], v[104:105], v[120:121]
  v_pk_add_f32 v[72:73], v[72:73], v[104:105]
  v_pk_add_f32 v[74:75], v[74:75], v[90:91]
  v_pk_add_f32 v[106:107], v[106:107], v[122:123]
  v_pk_add_f32 v[74:75], v[74:75], v[106:107]
  v_pk_add_f32 v[76:77], v[76:77], v[92:93]
  v_pk_add_f32 v[108:109], v[108:109], v[124:125]
  v_pk_add_f32 v[76:77], v[76:77], v[108:109]
  v_pk_add_f32 v[78:79], v[78:79], v[94:95]
  v_pk_add_f32 v[110:111], v[110:111], v[126:127]
  v_pk_add_f32 v[78:79], v[78:79], v[110:111]
  v_cvt_pk_bf16_f32 v16, v64, v65
  v_cvt_pk_bf16_f32 v17, v66, v67
  v_cvt_pk_bf16_f32 v18, v68, v69
  v_cvt_pk_bf16_f32 v19, v70, v71
  v_cvt_pk_bf16_f32 v20, v72, v73
  v_cvt_pk_bf16_f32 v21, v74, v75
  v_cvt_pk_bf16_f32 v22, v76, v77
  v_cvt_pk_bf16_f32 v23, v78, v79

  s_nop 1
  v_permlane32_swap_b32 v16, v18
  v_permlane32_swap_b32 v17, v19
  v_permlane32_swap_b32 v20, v22
  v_permlane32_swap_b32 v21, v23
  s_nop 1
  buffer_store_dwordx4 v[16:19], v10, s[16:19], s48 offen
  buffer_store_dwordx4 v[20:23], v10, s[16:19], s48 offen offset:32

  s_endpgm
gated_mix__mha_block__swiglu_ffn__prompt_kernel_compute:
  s_waitcnt lgkmcnt(0)

  s_lshr_b32 s30, s24, 1
  s_and_b32 s31, s24, 1
  v_and_b32 v48, 31, v0
  v_lshrrev_b32 v49, 5, v0
  v_lshrrev_b32 v50, 1, v48
  v_and_b32 v50, 7, v50
  s_lshl_b32 s32, s30, 1
  s_add_u32 s32, s32, s31
  s_xor_b32 s33, s32, 1
  s_lshl_b32 s34, s32, 12
  s_lshl_b32 s35, s33, 12
  v_lshlrev_b32 v51, 7, v48
  v_add_u32 v52, 0, v49
  v_xor_b32 v52, v52, v50
  v_lshl_add_u32 v52, v52, 4, v51
  v_add_u32 v2, s34, v52
  v_add_u32 v6, s35, v52
  v_add_u32 v52, 2, v49
  v_xor_b32 v52, v52, v50
  v_lshl_add_u32 v52, v52, 4, v51
  v_add_u32 v3, s34, v52
  v_add_u32 v7, s35, v52
  v_add_u32 v52, 4, v49
  v_xor_b32 v52, v52, v50
  v_lshl_add_u32 v52, v52, 4, v51
  v_add_u32 v4, s34, v52
  v_add_u32 v8, s35, v52
  v_add_u32 v52, 6, v49
  v_xor_b32 v52, v52, v50
  v_lshl_add_u32 v52, v52, 4, v51
  v_add_u32 v5, s34, v52
  v_add_u32 v9, s35, v52

  v_and_b32 v48, 15, v0
  v_lshrrev_b32 v50, 4, v0
  v_and_b32 v50, 1, v50
  v_lshrrev_b32 v52, 2, v48
  v_lshl_add_u32 v53, v49, 3, v52
  v_and_b32 v54, 3, v48
  v_lshlrev_b32 v54, 3, v54
  v_mov_b32 v64, 0
  v_mov_b32 v65, 0
  v_mov_b32 v66, 0
  v_mov_b32 v67, 0
  v_mov_b32 v68, 0
  v_mov_b32 v69, 0
  v_mov_b32 v70, 0
  v_mov_b32 v71, 0
  v_mov_b32 v72, 0
  v_mov_b32 v73, 0
  v_mov_b32 v74, 0
  v_mov_b32 v75, 0
  v_mov_b32 v76, 0
  v_mov_b32 v77, 0
  v_mov_b32 v78, 0
  v_mov_b32 v79, 0
  v_mov_b32 v80, 0
  v_mov_b32 v81, 0
  v_mov_b32 v82, 0
  v_mov_b32 v83, 0
  v_mov_b32 v84, 0
  v_mov_b32 v85, 0
  v_mov_b32 v86, 0
  v_mov_b32 v87, 0
  v_mov_b32 v88, 0
  v_mov_b32 v89, 0
  v_mov_b32 v90, 0
  v_mov_b32 v91, 0
  v_mov_b32 v92, 0
  v_mov_b32 v93, 0
  v_mov_b32 v94, 0
  v_mov_b32 v95, 0
  v_mov_b32 v96, 0
  v_mov_b32 v97, 0
  v_mov_b32 v98, 0
  v_mov_b32 v99, 0
  v_mov_b32 v100, 0
  v_mov_b32 v101, 0
  v_mov_b32 v102, 0
  v_mov_b32 v103, 0
  v_mov_b32 v104, 0
  v_mov_b32 v105, 0
  v_mov_b32 v106, 0
  v_mov_b32 v107, 0
  v_mov_b32 v108, 0
  v_mov_b32 v109, 0
  v_mov_b32 v110, 0
  v_mov_b32 v111, 0
  v_mov_b32 v112, 0
  v_mov_b32 v113, 0
  v_mov_b32 v114, 0
  v_mov_b32 v115, 0
  v_mov_b32 v116, 0
  v_mov_b32 v117, 0
  v_mov_b32 v118, 0
  v_mov_b32 v119, 0
  v_mov_b32 v120, 0
  v_mov_b32 v121, 0
  v_mov_b32 v122, 0
  v_mov_b32 v123, 0
  v_mov_b32 v124, 0
  v_mov_b32 v125, 0
  v_mov_b32 v126, 0
  v_mov_b32 v127, 0
  v_mov_b32 v128, 0
  v_mov_b32 v129, 0
  v_mov_b32 v130, 0
  v_mov_b32 v131, 0
  v_mov_b32 v132, 0
  v_mov_b32 v133, 0
  v_mov_b32 v134, 0
  v_mov_b32 v135, 0
  v_mov_b32 v136, 0
  v_mov_b32 v137, 0
  v_mov_b32 v138, 0
  v_mov_b32 v139, 0
  v_mov_b32 v140, 0
  v_mov_b32 v141, 0
  v_mov_b32 v142, 0
  v_mov_b32 v143, 0
  v_mov_b32 v144, 0
  v_mov_b32 v145, 0
  v_mov_b32 v146, 0
  v_mov_b32 v147, 0
  v_mov_b32 v148, 0
  v_mov_b32 v149, 0
  v_mov_b32 v150, 0
  v_mov_b32 v151, 0
  v_mov_b32 v152, 0
  v_mov_b32 v153, 0
  v_mov_b32 v154, 0
  v_mov_b32 v155, 0
  v_mov_b32 v156, 0
  v_mov_b32 v157, 0
  v_mov_b32 v158, 0
  v_mov_b32 v159, 0
  v_mov_b32 v160, 0
  v_mov_b32 v161, 0
  v_mov_b32 v162, 0
  v_mov_b32 v163, 0
  v_mov_b32 v164, 0
  v_mov_b32 v165, 0
  v_mov_b32 v166, 0
  v_mov_b32 v167, 0
  v_mov_b32 v168, 0
  v_mov_b32 v169, 0
  v_mov_b32 v170, 0
  v_mov_b32 v171, 0
  v_mov_b32 v172, 0
  v_mov_b32 v173, 0
  v_mov_b32 v174, 0
  v_mov_b32 v175, 0
  v_mov_b32 v176, 0
  v_mov_b32 v177, 0
  v_mov_b32 v178, 0
  v_mov_b32 v179, 0
  v_mov_b32 v180, 0
  v_mov_b32 v181, 0
  v_mov_b32 v182, 0
  v_mov_b32 v183, 0
  v_mov_b32 v184, 0
  v_mov_b32 v185, 0
  v_mov_b32 v186, 0
  v_mov_b32 v187, 0
  v_mov_b32 v188, 0
  v_mov_b32 v189, 0
  v_mov_b32 v190, 0
  v_mov_b32 v191, 0
  v_mov_b32 v192, 0
  v_mov_b32 v193, 0
  v_mov_b32 v194, 0
  v_mov_b32 v195, 0
  v_mov_b32 v196, 0
  v_mov_b32 v197, 0
  v_mov_b32 v198, 0
  v_mov_b32 v199, 0
  v_mov_b32 v200, 0
  v_mov_b32 v201, 0
  v_mov_b32 v202, 0
  v_mov_b32 v203, 0
  v_mov_b32 v204, 0
  v_mov_b32 v205, 0
  v_mov_b32 v206, 0
  v_mov_b32 v207, 0
  s_cmp_lg_u32 s62, 0
  s_cbranch_scc1 gated_mix__mha_block__swiglu_ffn__prompt_kernel_cB
  v_lshrrev_b32 v55, 1, v52
  v_and_b32 v55, 1, v55
  v_xor_b32 v55, s31, v55
  v_mul_u32_u24 v56, 384, v53
  v_lshl_add_u32 v56, v55, 6, v56
  v_lshl_add_u32 v56, v50, 5, v56
  v_add_u32 v56, v56, v54
  v_add_u32 v10, 16384, v56
  v_lshrrev_b32 v55, 1, v52
  v_and_b32 v55, 1, v55
  v_xor_b32 v55, s31, v55
  v_mul_u32_u24 v56, 384, v53
  v_lshl_add_u32 v56, v55, 6, v56
  v_lshl_add_u32 v56, v50, 5, v56
  v_add_u32 v56, v56, v54
  v_add_u32 v11, 16512, v56
  v_lshrrev_b32 v55, 1, v52
  v_and_b32 v55, 1, v55
  v_xor_b32 v55, s31, v55
  v_mul_u32_u24 v56, 384, v53
  v_lshl_add_u32 v56, v55, 6, v56
  v_lshl_add_u32 v56, v50, 5, v56
  v_add_u32 v56, v56, v54
  v_add_u32 v13, 16640, v56
  v_lshlrev_b32 v56, 6, v53
  v_lshl_add_u32 v56, v50, 12, v56
  v_xor_b32 v55, s31, v50
  v_lshl_add_u32 v56, v55, 5, v56
  v_add_u32 v56, v56, v54
  v_add_u32 v12, 40960, v56
  v_mov_b32 v14, 0
  s_barrier
  ds_read_b128 v[208:211], v2
  ds_read_b128 v[212:215], v6
  ds_read_b64_tr_b16 v[216:217], v10 offset:0
  ds_read_b64_tr_b16 v[218:219], v10 offset:1536
  ds_read_b64_tr_b16 v[220:221], v11 offset:0
  ds_read_b64_tr_b16 v[222:223], v11 offset:1536
  ds_read_b64_tr_b16 v[224:225], v12 offset:0
  ds_read_b64_tr_b16 v[226:227], v12 offset:256
  ds_read_b64_tr_b16 v[228:229], v13 offset:0
  ds_read_b64_tr_b16 v[230:231], v13 offset:1536
  s_waitcnt lgkmcnt(0)
  v_mfma_f32_32x32x16_bf16 v[64:79], v[216:219], v[208:211], v[64:79]
  ds_read_b128 v[16:19], v3
  ds_read_b128 v[20:23], v7
  v_mfma_f32_32x32x16_bf16 v[80:95], v[216:219], v[212:215], v[80:95]
  ds_read_b64_tr_b16 v[24:25], v10 offset:6144
  ds_read_b64_tr_b16 v[26:27], v10 offset:7680
  v_mfma_f32_32x32x16_bf16 v[96:111], v[220:223], v[208:211], v[96:111]
  ds_read_b64_tr_b16 v[28:29], v11 offset:6144
  ds_read_b64_tr_b16 v[30:31], v11 offset:7680
  v_mfma_f32_32x32x16_bf16 v[112:127], v[220:223], v[212:215], v[112:127]
  ds_read_b64_tr_b16 v[32:33], v12 offset:1024
  ds_read_b64_tr_b16 v[34:35], v12 offset:1280
  v_mfma_f32_32x32x16_bf16 v[128:143], v[224:227], v[208:211], v[128:143]
  ds_read_b64_tr_b16 v[36:37], v13 offset:6144
  ds_read_b64_tr_b16 v[38:39], v13 offset:7680
  v_mfma_f32_32x32x16_bf16 v[144:159], v[224:227], v[212:215], v[144:159]
  v_mfma_f32_32x32x16_bf16 v[160:175], v[208:211], v[228:231], v[160:175]
  v_mfma_f32_32x32x16_bf16 v[176:191], v[212:215], v[228:231], v[176:191]
  s_waitcnt lgkmcnt(0)
  v_mfma_f32_32x32x16_bf16 v[64:79], v[24:27], v[16:19], v[64:79]
  ds_read_b128 v[208:211], v4
  ds_read_b128 v[212:215], v8
  v_mfma_f32_32x32x16_bf16 v[80:95], v[24:27], v[20:23], v[80:95]
  ds_read_b64_tr_b16 v[216:217], v10 offset:12288
  ds_read_b64_tr_b16 v[218:219], v10 offset:13824
  v_mfma_f32_32x32x16_bf16 v[96:111], v[28:31], v[16:19], v[96:111]
  ds_read_b64_tr_b16 v[220:221], v11 offset:12288
  ds_read_b64_tr_b16 v[222:223], v11 offset:13824
  v_mfma_f32_32x32x16_bf16 v[112:127], v[28:31], v[20:23], v[112:127]
  ds_read_b64_tr_b16 v[224:225], v12 offset:2048
  ds_read_b64_tr_b16 v[226:227], v12 offset:2304
  v_mfma_f32_32x32x16_bf16 v[128:143], v[32:35], v[16:19], v[128:143]
  ds_read_b64_tr_b16 v[228:229], v13 offset:12288
  ds_read_b64_tr_b16 v[230:231], v13 offset:13824
  v_mfma_f32_32x32x16_bf16 v[144:159], v[32:35], v[20:23], v[144:159]
  v_mfma_f32_32x32x16_bf16 v[160:175], v[16:19], v[36:39], v[160:175]
  v_mfma_f32_32x32x16_bf16 v[176:191], v[20:23], v[36:39], v[176:191]
  s_waitcnt lgkmcnt(0)
  v_mfma_f32_32x32x16_bf16 v[64:79], v[216:219], v[208:211], v[64:79]
  ds_read_b128 v[16:19], v5
  ds_read_b128 v[20:23], v9
  v_mfma_f32_32x32x16_bf16 v[80:95], v[216:219], v[212:215], v[80:95]
  ds_read_b64_tr_b16 v[24:25], v10 offset:18432
  ds_read_b64_tr_b16 v[26:27], v10 offset:19968
  v_mfma_f32_32x32x16_bf16 v[96:111], v[220:223], v[208:211], v[96:111]
  ds_read_b64_tr_b16 v[28:29], v11 offset:18432
  ds_read_b64_tr_b16 v[30:31], v11 offset:19968
  v_mfma_f32_32x32x16_bf16 v[112:127], v[220:223], v[212:215], v[112:127]
  ds_read_b64_tr_b16 v[32:33], v12 offset:3072
  ds_read_b64_tr_b16 v[34:35], v12 offset:3328
  v_mfma_f32_32x32x16_bf16 v[128:143], v[224:227], v[208:211], v[128:143]
  ds_read_b64_tr_b16 v[36:37], v13 offset:18432
  ds_read_b64_tr_b16 v[38:39], v13 offset:19968
  v_mfma_f32_32x32x16_bf16 v[144:159], v[224:227], v[212:215], v[144:159]
  v_mfma_f32_32x32x16_bf16 v[160:175], v[208:211], v[228:231], v[160:175]
  v_mfma_f32_32x32x16_bf16 v[176:191], v[212:215], v[228:231], v[176:191]
  s_waitcnt lgkmcnt(0)
  v_mfma_f32_32x32x16_bf16 v[64:79], v[24:27], v[16:19], v[64:79]
  v_add_u32 v2, 53376, v2
  v_add_u32 v3, 53376, v3
  v_add_u32 v4, 53376, v4
  v_add_u32 v5, 53376, v5
  v_add_u32 v6, 53376, v6
  v_add_u32 v7, 53376, v7
  v_add_u32 v8, 53376, v8
  v_mfma_f32_32x32x16_bf16 v[80:95], v[24:27], v[20:23], v[80:95]
  v_add_u32 v9, 53376, v9
  v_add_u32 v10, 53376, v10
  v_add_u32 v11, 53376, v11
  v_add_u32 v12, 53376, v12
  v_add_u32 v13, 53376, v13
  v_add_u32 v14, 53376, v14
  s_barrier
  v_mfma_f32_32x32x16_bf16 v[96:111], v[28:31], v[16:19], v[96:111]
  ds_read_b128 v[208:211], v2
  ds_read_b128 v[212:215], v6
  ds_read_b64_tr_b16 v[216:217], v10 offset:0
  v_mfma_f32_32x32x16_bf16 v[112:127], v[28:31], v[20:23], v[112:127]
  ds_read_b64_tr_b16 v[218:219], v10 offset:1536
  ds_read_b64_tr_b16 v[220:221], v11 offset:0
  ds_read_b64_tr_b16 v[222:223], v11 offset:1536
  v_mfma_f32_32x32x16_bf16 v[128:143], v[32:35], v[16:19], v[128:143]
  ds_read_b64_tr_b16 v[224:225], v12 offset:0
  ds_read_b64_tr_b16 v[226:227], v12 offset:256
  ds_read_b64_tr_b16 v[228:229], v13 offset:0
  v_mfma_f32_32x32x16_bf16 v[144:159], v[32:35], v[20:23], v[144:159]
  ds_read_b64_tr_b16 v[230:231], v13 offset:1536
  v_mfma_f32_32x32x16_bf16 v[160:175], v[16:19], v[36:39], v[160:175]
  v_mfma_f32_32x32x16_bf16 v[176:191], v[20:23], v[36:39], v[176:191]
  s_waitcnt lgkmcnt(0)
  v_mfma_f32_32x32x16_bf16 v[64:79], v[216:219], v[208:211], v[64:79]
  ds_read_b128 v[16:19], v3
  ds_read_b128 v[20:23], v7
  v_mfma_f32_32x32x16_bf16 v[80:95], v[216:219], v[212:215], v[80:95]
  ds_read_b64_tr_b16 v[24:25], v10 offset:6144
  ds_read_b64_tr_b16 v[26:27], v10 offset:7680
  v_mfma_f32_32x32x16_bf16 v[96:111], v[220:223], v[208:211], v[96:111]
  ds_read_b64_tr_b16 v[28:29], v11 offset:6144
  ds_read_b64_tr_b16 v[30:31], v11 offset:7680
  v_mfma_f32_32x32x16_bf16 v[112:127], v[220:223], v[212:215], v[112:127]
  ds_read_b64_tr_b16 v[32:33], v12 offset:1024
  ds_read_b64_tr_b16 v[34:35], v12 offset:1280
  v_mfma_f32_32x32x16_bf16 v[128:143], v[224:227], v[208:211], v[128:143]
  ds_read_b64_tr_b16 v[36:37], v13 offset:6144
  ds_read_b64_tr_b16 v[38:39], v13 offset:7680
  v_mfma_f32_32x32x16_bf16 v[144:159], v[224:227], v[212:215], v[144:159]
  v_mfma_f32_32x32x16_bf16 v[160:175], v[208:211], v[228:231], v[160:175]
  v_mfma_f32_32x32x16_bf16 v[176:191], v[212:215], v[228:231], v[176:191]
  s_waitcnt lgkmcnt(0)
  v_mfma_f32_32x32x16_bf16 v[64:79], v[24:27], v[16:19], v[64:79]
  ds_read_b128 v[208:211], v4
  ds_read_b128 v[212:215], v8
  v_mfma_f32_32x32x16_bf16 v[80:95], v[24:27], v[20:23], v[80:95]
  ds_read_b64_tr_b16 v[216:217], v10 offset:12288
  ds_read_b64_tr_b16 v[218:219], v10 offset:13824
  v_mfma_f32_32x32x16_bf16 v[96:111], v[28:31], v[16:19], v[96:111]
  ds_read_b64_tr_b16 v[220:221], v11 offset:12288
  ds_read_b64_tr_b16 v[222:223], v11 offset:13824
  v_mfma_f32_32x32x16_bf16 v[112:127], v[28:31], v[20:23], v[112:127]
  ds_read_b64_tr_b16 v[224:225], v12 offset:2048
  ds_read_b64_tr_b16 v[226:227], v12 offset:2304
  v_mfma_f32_32x32x16_bf16 v[128:143], v[32:35], v[16:19], v[128:143]
  ds_read_b64_tr_b16 v[228:229], v13 offset:12288
  ds_read_b64_tr_b16 v[230:231], v13 offset:13824
  v_mfma_f32_32x32x16_bf16 v[144:159], v[32:35], v[20:23], v[144:159]
  v_mfma_f32_32x32x16_bf16 v[160:175], v[16:19], v[36:39], v[160:175]
  v_mfma_f32_32x32x16_bf16 v[176:191], v[20:23], v[36:39], v[176:191]
  s_waitcnt lgkmcnt(0)
  v_mfma_f32_32x32x16_bf16 v[64:79], v[216:219], v[208:211], v[64:79]
  ds_read_b128 v[16:19], v5
  ds_read_b128 v[20:23], v9
  v_mfma_f32_32x32x16_bf16 v[80:95], v[216:219], v[212:215], v[80:95]
  ds_read_b64_tr_b16 v[24:25], v10 offset:18432
  ds_read_b64_tr_b16 v[26:27], v10 offset:19968
  v_mfma_f32_32x32x16_bf16 v[96:111], v[220:223], v[208:211], v[96:111]
  ds_read_b64_tr_b16 v[28:29], v11 offset:18432
  ds_read_b64_tr_b16 v[30:31], v11 offset:19968
  v_mfma_f32_32x32x16_bf16 v[112:127], v[220:223], v[212:215], v[112:127]
  ds_read_b64_tr_b16 v[32:33], v12 offset:3072
  ds_read_b64_tr_b16 v[34:35], v12 offset:3328
  v_mfma_f32_32x32x16_bf16 v[128:143], v[224:227], v[208:211], v[128:143]
  ds_read_b64_tr_b16 v[36:37], v13 offset:18432
  ds_read_b64_tr_b16 v[38:39], v13 offset:19968
  v_mfma_f32_32x32x16_bf16 v[144:159], v[224:227], v[212:215], v[144:159]
  v_mfma_f32_32x32x16_bf16 v[160:175], v[208:211], v[228:231], v[160:175]
  v_mfma_f32_32x32x16_bf16 v[176:191], v[212:215], v[228:231], v[176:191]
  s_waitcnt lgkmcnt(0)
  v_mfma_f32_32x32x16_bf16 v[64:79], v[24:27], v[16:19], v[64:79]
  v_add_u32 v2, 53376, v2
  v_add_u32 v3, 53376, v3
  v_add_u32 v4, 53376, v4
  v_add_u32 v5, 53376, v5
  v_add_u32 v6, 53376, v6
  v_add_u32 v7, 53376, v7
  v_add_u32 v8, 53376, v8
  v_mfma_f32_32x32x16_bf16 v[80:95], v[24:27], v[20:23], v[80:95]
  v_add_u32 v9, 53376, v9
  v_add_u32 v10, 53376, v10
  v_add_u32 v11, 53376, v11
  v_add_u32 v12, 53376, v12
  v_add_u32 v13, 53376, v13
  v_add_u32 v14, 53376, v14
  s_barrier
  v_mfma_f32_32x32x16_bf16 v[96:111], v[28:31], v[16:19], v[96:111]
  ds_read_b128 v[208:211], v2
  ds_read_b128 v[212:215], v6
  ds_read_b64_tr_b16 v[216:217], v10 offset:0
  v_mfma_f32_32x32x16_bf16 v[112:127], v[28:31], v[20:23], v[112:127]
  ds_read_b64_tr_b16 v[218:219], v10 offset:1536
  ds_read_b64_tr_b16 v[220:221], v11 offset:0
  ds_read_b64_tr_b16 v[222:223], v11 offset:1536
  v_mfma_f32_32x32x16_bf16 v[128:143], v[32:35], v[16:19], v[128:143]
  ds_read_b64_tr_b16 v[224:225], v12 offset:0
  ds_read_b64_tr_b16 v[226:227], v12 offset:256
  ds_read_b64_tr_b16 v[228:229], v13 offset:0
  v_mfma_f32_32x32x16_bf16 v[144:159], v[32:35], v[20:23], v[144:159]
  ds_read_b64_tr_b16 v[230:231], v13 offset:1536
  v_mfma_f32_32x32x16_bf16 v[160:175], v[16:19], v[36:39], v[160:175]
  v_mfma_f32_32x32x16_bf16 v[176:191], v[20:23], v[36:39], v[176:191]
  s_waitcnt lgkmcnt(0)
  v_mfma_f32_32x32x16_bf16 v[64:79], v[216:219], v[208:211], v[64:79]
  ds_read_b128 v[16:19], v3
  ds_read_b128 v[20:23], v7
  v_mfma_f32_32x32x16_bf16 v[80:95], v[216:219], v[212:215], v[80:95]
  ds_read_b64_tr_b16 v[24:25], v10 offset:6144
  ds_read_b64_tr_b16 v[26:27], v10 offset:7680
  v_mfma_f32_32x32x16_bf16 v[96:111], v[220:223], v[208:211], v[96:111]
  ds_read_b64_tr_b16 v[28:29], v11 offset:6144
  ds_read_b64_tr_b16 v[30:31], v11 offset:7680
  v_mfma_f32_32x32x16_bf16 v[112:127], v[220:223], v[212:215], v[112:127]
  ds_read_b64_tr_b16 v[32:33], v12 offset:1024
  ds_read_b64_tr_b16 v[34:35], v12 offset:1280
  v_mfma_f32_32x32x16_bf16 v[128:143], v[224:227], v[208:211], v[128:143]
  ds_read_b64_tr_b16 v[36:37], v13 offset:6144
  ds_read_b64_tr_b16 v[38:39], v13 offset:7680
  v_mfma_f32_32x32x16_bf16 v[144:159], v[224:227], v[212:215], v[144:159]
  v_mfma_f32_32x32x16_bf16 v[160:175], v[208:211], v[228:231], v[160:175]
  v_mfma_f32_32x32x16_bf16 v[176:191], v[212:215], v[228:231], v[176:191]
  s_waitcnt lgkmcnt(0)
  v_mfma_f32_32x32x16_bf16 v[64:79], v[24:27], v[16:19], v[64:79]
  ds_read_b128 v[208:211], v4
  ds_read_b128 v[212:215], v8
  v_mfma_f32_32x32x16_bf16 v[80:95], v[24:27], v[20:23], v[80:95]
  ds_read_b64_tr_b16 v[216:217], v10 offset:12288
  ds_read_b64_tr_b16 v[218:219], v10 offset:13824
  v_mfma_f32_32x32x16_bf16 v[96:111], v[28:31], v[16:19], v[96:111]
  ds_read_b64_tr_b16 v[220:221], v11 offset:12288
  ds_read_b64_tr_b16 v[222:223], v11 offset:13824
  v_mfma_f32_32x32x16_bf16 v[112:127], v[28:31], v[20:23], v[112:127]
  ds_read_b64_tr_b16 v[224:225], v12 offset:2048
  ds_read_b64_tr_b16 v[226:227], v12 offset:2304
  v_mfma_f32_32x32x16_bf16 v[128:143], v[32:35], v[16:19], v[128:143]
  ds_read_b64_tr_b16 v[228:229], v13 offset:12288
  ds_read_b64_tr_b16 v[230:231], v13 offset:13824
  v_mfma_f32_32x32x16_bf16 v[144:159], v[32:35], v[20:23], v[144:159]
  v_mfma_f32_32x32x16_bf16 v[160:175], v[16:19], v[36:39], v[160:175]
  v_mfma_f32_32x32x16_bf16 v[176:191], v[20:23], v[36:39], v[176:191]
  s_waitcnt lgkmcnt(0)
  v_mfma_f32_32x32x16_bf16 v[64:79], v[216:219], v[208:211], v[64:79]
  ds_read_b128 v[16:19], v5
  ds_read_b128 v[20:23], v9
  v_mfma_f32_32x32x16_bf16 v[80:95], v[216:219], v[212:215], v[80:95]
  ds_read_b64_tr_b16 v[24:25], v10 offset:18432
  ds_read_b64_tr_b16 v[26:27], v10 offset:19968
  v_mfma_f32_32x32x16_bf16 v[96:111], v[220:223], v[208:211], v[96:111]
  ds_read_b64_tr_b16 v[28:29], v11 offset:18432
  ds_read_b64_tr_b16 v[30:31], v11 offset:19968
  v_mfma_f32_32x32x16_bf16 v[112:127], v[220:223], v[212:215], v[112:127]
  ds_read_b64_tr_b16 v[32:33], v12 offset:3072
  ds_read_b64_tr_b16 v[34:35], v12 offset:3328
  v_mfma_f32_32x32x16_bf16 v[128:143], v[224:227], v[208:211], v[128:143]
  ds_read_b64_tr_b16 v[36:37], v13 offset:18432
  ds_read_b64_tr_b16 v[38:39], v13 offset:19968
  v_mfma_f32_32x32x16_bf16 v[144:159], v[224:227], v[212:215], v[144:159]
  v_mfma_f32_32x32x16_bf16 v[160:175], v[208:211], v[228:231], v[160:175]
  v_mfma_f32_32x32x16_bf16 v[176:191], v[212:215], v[228:231], v[176:191]
  s_waitcnt lgkmcnt(0)
  v_mfma_f32_32x32x16_bf16 v[64:79], v[24:27], v[16:19], v[64:79]
  v_subrev_u32 v2, 106752, v2
  v_subrev_u32 v3, 106752, v3
  v_subrev_u32 v4, 106752, v4
  v_subrev_u32 v5, 106752, v5
  v_subrev_u32 v6, 106752, v6
  v_subrev_u32 v7, 106752, v7
  v_subrev_u32 v8, 106752, v8
  v_mfma_f32_32x32x16_bf16 v[80:95], v[24:27], v[20:23], v[80:95]
  v_subrev_u32 v9, 106752, v9
  v_subrev_u32 v10, 106752, v10
  v_subrev_u32 v11, 106752, v11
  v_subrev_u32 v12, 106752, v12
  v_subrev_u32 v13, 106752, v13
  v_subrev_u32 v14, 106752, v14
  s_barrier
  v_mfma_f32_32x32x16_bf16 v[96:111], v[28:31], v[16:19], v[96:111]
  ds_read_b128 v[208:211], v2
  ds_read_b128 v[212:215], v6
  ds_read_b64_tr_b16 v[216:217], v10 offset:0
  v_mfma_f32_32x32x16_bf16 v[112:127], v[28:31], v[20:23], v[112:127]
  ds_read_b64_tr_b16 v[218:219], v10 offset:1536
  ds_read_b64_tr_b16 v[220:221], v11 offset:0
  ds_read_b64_tr_b16 v[222:223], v11 offset:1536
  v_mfma_f32_32x32x16_bf16 v[128:143], v[32:35], v[16:19], v[128:143]
  ds_read_b64_tr_b16 v[224:225], v12 offset:0
  ds_read_b64_tr_b16 v[226:227], v12 offset:256
  ds_read_b64_tr_b16 v[228:229], v13 offset:0
  v_mfma_f32_32x32x16_bf16 v[144:159], v[32:35], v[20:23], v[144:159]
  ds_read_b64_tr_b16 v[230:231], v13 offset:1536
  v_mfma_f32_32x32x16_bf16 v[160:175], v[16:19], v[36:39], v[160:175]
  v_mfma_f32_32x32x16_bf16 v[176:191], v[20:23], v[36:39], v[176:191]
  s_waitcnt lgkmcnt(0)
  v_mfma_f32_32x32x16_bf16 v[64:79], v[216:219], v[208:211], v[64:79]
  ds_read_b128 v[16:19], v3
  ds_read_b128 v[20:23], v7
  v_mfma_f32_32x32x16_bf16 v[80:95], v[216:219], v[212:215], v[80:95]
  ds_read_b64_tr_b16 v[24:25], v10 offset:6144
  ds_read_b64_tr_b16 v[26:27], v10 offset:7680
  v_mfma_f32_32x32x16_bf16 v[96:111], v[220:223], v[208:211], v[96:111]
  ds_read_b64_tr_b16 v[28:29], v11 offset:6144
  ds_read_b64_tr_b16 v[30:31], v11 offset:7680
  v_mfma_f32_32x32x16_bf16 v[112:127], v[220:223], v[212:215], v[112:127]
  ds_read_b64_tr_b16 v[32:33], v12 offset:1024
  ds_read_b64_tr_b16 v[34:35], v12 offset:1280
  v_mfma_f32_32x32x16_bf16 v[128:143], v[224:227], v[208:211], v[128:143]
  ds_read_b64_tr_b16 v[36:37], v13 offset:6144
  ds_read_b64_tr_b16 v[38:39], v13 offset:7680
  v_mfma_f32_32x32x16_bf16 v[144:159], v[224:227], v[212:215], v[144:159]
  v_mfma_f32_32x32x16_bf16 v[160:175], v[208:211], v[228:231], v[160:175]
  v_mfma_f32_32x32x16_bf16 v[176:191], v[212:215], v[228:231], v[176:191]
  s_waitcnt lgkmcnt(0)
  v_mfma_f32_32x32x16_bf16 v[64:79], v[24:27], v[16:19], v[64:79]
  ds_read_b128 v[208:211], v4
  ds_read_b128 v[212:215], v8
  v_mfma_f32_32x32x16_bf16 v[80:95], v[24:27], v[20:23], v[80:95]
  ds_read_b64_tr_b16 v[216:217], v10 offset:12288
  ds_read_b64_tr_b16 v[218:219], v10 offset:13824
  v_mfma_f32_32x32x16_bf16 v[96:111], v[28:31], v[16:19], v[96:111]
  ds_read_b64_tr_b16 v[220:221], v11 offset:12288
  ds_read_b64_tr_b16 v[222:223], v11 offset:13824
  v_mfma_f32_32x32x16_bf16 v[112:127], v[28:31], v[20:23], v[112:127]
  ds_read_b64_tr_b16 v[224:225], v12 offset:2048
  ds_read_b64_tr_b16 v[226:227], v12 offset:2304
  v_mfma_f32_32x32x16_bf16 v[128:143], v[32:35], v[16:19], v[128:143]
  ds_read_b64_tr_b16 v[228:229], v13 offset:12288
  ds_read_b64_tr_b16 v[230:231], v13 offset:13824
  v_mfma_f32_32x32x16_bf16 v[144:159], v[32:35], v[20:23], v[144:159]
  v_mfma_f32_32x32x16_bf16 v[160:175], v[16:19], v[36:39], v[160:175]
  v_mfma_f32_32x32x16_bf16 v[176:191], v[20:23], v[36:39], v[176:191]
  s_waitcnt lgkmcnt(0)
  v_mfma_f32_32x32x16_bf16 v[64:79], v[216:219], v[208:211], v[64:79]
  ds_read_b128 v[16:19], v5
  ds_read_b128 v[20:23], v9
  v_mfma_f32_32x32x16_bf16 v[80:95], v[216:219], v[212:215], v[80:95]
  ds_read_b64_tr_b16 v[24:25], v10 offset:18432
  ds_read_b64_tr_b16 v[26:27], v10 offset:19968
  v_mfma_f32_32x32x16_bf16 v[96:111], v[220:223], v[208:211], v[96:111]
  ds_read_b64_tr_b16 v[28:29], v11 offset:18432
  ds_read_b64_tr_b16 v[30:31], v11 offset:19968
  v_mfma_f32_32x32x16_bf16 v[112:127], v[220:223], v[212:215], v[112:127]
  ds_read_b64_tr_b16 v[32:33], v12 offset:3072
  ds_read_b64_tr_b16 v[34:35], v12 offset:3328
  v_mfma_f32_32x32x16_bf16 v[128:143], v[224:227], v[208:211], v[128:143]
  ds_read_b64_tr_b16 v[36:37], v13 offset:18432
  ds_read_b64_tr_b16 v[38:39], v13 offset:19968
  v_mfma_f32_32x32x16_bf16 v[144:159], v[224:227], v[212:215], v[144:159]
  v_mfma_f32_32x32x16_bf16 v[160:175], v[208:211], v[228:231], v[160:175]
  v_mfma_f32_32x32x16_bf16 v[176:191], v[212:215], v[228:231], v[176:191]
  s_waitcnt lgkmcnt(0)
  v_mfma_f32_32x32x16_bf16 v[64:79], v[24:27], v[16:19], v[64:79]
  v_add_u32 v2, 53376, v2
  v_add_u32 v3, 53376, v3
  v_add_u32 v4, 53376, v4
  v_add_u32 v5, 53376, v5
  v_add_u32 v6, 53376, v6
  v_add_u32 v7, 53376, v7
  v_add_u32 v8, 53376, v8
  v_mfma_f32_32x32x16_bf16 v[80:95], v[24:27], v[20:23], v[80:95]
  v_add_u32 v9, 53376, v9
  v_add_u32 v10, 53376, v10
  v_add_u32 v11, 53376, v11
  v_add_u32 v12, 53376, v12
  v_add_u32 v13, 53376, v13
  v_add_u32 v14, 53376, v14
  s_barrier
  v_mfma_f32_32x32x16_bf16 v[96:111], v[28:31], v[16:19], v[96:111]
  ds_read_b128 v[208:211], v2
  ds_read_b128 v[212:215], v6
  ds_read_b64_tr_b16 v[216:217], v10 offset:0
  v_mfma_f32_32x32x16_bf16 v[112:127], v[28:31], v[20:23], v[112:127]
  ds_read_b64_tr_b16 v[218:219], v10 offset:1536
  ds_read_b64_tr_b16 v[220:221], v11 offset:0
  ds_read_b64_tr_b16 v[222:223], v11 offset:1536
  v_mfma_f32_32x32x16_bf16 v[128:143], v[32:35], v[16:19], v[128:143]
  ds_read_b64_tr_b16 v[224:225], v12 offset:0
  ds_read_b64_tr_b16 v[226:227], v12 offset:256
  ds_read_b64_tr_b16 v[228:229], v13 offset:0
  v_mfma_f32_32x32x16_bf16 v[144:159], v[32:35], v[20:23], v[144:159]
  ds_read_b64_tr_b16 v[230:231], v13 offset:1536
  v_mfma_f32_32x32x16_bf16 v[160:175], v[16:19], v[36:39], v[160:175]
  v_mfma_f32_32x32x16_bf16 v[176:191], v[20:23], v[36:39], v[176:191]
  s_waitcnt lgkmcnt(0)
  v_mfma_f32_32x32x16_bf16 v[64:79], v[216:219], v[208:211], v[64:79]
  ds_read_b128 v[16:19], v3
  ds_read_b128 v[20:23], v7
  v_mfma_f32_32x32x16_bf16 v[80:95], v[216:219], v[212:215], v[80:95]
  ds_read_b64_tr_b16 v[24:25], v10 offset:6144
  ds_read_b64_tr_b16 v[26:27], v10 offset:7680
  v_mfma_f32_32x32x16_bf16 v[96:111], v[220:223], v[208:211], v[96:111]
  ds_read_b64_tr_b16 v[28:29], v11 offset:6144
  ds_read_b64_tr_b16 v[30:31], v11 offset:7680
  v_mfma_f32_32x32x16_bf16 v[112:127], v[220:223], v[212:215], v[112:127]
  ds_read_b64_tr_b16 v[32:33], v12 offset:1024
  ds_read_b64_tr_b16 v[34:35], v12 offset:1280
  v_mfma_f32_32x32x16_bf16 v[128:143], v[224:227], v[208:211], v[128:143]
  ds_read_b64_tr_b16 v[36:37], v13 offset:6144
  ds_read_b64_tr_b16 v[38:39], v13 offset:7680
  v_mfma_f32_32x32x16_bf16 v[144:159], v[224:227], v[212:215], v[144:159]
  v_mfma_f32_32x32x16_bf16 v[160:175], v[208:211], v[228:231], v[160:175]
  v_mfma_f32_32x32x16_bf16 v[176:191], v[212:215], v[228:231], v[176:191]
  s_waitcnt lgkmcnt(0)
  v_mfma_f32_32x32x16_bf16 v[64:79], v[24:27], v[16:19], v[64:79]
  ds_read_b128 v[208:211], v4
  ds_read_b128 v[212:215], v8
  v_mfma_f32_32x32x16_bf16 v[80:95], v[24:27], v[20:23], v[80:95]
  ds_read_b64_tr_b16 v[216:217], v10 offset:12288
  ds_read_b64_tr_b16 v[218:219], v10 offset:13824
  v_mfma_f32_32x32x16_bf16 v[96:111], v[28:31], v[16:19], v[96:111]
  ds_read_b64_tr_b16 v[220:221], v11 offset:12288
  ds_read_b64_tr_b16 v[222:223], v11 offset:13824
  v_mfma_f32_32x32x16_bf16 v[112:127], v[28:31], v[20:23], v[112:127]
  ds_read_b64_tr_b16 v[224:225], v12 offset:2048
  ds_read_b64_tr_b16 v[226:227], v12 offset:2304
  v_mfma_f32_32x32x16_bf16 v[128:143], v[32:35], v[16:19], v[128:143]
  ds_read_b64_tr_b16 v[228:229], v13 offset:12288
  ds_read_b64_tr_b16 v[230:231], v13 offset:13824
  v_mfma_f32_32x32x16_bf16 v[144:159], v[32:35], v[20:23], v[144:159]
  v_mfma_f32_32x32x16_bf16 v[160:175], v[16:19], v[36:39], v[160:175]
  v_mfma_f32_32x32x16_bf16 v[176:191], v[20:23], v[36:39], v[176:191]
  s_waitcnt lgkmcnt(0)
  v_mfma_f32_32x32x16_bf16 v[64:79], v[216:219], v[208:211], v[64:79]
  ds_read_b128 v[16:19], v5
  ds_read_b128 v[20:23], v9
  v_mfma_f32_32x32x16_bf16 v[80:95], v[216:219], v[212:215], v[80:95]
  ds_read_b64_tr_b16 v[24:25], v10 offset:18432
  ds_read_b64_tr_b16 v[26:27], v10 offset:19968
  v_mfma_f32_32x32x16_bf16 v[96:111], v[220:223], v[208:211], v[96:111]
  ds_read_b64_tr_b16 v[28:29], v11 offset:18432
  ds_read_b64_tr_b16 v[30:31], v11 offset:19968
  v_mfma_f32_32x32x16_bf16 v[112:127], v[220:223], v[212:215], v[112:127]
  ds_read_b64_tr_b16 v[32:33], v12 offset:3072
  ds_read_b64_tr_b16 v[34:35], v12 offset:3328
  v_mfma_f32_32x32x16_bf16 v[128:143], v[224:227], v[208:211], v[128:143]
  ds_read_b64_tr_b16 v[36:37], v13 offset:18432
  ds_read_b64_tr_b16 v[38:39], v13 offset:19968
  v_mfma_f32_32x32x16_bf16 v[144:159], v[224:227], v[212:215], v[144:159]
  v_mfma_f32_32x32x16_bf16 v[160:175], v[208:211], v[228:231], v[160:175]
  v_mfma_f32_32x32x16_bf16 v[176:191], v[212:215], v[228:231], v[176:191]
  s_waitcnt lgkmcnt(0)
  v_mfma_f32_32x32x16_bf16 v[64:79], v[24:27], v[16:19], v[64:79]
  v_add_u32 v2, 53376, v2
  v_add_u32 v3, 53376, v3
  v_add_u32 v4, 53376, v4
  v_add_u32 v5, 53376, v5
  v_add_u32 v6, 53376, v6
  v_add_u32 v7, 53376, v7
  v_add_u32 v8, 53376, v8
  v_mfma_f32_32x32x16_bf16 v[80:95], v[24:27], v[20:23], v[80:95]
  v_add_u32 v9, 53376, v9
  v_add_u32 v10, 53376, v10
  v_add_u32 v11, 53376, v11
  v_add_u32 v12, 53376, v12
  v_add_u32 v13, 53376, v13
  v_add_u32 v14, 53376, v14
  s_barrier
  v_mfma_f32_32x32x16_bf16 v[96:111], v[28:31], v[16:19], v[96:111]
  ds_read_b128 v[208:211], v2
  ds_read_b128 v[212:215], v6
  ds_read_b64_tr_b16 v[216:217], v10 offset:0
  v_mfma_f32_32x32x16_bf16 v[112:127], v[28:31], v[20:23], v[112:127]
  ds_read_b64_tr_b16 v[218:219], v10 offset:1536
  ds_read_b64_tr_b16 v[220:221], v11 offset:0
  ds_read_b64_tr_b16 v[222:223], v11 offset:1536
  v_mfma_f32_32x32x16_bf16 v[128:143], v[32:35], v[16:19], v[128:143]
  ds_read_b64_tr_b16 v[224:225], v12 offset:0
  ds_read_b64_tr_b16 v[226:227], v12 offset:256
  ds_read_b64_tr_b16 v[228:229], v13 offset:0
  v_mfma_f32_32x32x16_bf16 v[144:159], v[32:35], v[20:23], v[144:159]
  ds_read_b64_tr_b16 v[230:231], v13 offset:1536
  v_mfma_f32_32x32x16_bf16 v[160:175], v[16:19], v[36:39], v[160:175]
  v_mfma_f32_32x32x16_bf16 v[176:191], v[20:23], v[36:39], v[176:191]
  s_waitcnt lgkmcnt(0)
  v_mfma_f32_32x32x16_bf16 v[64:79], v[216:219], v[208:211], v[64:79]
  ds_read_b128 v[16:19], v3
  ds_read_b128 v[20:23], v7
  v_mfma_f32_32x32x16_bf16 v[80:95], v[216:219], v[212:215], v[80:95]
  ds_read_b64_tr_b16 v[24:25], v10 offset:6144
  ds_read_b64_tr_b16 v[26:27], v10 offset:7680
  v_mfma_f32_32x32x16_bf16 v[96:111], v[220:223], v[208:211], v[96:111]
  ds_read_b64_tr_b16 v[28:29], v11 offset:6144
  ds_read_b64_tr_b16 v[30:31], v11 offset:7680
  v_mfma_f32_32x32x16_bf16 v[112:127], v[220:223], v[212:215], v[112:127]
  ds_read_b64_tr_b16 v[32:33], v12 offset:1024
  ds_read_b64_tr_b16 v[34:35], v12 offset:1280
  v_mfma_f32_32x32x16_bf16 v[128:143], v[224:227], v[208:211], v[128:143]
  ds_read_b64_tr_b16 v[36:37], v13 offset:6144
  ds_read_b64_tr_b16 v[38:39], v13 offset:7680
  v_mfma_f32_32x32x16_bf16 v[144:159], v[224:227], v[212:215], v[144:159]
  v_mfma_f32_32x32x16_bf16 v[160:175], v[208:211], v[228:231], v[160:175]
  v_mfma_f32_32x32x16_bf16 v[176:191], v[212:215], v[228:231], v[176:191]
  s_waitcnt lgkmcnt(0)
  v_mfma_f32_32x32x16_bf16 v[64:79], v[24:27], v[16:19], v[64:79]
  ds_read_b128 v[208:211], v4
  ds_read_b128 v[212:215], v8
  v_mfma_f32_32x32x16_bf16 v[80:95], v[24:27], v[20:23], v[80:95]
  ds_read_b64_tr_b16 v[216:217], v10 offset:12288
  ds_read_b64_tr_b16 v[218:219], v10 offset:13824
  v_mfma_f32_32x32x16_bf16 v[96:111], v[28:31], v[16:19], v[96:111]
  ds_read_b64_tr_b16 v[220:221], v11 offset:12288
  ds_read_b64_tr_b16 v[222:223], v11 offset:13824
  v_mfma_f32_32x32x16_bf16 v[112:127], v[28:31], v[20:23], v[112:127]
  ds_read_b64_tr_b16 v[224:225], v12 offset:2048
  ds_read_b64_tr_b16 v[226:227], v12 offset:2304
  v_mfma_f32_32x32x16_bf16 v[128:143], v[32:35], v[16:19], v[128:143]
  ds_read_b64_tr_b16 v[228:229], v13 offset:12288
  ds_read_b64_tr_b16 v[230:231], v13 offset:13824
  v_mfma_f32_32x32x16_bf16 v[144:159], v[32:35], v[20:23], v[144:159]
  v_mfma_f32_32x32x16_bf16 v[160:175], v[16:19], v[36:39], v[160:175]
  v_mfma_f32_32x32x16_bf16 v[176:191], v[20:23], v[36:39], v[176:191]
  s_waitcnt lgkmcnt(0)
  v_mfma_f32_32x32x16_bf16 v[64:79], v[216:219], v[208:211], v[64:79]
  ds_read_b128 v[16:19], v5
  ds_read_b128 v[20:23], v9
  v_mfma_f32_32x32x16_bf16 v[80:95], v[216:219], v[212:215], v[80:95]
  ds_read_b64_tr_b16 v[24:25], v10 offset:18432
  ds_read_b64_tr_b16 v[26:27], v10 offset:19968
  v_mfma_f32_32x32x16_bf16 v[96:111], v[220:223], v[208:211], v[96:111]
  ds_read_b64_tr_b16 v[28:29], v11 offset:18432
  ds_read_b64_tr_b16 v[30:31], v11 offset:19968
  v_mfma_f32_32x32x16_bf16 v[112:127], v[220:223], v[212:215], v[112:127]
  ds_read_b64_tr_b16 v[32:33], v12 offset:3072
  ds_read_b64_tr_b16 v[34:35], v12 offset:3328
  v_mfma_f32_32x32x16_bf16 v[128:143], v[224:227], v[208:211], v[128:143]
  ds_read_b64_tr_b16 v[36:37], v13 offset:18432
  ds_read_b64_tr_b16 v[38:39], v13 offset:19968
  v_mfma_f32_32x32x16_bf16 v[144:159], v[224:227], v[212:215], v[144:159]
  v_mfma_f32_32x32x16_bf16 v[160:175], v[208:211], v[228:231], v[160:175]
  v_mfma_f32_32x32x16_bf16 v[176:191], v[212:215], v[228:231], v[176:191]
  s_waitcnt lgkmcnt(0)
  v_mfma_f32_32x32x16_bf16 v[64:79], v[24:27], v[16:19], v[64:79]
  v_subrev_u32 v2, 106752, v2
  v_subrev_u32 v3, 106752, v3
  v_subrev_u32 v4, 106752, v4
  v_subrev_u32 v5, 106752, v5
  v_subrev_u32 v6, 106752, v6
  v_subrev_u32 v7, 106752, v7
  v_subrev_u32 v8, 106752, v8
  v_mfma_f32_32x32x16_bf16 v[80:95], v[24:27], v[20:23], v[80:95]
  v_subrev_u32 v9, 106752, v9
  v_subrev_u32 v10, 106752, v10
  v_subrev_u32 v11, 106752, v11
  v_subrev_u32 v12, 106752, v12
  v_subrev_u32 v13, 106752, v13
  v_subrev_u32 v14, 106752, v14
  s_barrier
  v_mfma_f32_32x32x16_bf16 v[96:111], v[28:31], v[16:19], v[96:111]
  ds_read_b128 v[208:211], v2
  ds_read_b128 v[212:215], v6
  ds_read_b64_tr_b16 v[216:217], v10 offset:0
  v_mfma_f32_32x32x16_bf16 v[112:127], v[28:31], v[20:23], v[112:127]
  ds_read_b64_tr_b16 v[218:219], v10 offset:1536
  ds_read_b64_tr_b16 v[220:221], v11 offset:0
  ds_read_b64_tr_b16 v[222:223], v11 offset:1536
  v_mfma_f32_32x32x16_bf16 v[128:143], v[32:35], v[16:19], v[128:143]
  ds_read_b64_tr_b16 v[224:225], v12 offset:0
  ds_read_b64_tr_b16 v[226:227], v12 offset:256
  ds_read_b64_tr_b16 v[228:229], v13 offset:0
  v_mfma_f32_32x32x16_bf16 v[144:159], v[32:35], v[20:23], v[144:159]
  ds_read_b64_tr_b16 v[230:231], v13 offset:1536
  v_mfma_f32_32x32x16_bf16 v[160:175], v[16:19], v[36:39], v[160:175]
  v_mfma_f32_32x32x16_bf16 v[176:191], v[20:23], v[36:39], v[176:191]
  s_waitcnt lgkmcnt(0)
  v_mfma_f32_32x32x16_bf16 v[64:79], v[216:219], v[208:211], v[64:79]
  ds_read_b128 v[16:19], v3
  ds_read_b128 v[20:23], v7
  v_mfma_f32_32x32x16_bf16 v[80:95], v[216:219], v[212:215], v[80:95]
  ds_read_b64_tr_b16 v[24:25], v10 offset:6144
  ds_read_b64_tr_b16 v[26:27], v10 offset:7680
  v_mfma_f32_32x32x16_bf16 v[96:111], v[220:223], v[208:211], v[96:111]
  ds_read_b64_tr_b16 v[28:29], v11 offset:6144
  ds_read_b64_tr_b16 v[30:31], v11 offset:7680
  v_mfma_f32_32x32x16_bf16 v[112:127], v[220:223], v[212:215], v[112:127]
  ds_read_b64_tr_b16 v[32:33], v12 offset:1024
  ds_read_b64_tr_b16 v[34:35], v12 offset:1280
  v_mfma_f32_32x32x16_bf16 v[128:143], v[224:227], v[208:211], v[128:143]
  ds_read_b64_tr_b16 v[36:37], v13 offset:6144
  ds_read_b64_tr_b16 v[38:39], v13 offset:7680
  v_mfma_f32_32x32x16_bf16 v[144:159], v[224:227], v[212:215], v[144:159]
  v_mfma_f32_32x32x16_bf16 v[160:175], v[208:211], v[228:231], v[160:175]
  v_mfma_f32_32x32x16_bf16 v[176:191], v[212:215], v[228:231], v[176:191]
  s_waitcnt lgkmcnt(0)
  v_mfma_f32_32x32x16_bf16 v[64:79], v[24:27], v[16:19], v[64:79]
  ds_read_b128 v[208:211], v4
  ds_read_b128 v[212:215], v8
  v_mfma_f32_32x32x16_bf16 v[80:95], v[24:27], v[20:23], v[80:95]
  ds_read_b64_tr_b16 v[216:217], v10 offset:12288
  ds_read_b64_tr_b16 v[218:219], v10 offset:13824
  v_mfma_f32_32x32x16_bf16 v[96:111], v[28:31], v[16:19], v[96:111]
  ds_read_b64_tr_b16 v[220:221], v11 offset:12288
  ds_read_b64_tr_b16 v[222:223], v11 offset:13824
  v_mfma_f32_32x32x16_bf16 v[112:127], v[28:31], v[20:23], v[112:127]
  ds_read_b64_tr_b16 v[224:225], v12 offset:2048
  ds_read_b64_tr_b16 v[226:227], v12 offset:2304
  v_mfma_f32_32x32x16_bf16 v[128:143], v[32:35], v[16:19], v[128:143]
  ds_read_b64_tr_b16 v[228:229], v13 offset:12288
  ds_read_b64_tr_b16 v[230:231], v13 offset:13824
  v_mfma_f32_32x32x16_bf16 v[144:159], v[32:35], v[20:23], v[144:159]
  v_mfma_f32_32x32x16_bf16 v[160:175], v[16:19], v[36:39], v[160:175]
  v_mfma_f32_32x32x16_bf16 v[176:191], v[20:23], v[36:39], v[176:191]
  s_waitcnt lgkmcnt(0)
  v_mfma_f32_32x32x16_bf16 v[64:79], v[216:219], v[208:211], v[64:79]
  ds_read_b128 v[16:19], v5
  ds_read_b128 v[20:23], v9
  v_mfma_f32_32x32x16_bf16 v[80:95], v[216:219], v[212:215], v[80:95]
  ds_read_b64_tr_b16 v[24:25], v10 offset:18432
  ds_read_b64_tr_b16 v[26:27], v10 offset:19968
  v_mfma_f32_32x32x16_bf16 v[96:111], v[220:223], v[208:211], v[96:111]
  ds_read_b64_tr_b16 v[28:29], v11 offset:18432
  ds_read_b64_tr_b16 v[30:31], v11 offset:19968
  v_mfma_f32_32x32x16_bf16 v[112:127], v[220:223], v[212:215], v[112:127]
  ds_read_b64_tr_b16 v[32:33], v12 offset:3072
  ds_read_b64_tr_b16 v[34:35], v12 offset:3328
  v_mfma_f32_32x32x16_bf16 v[128:143], v[224:227], v[208:211], v[128:143]
  ds_read_b64_tr_b16 v[36:37], v13 offset:18432
  ds_read_b64_tr_b16 v[38:39], v13 offset:19968
  v_mfma_f32_32x32x16_bf16 v[144:159], v[224:227], v[212:215], v[144:159]
  v_mfma_f32_32x32x16_bf16 v[160:175], v[208:211], v[228:231], v[160:175]
  v_mfma_f32_32x32x16_bf16 v[176:191], v[212:215], v[228:231], v[176:191]
  s_waitcnt lgkmcnt(0)
  v_mfma_f32_32x32x16_bf16 v[64:79], v[24:27], v[16:19], v[64:79]
  v_add_u32 v2, 53376, v2
  v_add_u32 v3, 53376, v3
  v_add_u32 v4, 53376, v4
  v_add_u32 v5, 53376, v5
  v_add_u32 v6, 53376, v6
  v_add_u32 v7, 53376, v7
  v_add_u32 v8, 53376, v8
  v_mfma_f32_32x32x16_bf16 v[80:95], v[24:27], v[20:23], v[80:95]
  v_add_u32 v9, 53376, v9
  v_add_u32 v10, 53376, v10
  v_add_u32 v11, 53376, v11
  v_add_u32 v12, 53376, v12
  v_add_u32 v13, 53376, v13
  v_add_u32 v14, 53376, v14
  s_barrier
  v_mfma_f32_32x32x16_bf16 v[96:111], v[28:31], v[16:19], v[96:111]
  ds_read_b128 v[208:211], v2
  ds_read_b128 v[212:215], v6
  ds_read_b64_tr_b16 v[216:217], v10 offset:0
  v_mfma_f32_32x32x16_bf16 v[112:127], v[28:31], v[20:23], v[112:127]
  ds_read_b64_tr_b16 v[218:219], v10 offset:1536
  ds_read_b64_tr_b16 v[220:221], v11 offset:0
  ds_read_b64_tr_b16 v[222:223], v11 offset:1536
  v_mfma_f32_32x32x16_bf16 v[128:143], v[32:35], v[16:19], v[128:143]
  ds_read_b64_tr_b16 v[224:225], v12 offset:0
  ds_read_b64_tr_b16 v[226:227], v12 offset:256
  ds_read_b64_tr_b16 v[228:229], v13 offset:0
  v_mfma_f32_32x32x16_bf16 v[144:159], v[32:35], v[20:23], v[144:159]
  ds_read_b64_tr_b16 v[230:231], v13 offset:1536
  v_mfma_f32_32x32x16_bf16 v[160:175], v[16:19], v[36:39], v[160:175]
  v_mfma_f32_32x32x16_bf16 v[176:191], v[20:23], v[36:39], v[176:191]
  s_waitcnt lgkmcnt(0)
  v_mfma_f32_32x32x16_bf16 v[64:79], v[216:219], v[208:211], v[64:79]
  ds_read_b128 v[16:19], v3
  ds_read_b128 v[20:23], v7
  v_mfma_f32_32x32x16_bf16 v[80:95], v[216:219], v[212:215], v[80:95]
  ds_read_b64_tr_b16 v[24:25], v10 offset:6144
  ds_read_b64_tr_b16 v[26:27], v10 offset:7680
  v_mfma_f32_32x32x16_bf16 v[96:111], v[220:223], v[208:211], v[96:111]
  ds_read_b64_tr_b16 v[28:29], v11 offset:6144
  ds_read_b64_tr_b16 v[30:31], v11 offset:7680
  v_mfma_f32_32x32x16_bf16 v[112:127], v[220:223], v[212:215], v[112:127]
  ds_read_b64_tr_b16 v[32:33], v12 offset:1024
  ds_read_b64_tr_b16 v[34:35], v12 offset:1280
  v_mfma_f32_32x32x16_bf16 v[128:143], v[224:227], v[208:211], v[128:143]
  ds_read_b64_tr_b16 v[36:37], v13 offset:6144
  ds_read_b64_tr_b16 v[38:39], v13 offset:7680
  v_mfma_f32_32x32x16_bf16 v[144:159], v[224:227], v[212:215], v[144:159]
  v_mfma_f32_32x32x16_bf16 v[160:175], v[208:211], v[228:231], v[160:175]
  v_mfma_f32_32x32x16_bf16 v[176:191], v[212:215], v[228:231], v[176:191]
  s_waitcnt lgkmcnt(0)
  v_mfma_f32_32x32x16_bf16 v[64:79], v[24:27], v[16:19], v[64:79]
  ds_read_b128 v[208:211], v4
  ds_read_b128 v[212:215], v8
  v_mfma_f32_32x32x16_bf16 v[80:95], v[24:27], v[20:23], v[80:95]
  ds_read_b64_tr_b16 v[216:217], v10 offset:12288
  ds_read_b64_tr_b16 v[218:219], v10 offset:13824
  v_mfma_f32_32x32x16_bf16 v[96:111], v[28:31], v[16:19], v[96:111]
  ds_read_b64_tr_b16 v[220:221], v11 offset:12288
  ds_read_b64_tr_b16 v[222:223], v11 offset:13824
  v_mfma_f32_32x32x16_bf16 v[112:127], v[28:31], v[20:23], v[112:127]
  ds_read_b64_tr_b16 v[224:225], v12 offset:2048
  ds_read_b64_tr_b16 v[226:227], v12 offset:2304
  v_mfma_f32_32x32x16_bf16 v[128:143], v[32:35], v[16:19], v[128:143]
  ds_read_b64_tr_b16 v[228:229], v13 offset:12288
  ds_read_b64_tr_b16 v[230:231], v13 offset:13824
  v_mfma_f32_32x32x16_bf16 v[144:159], v[32:35], v[20:23], v[144:159]
  v_mfma_f32_32x32x16_bf16 v[160:175], v[16:19], v[36:39], v[160:175]
  v_mfma_f32_32x32x16_bf16 v[176:191], v[20:23], v[36:39], v[176:191]
  s_waitcnt lgkmcnt(0)
  v_mfma_f32_32x32x16_bf16 v[64:79], v[216:219], v[208:211], v[64:79]
  ds_read_b128 v[16:19], v5
  ds_read_b128 v[20:23], v9
  v_mfma_f32_32x32x16_bf16 v[80:95], v[216:219], v[212:215], v[80:95]
  ds_read_b64_tr_b16 v[24:25], v10 offset:18432
  ds_read_b64_tr_b16 v[26:27], v10 offset:19968
  v_mfma_f32_32x32x16_bf16 v[96:111], v[220:223], v[208:211], v[96:111]
  ds_read_b64_tr_b16 v[28:29], v11 offset:18432
  ds_read_b64_tr_b16 v[30:31], v11 offset:19968
  v_mfma_f32_32x32x16_bf16 v[112:127], v[220:223], v[212:215], v[112:127]
  ds_read_b64_tr_b16 v[32:33], v12 offset:3072
  ds_read_b64_tr_b16 v[34:35], v12 offset:3328
  v_mfma_f32_32x32x16_bf16 v[128:143], v[224:227], v[208:211], v[128:143]
  ds_read_b64_tr_b16 v[36:37], v13 offset:18432
  ds_read_b64_tr_b16 v[38:39], v13 offset:19968
  v_mfma_f32_32x32x16_bf16 v[144:159], v[224:227], v[212:215], v[144:159]
  v_mfma_f32_32x32x16_bf16 v[160:175], v[208:211], v[228:231], v[160:175]
  v_mfma_f32_32x32x16_bf16 v[176:191], v[212:215], v[228:231], v[176:191]
  s_waitcnt lgkmcnt(0)
  s_barrier
  v_mfma_f32_32x32x16_bf16 v[64:79], v[24:27], v[16:19], v[64:79]
  v_mfma_f32_32x32x16_bf16 v[80:95], v[24:27], v[20:23], v[80:95]
  v_mfma_f32_32x32x16_bf16 v[96:111], v[28:31], v[16:19], v[96:111]
  v_mfma_f32_32x32x16_bf16 v[112:127], v[28:31], v[20:23], v[112:127]
  v_mfma_f32_32x32x16_bf16 v[128:143], v[32:35], v[16:19], v[128:143]
  v_mfma_f32_32x32x16_bf16 v[144:159], v[32:35], v[20:23], v[144:159]
  v_mfma_f32_32x32x16_bf16 v[160:175], v[16:19], v[36:39], v[160:175]
  v_mfma_f32_32x32x16_bf16 v[176:191], v[20:23], v[36:39], v[176:191]
  s_mov_b32 s44, s8
  s_mov_b32 s45, s9
  s_mov_b32 s46, 0x1500000
  s_mov_b32 s47, 0x20000

  s_nop 3
  v_lshlrev_b32 v2, 4, v0
  s_lshl_b32 s36, s26, 2
  s_add_u32 s37, s36, s32
  s_add_u32 s38, s36, s33
  v_and_b32 v3, 15, v0
  v_lshlrev_b32 v3, 4, v3
  v_lshrrev_b32 v4, 5, v0
  v_lshl_add_u32 v3, v4, 8, v3
  v_lshrrev_b32 v4, 4, v0
  v_and_b32 v4, 1, v4
  v_lshl_add_u32 v3, v4, 16, v3
  s_mul_i32 s50, s32, 9216
  s_mul_i32 s51, s33, 9216
  s_add_u32 s50, s50, 65536
  s_add_u32 s51, s51, 65536
  v_add_u32 v224, s50, v2
  v_add_u32 v225, s51, v2
  v_mov_b32 v56, 0x3eb8aa3b
  v_mov_b32 v57, 0x3eb8aa3b
  s_lshl_b32 s39, s27, 2
  s_lshl_b32 s40, s31, 1
  s_add_u32 s39, s39, s40
  s_lshl_b32 s39, s39, 6
  s_add_u32 s40, s39, s37
  s_lshl_b32 s40, s40, 10
  s_add_u32 s41, s39, s38
  s_lshl_b32 s41, s41, 10
  v_cvt_pk_bf16_f32 v16, v96, v97
  v_cvt_pk_bf16_f32 v17, v98, v99
  v_cvt_pk_bf16_f32 v18, v100, v101
  v_cvt_pk_bf16_f32 v19, v102, v103
  v_cvt_pk_bf16_f32 v20, v104, v105
  v_cvt_pk_bf16_f32 v21, v106, v107
  v_cvt_pk_bf16_f32 v22, v108, v109
  v_cvt_pk_bf16_f32 v23, v110, v111
  s_add_u32 s42, s40, 0x300000
  s_add_u32 s43, s42, 65536
  buffer_store_dwordx4 v[16:19], v2, s[44:47], s42 offen sc1
  buffer_store_dwordx4 v[20:23], v2, s[44:47], s43 offen sc1
  v_cvt_pk_bf16_f32 v24, v112, v113
  v_cvt_pk_bf16_f32 v25, v114, v115
  v_cvt_pk_bf16_f32 v26, v116, v117
  v_cvt_pk_bf16_f32 v27, v118, v119
  v_cvt_pk_bf16_f32 v28, v120, v121
  v_cvt_pk_bf16_f32 v29, v122, v123
  v_cvt_pk_bf16_f32 v30, v124, v125
  v_cvt_pk_bf16_f32 v31, v126, v127
  s_add_u32 s42, s41, 0x300000
  s_add_u32 s43, s42, 65536
  buffer_store_dwordx4 v[24:27], v2, s[44:47], s42 offen sc1
  buffer_store_dwordx4 v[28:31], v2, s[44:47], s43 offen sc1
  v_cvt_pk_bf16_f32 v40, v160, v161
  v_cvt_pk_bf16_f32 v41, v162, v163
  v_cvt_pk_bf16_f32 v42, v164, v165
  v_cvt_pk_bf16_f32 v43, v166, v167
  v_cvt_pk_bf16_f32 v44, v168, v169
  v_cvt_pk_bf16_f32 v45, v170, v171
  v_cvt_pk_bf16_f32 v46, v172, v173
  v_cvt_pk_bf16_f32 v47, v174, v175
  s_add_u32 s42, s40, 0x500000
  buffer_store_dwordx4 v[40:43], v3, s[44:47], s42 offen sc1
  buffer_store_dwordx4 v[44:47], v3, s[44:47], s42 offen offset:512 sc1
  v_cvt_pk_bf16_f32 v48, v176, v177
  v_cvt_pk_bf16_f32 v49, v178, v179
  v_cvt_pk_bf16_f32 v50, v180, v181
  v_cvt_pk_bf16_f32 v51, v182, v183
  v_cvt_pk_bf16_f32 v52, v184, v185
  v_cvt_pk_bf16_f32 v53, v186, v187
  v_cvt_pk_bf16_f32 v54, v188, v189
  v_cvt_pk_bf16_f32 v55, v190, v191
  s_add_u32 s42, s41, 0x500000
  buffer_store_dwordx4 v[48:51], v3, s[44:47], s42 offen sc1
  buffer_store_dwordx4 v[52:55], v3, s[44:47], s42 offen offset:512 sc1
  v_pk_mul_f32 v[64:65], v[64:65], v[56:57]
  v_pk_mul_f32 v[66:67], v[66:67], v[56:57]
  v_pk_mul_f32 v[68:69], v[68:69], v[56:57]
  v_pk_mul_f32 v[70:71], v[70:71], v[56:57]
  v_pk_mul_f32 v[72:73], v[72:73], v[56:57]
  v_pk_mul_f32 v[74:75], v[74:75], v[56:57]
  v_pk_mul_f32 v[76:77], v[76:77], v[56:57]
  v_pk_mul_f32 v[78:79], v[78:79], v[56:57]
  v_cvt_pk_bf16_f32 v32, v64, v65
  v_cvt_pk_bf16_f32 v33, v66, v67
  v_cvt_pk_bf16_f32 v34, v68, v69
  v_cvt_pk_bf16_f32 v35, v70, v71
  v_cvt_pk_bf16_f32 v36, v72, v73
  v_cvt_pk_bf16_f32 v37, v74, v75
  v_cvt_pk_bf16_f32 v38, v76, v77
  v_cvt_pk_bf16_f32 v39, v78, v79
  s_add_u32 s42, s40, 0x100000
  s_add_u32 s43, s42, 65536
  buffer_store_dwordx4 v[32:35], v2, s[44:47], s42 offen sc1
  buffer_store_dwordx4 v[36:39], v2, s[44:47], s43 offen sc1
  v_pk_mul_f32 v[80:81], v[80:81], v[56:57]
  v_pk_mul_f32 v[82:83], v[82:83], v[56:57]
  v_pk_mul_f32 v[84:85], v[84:85], v[56:57]
  v_pk_mul_f32 v[86:87], v[86:87], v[56:57]
  v_pk_mul_f32 v[88:89], v[88:89], v[56:57]
  v_pk_mul_f32 v[90:91], v[90:91], v[56:57]
  v_pk_mul_f32 v[92:93], v[92:93], v[56:57]
  v_pk_mul_f32 v[94:95], v[94:95], v[56:57]
  v_cvt_pk_bf16_f32 v16, v80, v81
  v_cvt_pk_bf16_f32 v17, v82, v83
  v_cvt_pk_bf16_f32 v18, v84, v85
  v_cvt_pk_bf16_f32 v19, v86, v87
  v_cvt_pk_bf16_f32 v20, v88, v89
  v_cvt_pk_bf16_f32 v21, v90, v91
  v_cvt_pk_bf16_f32 v22, v92, v93
  v_cvt_pk_bf16_f32 v23, v94, v95
  s_add_u32 s42, s41, 0x100000
  s_add_u32 s43, s42, 65536
  buffer_store_dwordx4 v[16:19], v2, s[44:47], s42 offen sc1
  buffer_store_dwordx4 v[20:23], v2, s[44:47], s43 offen sc1
  v_mov_b32 v220, 0xbfb8aa3b
  v_mov_b32 v221, 0xbfb8aa3b
  v_mov_b32 v222, 1.0
  v_mov_b32 v223, 1.0
  s_lshl_b32 s34, s31, 10
  v_add_u32 v226, s34, v224
  v_add_u32 v227, s34, v225
  v_pk_mul_f32 v[208:209], v[128:129], v[220:221]
  v_pk_mul_f32 v[210:211], v[130:131], v[220:221]
  v_pk_mul_f32 v[212:213], v[132:133], v[220:221]
  v_pk_mul_f32 v[214:215], v[134:135], v[220:221]
  v_exp_f32 v208, v208
  v_exp_f32 v209, v209
  v_exp_f32 v210, v210
  v_exp_f32 v211, v211
  v_exp_f32 v212, v212
  v_exp_f32 v213, v213
  v_exp_f32 v214, v214
  v_exp_f32 v215, v215
  v_pk_mul_f32 v[136:137], v[128:129], v[136:137]
  v_pk_mul_f32 v[138:139], v[130:131], v[138:139]
  v_pk_mul_f32 v[140:141], v[132:133], v[140:141]
  v_pk_mul_f32 v[142:143], v[134:135], v[142:143]
  v_pk_add_f32 v[208:209], v[208:209], v[222:223]
  v_pk_add_f32 v[210:211], v[210:211], v[222:223]
  v_pk_add_f32 v[212:213], v[212:213], v[222:223]
  v_pk_add_f32 v[214:215], v[214:215], v[222:223]
  v_rcp_f32 v208, v208
  v_rcp_f32 v209, v209
  v_rcp_f32 v210, v210
  v_rcp_f32 v211, v211
  v_rcp_f32 v212, v212
  v_rcp_f32 v213, v213
  v_rcp_f32 v214, v214
  v_rcp_f32 v215, v215
  s_nop 0
  v_pk_mul_f32 v[208:209], v[136:137], v[208:209]
  v_pk_mul_f32 v[210:211], v[138:139], v[210:211]
  v_pk_mul_f32 v[212:213], v[140:141], v[212:213]
  v_pk_mul_f32 v[214:215], v[142:143], v[214:215]
  v_cvt_pk_bf16_f32 v216, v208, v209
  v_cvt_pk_bf16_f32 v217, v210, v211
  v_cvt_pk_bf16_f32 v218, v212, v213
  v_cvt_pk_bf16_f32 v219, v214, v215
  ds_write_b128 v226, v[216:219] offset:0
  v_pk_mul_f32 v[208:209], v[144:145], v[220:221]
  v_pk_mul_f32 v[210:211], v[146:147], v[220:221]
  v_pk_mul_f32 v[212:213], v[148:149], v[220:221]
  v_pk_mul_f32 v[214:215], v[150:151], v[220:221]
  v_exp_f32 v208, v208
  v_exp_f32 v209, v209
  v_exp_f32 v210, v210
  v_exp_f32 v211, v211
  v_exp_f32 v212, v212
  v_exp_f32 v213, v213
  v_exp_f32 v214, v214
  v_exp_f32 v215, v215
  v_pk_mul_f32 v[152:153], v[144:145], v[152:153]
  v_pk_mul_f32 v[154:155], v[146:147], v[154:155]
  v_pk_mul_f32 v[156:157], v[148:149], v[156:157]
  v_pk_mul_f32 v[158:159], v[150:151], v[158:159]
  v_pk_add_f32 v[208:209], v[208:209], v[222:223]
  v_pk_add_f32 v[210:211], v[210:211], v[222:223]
  v_pk_add_f32 v[212:213], v[212:213], v[222:223]
  v_pk_add_f32 v[214:215], v[214:215], v[222:223]
  v_rcp_f32 v208, v208
  v_rcp_f32 v209, v209
  v_rcp_f32 v210, v210
  v_rcp_f32 v211, v211
  v_rcp_f32 v212, v212
  v_rcp_f32 v213, v213
  v_rcp_f32 v214, v214
  v_rcp_f32 v215, v215
  s_nop 0
  v_pk_mul_f32 v[208:209], v[152:153], v[208:209]
  v_pk_mul_f32 v[210:211], v[154:155], v[210:211]
  v_pk_mul_f32 v[212:213], v[156:157], v[212:213]
  v_pk_mul_f32 v[214:215], v[158:159], v[214:215]
  v_cvt_pk_bf16_f32 v216, v208, v209
  v_cvt_pk_bf16_f32 v217, v210, v211
  v_cvt_pk_bf16_f32 v218, v212, v213
  v_cvt_pk_bf16_f32 v219, v214, v215
  ds_write_b128 v227, v[216:219] offset:0
  s_branch gated_mix__mha_block__swiglu_ffn__prompt_kernel_cdone
gated_mix__mha_block__swiglu_ffn__prompt_kernel_cB:
  v_mul_u32_u24 v56, 288, v53
  v_mul_u32_u24 v55, 18560, v50
  v_add3_u32 v56, v56, v55, v54
  v_add_u32 v56, 16384, v56
  s_lshl_b32 s34, s31, 7
  v_add_u32 v55, s34, v56
  v_add_u32 v10, 0, v55
  v_add_u32 v11, 32, v55
  v_add_u32 v12, 64, v55
  v_add_u32 v13, 96, v55
  v_add_u32 v14, 256, v56
  s_barrier
  ds_read_b128 v[208:211], v2
  ds_read_b128 v[212:215], v6
  ds_read_b64_tr_b16 v[216:217], v10 offset:0
  ds_read_b64_tr_b16 v[218:219], v10 offset:1152
  ds_read_b64_tr_b16 v[220:221], v11 offset:0
  ds_read_b64_tr_b16 v[222:223], v11 offset:1152
  ds_read_b64_tr_b16 v[224:225], v12 offset:0
  ds_read_b64_tr_b16 v[226:227], v12 offset:1152
  ds_read_b64_tr_b16 v[228:229], v13 offset:0
  ds_read_b64_tr_b16 v[230:231], v13 offset:1152
  ds_read_b64_tr_b16 v[232:233], v14 offset:0
  ds_read_b64_tr_b16 v[234:235], v14 offset:1152
  s_waitcnt lgkmcnt(0)
  v_mfma_f32_32x32x16_bf16 v[64:79], v[216:219], v[208:211], v[64:79]
  ds_read_b128 v[16:19], v3
  ds_read_b128 v[20:23], v7
  v_mfma_f32_32x32x16_bf16 v[80:95], v[216:219], v[212:215], v[80:95]
  ds_read_b64_tr_b16 v[24:25], v10 offset:4608
  ds_read_b64_tr_b16 v[26:27], v10 offset:5760
  v_mfma_f32_32x32x16_bf16 v[96:111], v[220:223], v[208:211], v[96:111]
  ds_read_b64_tr_b16 v[28:29], v11 offset:4608
  ds_read_b64_tr_b16 v[30:31], v11 offset:5760
  v_mfma_f32_32x32x16_bf16 v[112:127], v[220:223], v[212:215], v[112:127]
  ds_read_b64_tr_b16 v[32:33], v12 offset:4608
  ds_read_b64_tr_b16 v[34:35], v12 offset:5760
  v_mfma_f32_32x32x16_bf16 v[128:143], v[224:227], v[208:211], v[128:143]
  ds_read_b64_tr_b16 v[36:37], v13 offset:4608
  ds_read_b64_tr_b16 v[38:39], v13 offset:5760
  v_mfma_f32_32x32x16_bf16 v[144:159], v[224:227], v[212:215], v[144:159]
  ds_read_b64_tr_b16 v[40:41], v14 offset:4608
  ds_read_b64_tr_b16 v[42:43], v14 offset:5760
  v_mfma_f32_32x32x16_bf16 v[160:175], v[228:231], v[208:211], v[160:175]
  v_mfma_f32_32x32x16_bf16 v[176:191], v[228:231], v[212:215], v[176:191]
  v_mfma_f32_32x32x16_bf16 v[192:207], v[232:235], v[208:211], v[192:207]
  s_waitcnt lgkmcnt(0)
  v_mfma_f32_32x32x16_bf16 v[64:79], v[24:27], v[16:19], v[64:79]
  ds_read_b128 v[208:211], v4
  ds_read_b128 v[212:215], v8
  v_mfma_f32_32x32x16_bf16 v[80:95], v[24:27], v[20:23], v[80:95]
  ds_read_b64_tr_b16 v[216:217], v10 offset:9216
  ds_read_b64_tr_b16 v[218:219], v10 offset:10368
  v_mfma_f32_32x32x16_bf16 v[96:111], v[28:31], v[16:19], v[96:111]
  ds_read_b64_tr_b16 v[220:221], v11 offset:9216
  ds_read_b64_tr_b16 v[222:223], v11 offset:10368
  v_mfma_f32_32x32x16_bf16 v[112:127], v[28:31], v[20:23], v[112:127]
  ds_read_b64_tr_b16 v[224:225], v12 offset:9216
  ds_read_b64_tr_b16 v[226:227], v12 offset:10368
  v_mfma_f32_32x32x16_bf16 v[128:143], v[32:35], v[16:19], v[128:143]
  ds_read_b64_tr_b16 v[228:229], v13 offset:9216
  ds_read_b64_tr_b16 v[230:231], v13 offset:10368
  v_mfma_f32_32x32x16_bf16 v[144:159], v[32:35], v[20:23], v[144:159]
  ds_read_b64_tr_b16 v[232:233], v14 offset:9216
  ds_read_b64_tr_b16 v[234:235], v14 offset:10368
  v_mfma_f32_32x32x16_bf16 v[160:175], v[36:39], v[16:19], v[160:175]
  v_mfma_f32_32x32x16_bf16 v[176:191], v[36:39], v[20:23], v[176:191]
  v_mfma_f32_32x32x16_bf16 v[192:207], v[40:43], v[16:19], v[192:207]
  s_waitcnt lgkmcnt(0)
  v_mfma_f32_32x32x16_bf16 v[64:79], v[216:219], v[208:211], v[64:79]
  ds_read_b128 v[16:19], v5
  ds_read_b128 v[20:23], v9
  v_mfma_f32_32x32x16_bf16 v[80:95], v[216:219], v[212:215], v[80:95]
  ds_read_b64_tr_b16 v[24:25], v10 offset:13824
  ds_read_b64_tr_b16 v[26:27], v10 offset:14976
  v_mfma_f32_32x32x16_bf16 v[96:111], v[220:223], v[208:211], v[96:111]
  ds_read_b64_tr_b16 v[28:29], v11 offset:13824
  ds_read_b64_tr_b16 v[30:31], v11 offset:14976
  v_mfma_f32_32x32x16_bf16 v[112:127], v[220:223], v[212:215], v[112:127]
  ds_read_b64_tr_b16 v[32:33], v12 offset:13824
  ds_read_b64_tr_b16 v[34:35], v12 offset:14976
  v_mfma_f32_32x32x16_bf16 v[128:143], v[224:227], v[208:211], v[128:143]
  ds_read_b64_tr_b16 v[36:37], v13 offset:13824
  ds_read_b64_tr_b16 v[38:39], v13 offset:14976
  v_mfma_f32_32x32x16_bf16 v[144:159], v[224:227], v[212:215], v[144:159]
  ds_read_b64_tr_b16 v[40:41], v14 offset:13824
  ds_read_b64_tr_b16 v[42:43], v14 offset:14976
  v_mfma_f32_32x32x16_bf16 v[160:175], v[228:231], v[208:211], v[160:175]
  v_mfma_f32_32x32x16_bf16 v[176:191], v[228:231], v[212:215], v[176:191]
  v_mfma_f32_32x32x16_bf16 v[192:207], v[232:235], v[208:211], v[192:207]
  s_waitcnt lgkmcnt(0)
  v_mfma_f32_32x32x16_bf16 v[64:79], v[24:27], v[16:19], v[64:79]
  v_add_u32 v2, 53376, v2
  v_add_u32 v3, 53376, v3
  v_add_u32 v4, 53376, v4
  v_add_u32 v5, 53376, v5
  v_add_u32 v6, 53376, v6
  v_add_u32 v7, 53376, v7
  v_add_u32 v8, 53376, v8
  v_mfma_f32_32x32x16_bf16 v[80:95], v[24:27], v[20:23], v[80:95]
  v_add_u32 v9, 53376, v9
  v_add_u32 v10, 53376, v10
  v_add_u32 v11, 53376, v11
  v_add_u32 v12, 53376, v12
  v_add_u32 v13, 53376, v13
  v_add_u32 v14, 53376, v14
  s_barrier
  v_mfma_f32_32x32x16_bf16 v[96:111], v[28:31], v[16:19], v[96:111]
  ds_read_b128 v[208:211], v2
  ds_read_b128 v[212:215], v6
  ds_read_b64_tr_b16 v[216:217], v10 offset:0
  v_mfma_f32_32x32x16_bf16 v[112:127], v[28:31], v[20:23], v[112:127]
  ds_read_b64_tr_b16 v[218:219], v10 offset:1152
  ds_read_b64_tr_b16 v[220:221], v11 offset:0
  ds_read_b64_tr_b16 v[222:223], v11 offset:1152
  v_mfma_f32_32x32x16_bf16 v[128:143], v[32:35], v[16:19], v[128:143]
  ds_read_b64_tr_b16 v[224:225], v12 offset:0
  ds_read_b64_tr_b16 v[226:227], v12 offset:1152
  ds_read_b64_tr_b16 v[228:229], v13 offset:0
  v_mfma_f32_32x32x16_bf16 v[144:159], v[32:35], v[20:23], v[144:159]
  ds_read_b64_tr_b16 v[230:231], v13 offset:1152
  ds_read_b64_tr_b16 v[232:233], v14 offset:0
  ds_read_b64_tr_b16 v[234:235], v14 offset:1152
  v_mfma_f32_32x32x16_bf16 v[160:175], v[36:39], v[16:19], v[160:175]
  v_mfma_f32_32x32x16_bf16 v[176:191], v[36:39], v[20:23], v[176:191]
  v_mfma_f32_32x32x16_bf16 v[192:207], v[40:43], v[16:19], v[192:207]
  s_waitcnt lgkmcnt(0)
  v_mfma_f32_32x32x16_bf16 v[64:79], v[216:219], v[208:211], v[64:79]
  ds_read_b128 v[16:19], v3
  ds_read_b128 v[20:23], v7
  v_mfma_f32_32x32x16_bf16 v[80:95], v[216:219], v[212:215], v[80:95]
  ds_read_b64_tr_b16 v[24:25], v10 offset:4608
  ds_read_b64_tr_b16 v[26:27], v10 offset:5760
  v_mfma_f32_32x32x16_bf16 v[96:111], v[220:223], v[208:211], v[96:111]
  ds_read_b64_tr_b16 v[28:29], v11 offset:4608
  ds_read_b64_tr_b16 v[30:31], v11 offset:5760
  v_mfma_f32_32x32x16_bf16 v[112:127], v[220:223], v[212:215], v[112:127]
  ds_read_b64_tr_b16 v[32:33], v12 offset:4608
  ds_read_b64_tr_b16 v[34:35], v12 offset:5760
  v_mfma_f32_32x32x16_bf16 v[128:143], v[224:227], v[208:211], v[128:143]
  ds_read_b64_tr_b16 v[36:37], v13 offset:4608
  ds_read_b64_tr_b16 v[38:39], v13 offset:5760
  v_mfma_f32_32x32x16_bf16 v[144:159], v[224:227], v[212:215], v[144:159]
  ds_read_b64_tr_b16 v[40:41], v14 offset:4608
  ds_read_b64_tr_b16 v[42:43], v14 offset:5760
  v_mfma_f32_32x32x16_bf16 v[160:175], v[228:231], v[208:211], v[160:175]
  v_mfma_f32_32x32x16_bf16 v[176:191], v[228:231], v[212:215], v[176:191]
  v_mfma_f32_32x32x16_bf16 v[192:207], v[232:235], v[208:211], v[192:207]
  s_waitcnt lgkmcnt(0)
  v_mfma_f32_32x32x16_bf16 v[64:79], v[24:27], v[16:19], v[64:79]
  ds_read_b128 v[208:211], v4
  ds_read_b128 v[212:215], v8
  v_mfma_f32_32x32x16_bf16 v[80:95], v[24:27], v[20:23], v[80:95]
  ds_read_b64_tr_b16 v[216:217], v10 offset:9216
  ds_read_b64_tr_b16 v[218:219], v10 offset:10368
  v_mfma_f32_32x32x16_bf16 v[96:111], v[28:31], v[16:19], v[96:111]
  ds_read_b64_tr_b16 v[220:221], v11 offset:9216
  ds_read_b64_tr_b16 v[222:223], v11 offset:10368
  v_mfma_f32_32x32x16_bf16 v[112:127], v[28:31], v[20:23], v[112:127]
  ds_read_b64_tr_b16 v[224:225], v12 offset:9216
  ds_read_b64_tr_b16 v[226:227], v12 offset:10368
  v_mfma_f32_32x32x16_bf16 v[128:143], v[32:35], v[16:19], v[128:143]
  ds_read_b64_tr_b16 v[228:229], v13 offset:9216
  ds_read_b64_tr_b16 v[230:231], v13 offset:10368
  v_mfma_f32_32x32x16_bf16 v[144:159], v[32:35], v[20:23], v[144:159]
  ds_read_b64_tr_b16 v[232:233], v14 offset:9216
  ds_read_b64_tr_b16 v[234:235], v14 offset:10368
  v_mfma_f32_32x32x16_bf16 v[160:175], v[36:39], v[16:19], v[160:175]
  v_mfma_f32_32x32x16_bf16 v[176:191], v[36:39], v[20:23], v[176:191]
  v_mfma_f32_32x32x16_bf16 v[192:207], v[40:43], v[16:19], v[192:207]
  s_waitcnt lgkmcnt(0)
  v_mfma_f32_32x32x16_bf16 v[64:79], v[216:219], v[208:211], v[64:79]
  ds_read_b128 v[16:19], v5
  ds_read_b128 v[20:23], v9
  v_mfma_f32_32x32x16_bf16 v[80:95], v[216:219], v[212:215], v[80:95]
  ds_read_b64_tr_b16 v[24:25], v10 offset:13824
  ds_read_b64_tr_b16 v[26:27], v10 offset:14976
  v_mfma_f32_32x32x16_bf16 v[96:111], v[220:223], v[208:211], v[96:111]
  ds_read_b64_tr_b16 v[28:29], v11 offset:13824
  ds_read_b64_tr_b16 v[30:31], v11 offset:14976
  v_mfma_f32_32x32x16_bf16 v[112:127], v[220:223], v[212:215], v[112:127]
  ds_read_b64_tr_b16 v[32:33], v12 offset:13824
  ds_read_b64_tr_b16 v[34:35], v12 offset:14976
  v_mfma_f32_32x32x16_bf16 v[128:143], v[224:227], v[208:211], v[128:143]
  ds_read_b64_tr_b16 v[36:37], v13 offset:13824
  ds_read_b64_tr_b16 v[38:39], v13 offset:14976
  v_mfma_f32_32x32x16_bf16 v[144:159], v[224:227], v[212:215], v[144:159]
  ds_read_b64_tr_b16 v[40:41], v14 offset:13824
  ds_read_b64_tr_b16 v[42:43], v14 offset:14976
  v_mfma_f32_32x32x16_bf16 v[160:175], v[228:231], v[208:211], v[160:175]
  v_mfma_f32_32x32x16_bf16 v[176:191], v[228:231], v[212:215], v[176:191]
  v_mfma_f32_32x32x16_bf16 v[192:207], v[232:235], v[208:211], v[192:207]
  s_waitcnt lgkmcnt(0)
  v_mfma_f32_32x32x16_bf16 v[64:79], v[24:27], v[16:19], v[64:79]
  v_add_u32 v2, 53376, v2
  v_add_u32 v3, 53376, v3
  v_add_u32 v4, 53376, v4
  v_add_u32 v5, 53376, v5
  v_add_u32 v6, 53376, v6
  v_add_u32 v7, 53376, v7
  v_add_u32 v8, 53376, v8
  v_mfma_f32_32x32x16_bf16 v[80:95], v[24:27], v[20:23], v[80:95]
  v_add_u32 v9, 53376, v9
  v_add_u32 v10, 53376, v10
  v_add_u32 v11, 53376, v11
  v_add_u32 v12, 53376, v12
  v_add_u32 v13, 53376, v13
  v_add_u32 v14, 53376, v14
  s_barrier
  v_mfma_f32_32x32x16_bf16 v[96:111], v[28:31], v[16:19], v[96:111]
  ds_read_b128 v[208:211], v2
  ds_read_b128 v[212:215], v6
  ds_read_b64_tr_b16 v[216:217], v10 offset:0
  v_mfma_f32_32x32x16_bf16 v[112:127], v[28:31], v[20:23], v[112:127]
  ds_read_b64_tr_b16 v[218:219], v10 offset:1152
  ds_read_b64_tr_b16 v[220:221], v11 offset:0
  ds_read_b64_tr_b16 v[222:223], v11 offset:1152
  v_mfma_f32_32x32x16_bf16 v[128:143], v[32:35], v[16:19], v[128:143]
  ds_read_b64_tr_b16 v[224:225], v12 offset:0
  ds_read_b64_tr_b16 v[226:227], v12 offset:1152
  ds_read_b64_tr_b16 v[228:229], v13 offset:0
  v_mfma_f32_32x32x16_bf16 v[144:159], v[32:35], v[20:23], v[144:159]
  ds_read_b64_tr_b16 v[230:231], v13 offset:1152
  ds_read_b64_tr_b16 v[232:233], v14 offset:0
  ds_read_b64_tr_b16 v[234:235], v14 offset:1152
  v_mfma_f32_32x32x16_bf16 v[160:175], v[36:39], v[16:19], v[160:175]
  v_mfma_f32_32x32x16_bf16 v[176:191], v[36:39], v[20:23], v[176:191]
  v_mfma_f32_32x32x16_bf16 v[192:207], v[40:43], v[16:19], v[192:207]
  s_waitcnt lgkmcnt(0)
  v_mfma_f32_32x32x16_bf16 v[64:79], v[216:219], v[208:211], v[64:79]
  ds_read_b128 v[16:19], v3
  ds_read_b128 v[20:23], v7
  v_mfma_f32_32x32x16_bf16 v[80:95], v[216:219], v[212:215], v[80:95]
  ds_read_b64_tr_b16 v[24:25], v10 offset:4608
  ds_read_b64_tr_b16 v[26:27], v10 offset:5760
  v_mfma_f32_32x32x16_bf16 v[96:111], v[220:223], v[208:211], v[96:111]
  ds_read_b64_tr_b16 v[28:29], v11 offset:4608
  ds_read_b64_tr_b16 v[30:31], v11 offset:5760
  v_mfma_f32_32x32x16_bf16 v[112:127], v[220:223], v[212:215], v[112:127]
  ds_read_b64_tr_b16 v[32:33], v12 offset:4608
  ds_read_b64_tr_b16 v[34:35], v12 offset:5760
  v_mfma_f32_32x32x16_bf16 v[128:143], v[224:227], v[208:211], v[128:143]
  ds_read_b64_tr_b16 v[36:37], v13 offset:4608
  ds_read_b64_tr_b16 v[38:39], v13 offset:5760
  v_mfma_f32_32x32x16_bf16 v[144:159], v[224:227], v[212:215], v[144:159]
  ds_read_b64_tr_b16 v[40:41], v14 offset:4608
  ds_read_b64_tr_b16 v[42:43], v14 offset:5760
  v_mfma_f32_32x32x16_bf16 v[160:175], v[228:231], v[208:211], v[160:175]
  v_mfma_f32_32x32x16_bf16 v[176:191], v[228:231], v[212:215], v[176:191]
  v_mfma_f32_32x32x16_bf16 v[192:207], v[232:235], v[208:211], v[192:207]
  s_waitcnt lgkmcnt(0)
  v_mfma_f32_32x32x16_bf16 v[64:79], v[24:27], v[16:19], v[64:79]
  ds_read_b128 v[208:211], v4
  ds_read_b128 v[212:215], v8
  v_mfma_f32_32x32x16_bf16 v[80:95], v[24:27], v[20:23], v[80:95]
  ds_read_b64_tr_b16 v[216:217], v10 offset:9216
  ds_read_b64_tr_b16 v[218:219], v10 offset:10368
  v_mfma_f32_32x32x16_bf16 v[96:111], v[28:31], v[16:19], v[96:111]
  ds_read_b64_tr_b16 v[220:221], v11 offset:9216
  ds_read_b64_tr_b16 v[222:223], v11 offset:10368
  v_mfma_f32_32x32x16_bf16 v[112:127], v[28:31], v[20:23], v[112:127]
  ds_read_b64_tr_b16 v[224:225], v12 offset:9216
  ds_read_b64_tr_b16 v[226:227], v12 offset:10368
  v_mfma_f32_32x32x16_bf16 v[128:143], v[32:35], v[16:19], v[128:143]
  ds_read_b64_tr_b16 v[228:229], v13 offset:9216
  ds_read_b64_tr_b16 v[230:231], v13 offset:10368
  v_mfma_f32_32x32x16_bf16 v[144:159], v[32:35], v[20:23], v[144:159]
  ds_read_b64_tr_b16 v[232:233], v14 offset:9216
  ds_read_b64_tr_b16 v[234:235], v14 offset:10368
  v_mfma_f32_32x32x16_bf16 v[160:175], v[36:39], v[16:19], v[160:175]
  v_mfma_f32_32x32x16_bf16 v[176:191], v[36:39], v[20:23], v[176:191]
  v_mfma_f32_32x32x16_bf16 v[192:207], v[40:43], v[16:19], v[192:207]
  s_waitcnt lgkmcnt(0)
  v_mfma_f32_32x32x16_bf16 v[64:79], v[216:219], v[208:211], v[64:79]
  ds_read_b128 v[16:19], v5
  ds_read_b128 v[20:23], v9
  v_mfma_f32_32x32x16_bf16 v[80:95], v[216:219], v[212:215], v[80:95]
  ds_read_b64_tr_b16 v[24:25], v10 offset:13824
  ds_read_b64_tr_b16 v[26:27], v10 offset:14976
  v_mfma_f32_32x32x16_bf16 v[96:111], v[220:223], v[208:211], v[96:111]
  ds_read_b64_tr_b16 v[28:29], v11 offset:13824
  ds_read_b64_tr_b16 v[30:31], v11 offset:14976
  v_mfma_f32_32x32x16_bf16 v[112:127], v[220:223], v[212:215], v[112:127]
  ds_read_b64_tr_b16 v[32:33], v12 offset:13824
  ds_read_b64_tr_b16 v[34:35], v12 offset:14976
  v_mfma_f32_32x32x16_bf16 v[128:143], v[224:227], v[208:211], v[128:143]
  ds_read_b64_tr_b16 v[36:37], v13 offset:13824
  ds_read_b64_tr_b16 v[38:39], v13 offset:14976
  v_mfma_f32_32x32x16_bf16 v[144:159], v[224:227], v[212:215], v[144:159]
  ds_read_b64_tr_b16 v[40:41], v14 offset:13824
  ds_read_b64_tr_b16 v[42:43], v14 offset:14976
  v_mfma_f32_32x32x16_bf16 v[160:175], v[228:231], v[208:211], v[160:175]
  v_mfma_f32_32x32x16_bf16 v[176:191], v[228:231], v[212:215], v[176:191]
  v_mfma_f32_32x32x16_bf16 v[192:207], v[232:235], v[208:211], v[192:207]
  s_waitcnt lgkmcnt(0)
  v_mfma_f32_32x32x16_bf16 v[64:79], v[24:27], v[16:19], v[64:79]
  v_subrev_u32 v2, 106752, v2
  v_subrev_u32 v3, 106752, v3
  v_subrev_u32 v4, 106752, v4
  v_subrev_u32 v5, 106752, v5
  v_subrev_u32 v6, 106752, v6
  v_subrev_u32 v7, 106752, v7
  v_subrev_u32 v8, 106752, v8
  v_mfma_f32_32x32x16_bf16 v[80:95], v[24:27], v[20:23], v[80:95]
  v_subrev_u32 v9, 106752, v9
  v_subrev_u32 v10, 106752, v10
  v_subrev_u32 v11, 106752, v11
  v_subrev_u32 v12, 106752, v12
  v_subrev_u32 v13, 106752, v13
  v_subrev_u32 v14, 106752, v14
  s_barrier
  v_mfma_f32_32x32x16_bf16 v[96:111], v[28:31], v[16:19], v[96:111]
  ds_read_b128 v[208:211], v2
  ds_read_b128 v[212:215], v6
  ds_read_b64_tr_b16 v[216:217], v10 offset:0
  v_mfma_f32_32x32x16_bf16 v[112:127], v[28:31], v[20:23], v[112:127]
  ds_read_b64_tr_b16 v[218:219], v10 offset:1152
  ds_read_b64_tr_b16 v[220:221], v11 offset:0
  ds_read_b64_tr_b16 v[222:223], v11 offset:1152
  v_mfma_f32_32x32x16_bf16 v[128:143], v[32:35], v[16:19], v[128:143]
  ds_read_b64_tr_b16 v[224:225], v12 offset:0
  ds_read_b64_tr_b16 v[226:227], v12 offset:1152
  ds_read_b64_tr_b16 v[228:229], v13 offset:0
  v_mfma_f32_32x32x16_bf16 v[144:159], v[32:35], v[20:23], v[144:159]
  ds_read_b64_tr_b16 v[230:231], v13 offset:1152
  ds_read_b64_tr_b16 v[232:233], v14 offset:0
  ds_read_b64_tr_b16 v[234:235], v14 offset:1152
  v_mfma_f32_32x32x16_bf16 v[160:175], v[36:39], v[16:19], v[160:175]
  v_mfma_f32_32x32x16_bf16 v[176:191], v[36:39], v[20:23], v[176:191]
  v_mfma_f32_32x32x16_bf16 v[192:207], v[40:43], v[16:19], v[192:207]
  s_waitcnt lgkmcnt(0)
  v_mfma_f32_32x32x16_bf16 v[64:79], v[216:219], v[208:211], v[64:79]
  ds_read_b128 v[16:19], v3
  ds_read_b128 v[20:23], v7
  v_mfma_f32_32x32x16_bf16 v[80:95], v[216:219], v[212:215], v[80:95]
  ds_read_b64_tr_b16 v[24:25], v10 offset:4608
  ds_read_b64_tr_b16 v[26:27], v10 offset:5760
  v_mfma_f32_32x32x16_bf16 v[96:111], v[220:223], v[208:211], v[96:111]
  ds_read_b64_tr_b16 v[28:29], v11 offset:4608
  ds_read_b64_tr_b16 v[30:31], v11 offset:5760
  v_mfma_f32_32x32x16_bf16 v[112:127], v[220:223], v[212:215], v[112:127]
  ds_read_b64_tr_b16 v[32:33], v12 offset:4608
  ds_read_b64_tr_b16 v[34:35], v12 offset:5760
  v_mfma_f32_32x32x16_bf16 v[128:143], v[224:227], v[208:211], v[128:143]
  ds_read_b64_tr_b16 v[36:37], v13 offset:4608
  ds_read_b64_tr_b16 v[38:39], v13 offset:5760
  v_mfma_f32_32x32x16_bf16 v[144:159], v[224:227], v[212:215], v[144:159]
  ds_read_b64_tr_b16 v[40:41], v14 offset:4608
  ds_read_b64_tr_b16 v[42:43], v14 offset:5760
  v_mfma_f32_32x32x16_bf16 v[160:175], v[228:231], v[208:211], v[160:175]
  v_mfma_f32_32x32x16_bf16 v[176:191], v[228:231], v[212:215], v[176:191]
  v_mfma_f32_32x32x16_bf16 v[192:207], v[232:235], v[208:211], v[192:207]
  s_waitcnt lgkmcnt(0)
  v_mfma_f32_32x32x16_bf16 v[64:79], v[24:27], v[16:19], v[64:79]
  ds_read_b128 v[208:211], v4
  ds_read_b128 v[212:215], v8
  v_mfma_f32_32x32x16_bf16 v[80:95], v[24:27], v[20:23], v[80:95]
  ds_read_b64_tr_b16 v[216:217], v10 offset:9216
  ds_read_b64_tr_b16 v[218:219], v10 offset:10368
  v_mfma_f32_32x32x16_bf16 v[96:111], v[28:31], v[16:19], v[96:111]
  ds_read_b64_tr_b16 v[220:221], v11 offset:9216
  ds_read_b64_tr_b16 v[222:223], v11 offset:10368
  v_mfma_f32_32x32x16_bf16 v[112:127], v[28:31], v[20:23], v[112:127]
  ds_read_b64_tr_b16 v[224:225], v12 offset:9216
  ds_read_b64_tr_b16 v[226:227], v12 offset:10368
  v_mfma_f32_32x32x16_bf16 v[128:143], v[32:35], v[16:19], v[128:143]
  ds_read_b64_tr_b16 v[228:229], v13 offset:9216
  ds_read_b64_tr_b16 v[230:231], v13 offset:10368
  v_mfma_f32_32x32x16_bf16 v[144:159], v[32:35], v[20:23], v[144:159]
  ds_read_b64_tr_b16 v[232:233], v14 offset:9216
  ds_read_b64_tr_b16 v[234:235], v14 offset:10368
  v_mfma_f32_32x32x16_bf16 v[160:175], v[36:39], v[16:19], v[160:175]
  v_mfma_f32_32x32x16_bf16 v[176:191], v[36:39], v[20:23], v[176:191]
  v_mfma_f32_32x32x16_bf16 v[192:207], v[40:43], v[16:19], v[192:207]
  s_waitcnt lgkmcnt(0)
  v_mfma_f32_32x32x16_bf16 v[64:79], v[216:219], v[208:211], v[64:79]
  ds_read_b128 v[16:19], v5
  ds_read_b128 v[20:23], v9
  v_mfma_f32_32x32x16_bf16 v[80:95], v[216:219], v[212:215], v[80:95]
  ds_read_b64_tr_b16 v[24:25], v10 offset:13824
  ds_read_b64_tr_b16 v[26:27], v10 offset:14976
  v_mfma_f32_32x32x16_bf16 v[96:111], v[220:223], v[208:211], v[96:111]
  ds_read_b64_tr_b16 v[28:29], v11 offset:13824
  ds_read_b64_tr_b16 v[30:31], v11 offset:14976
  v_mfma_f32_32x32x16_bf16 v[112:127], v[220:223], v[212:215], v[112:127]
  ds_read_b64_tr_b16 v[32:33], v12 offset:13824
  ds_read_b64_tr_b16 v[34:35], v12 offset:14976
  v_mfma_f32_32x32x16_bf16 v[128:143], v[224:227], v[208:211], v[128:143]
  ds_read_b64_tr_b16 v[36:37], v13 offset:13824
  ds_read_b64_tr_b16 v[38:39], v13 offset:14976
  v_mfma_f32_32x32x16_bf16 v[144:159], v[224:227], v[212:215], v[144:159]
  ds_read_b64_tr_b16 v[40:41], v14 offset:13824
  ds_read_b64_tr_b16 v[42:43], v14 offset:14976
  v_mfma_f32_32x32x16_bf16 v[160:175], v[228:231], v[208:211], v[160:175]
  v_mfma_f32_32x32x16_bf16 v[176:191], v[228:231], v[212:215], v[176:191]
  v_mfma_f32_32x32x16_bf16 v[192:207], v[232:235], v[208:211], v[192:207]
  s_waitcnt lgkmcnt(0)
  v_mfma_f32_32x32x16_bf16 v[64:79], v[24:27], v[16:19], v[64:79]
  v_add_u32 v2, 53376, v2
  v_add_u32 v3, 53376, v3
  v_add_u32 v4, 53376, v4
  v_add_u32 v5, 53376, v5
  v_add_u32 v6, 53376, v6
  v_add_u32 v7, 53376, v7
  v_add_u32 v8, 53376, v8
  v_mfma_f32_32x32x16_bf16 v[80:95], v[24:27], v[20:23], v[80:95]
  v_add_u32 v9, 53376, v9
  v_add_u32 v10, 53376, v10
  v_add_u32 v11, 53376, v11
  v_add_u32 v12, 53376, v12
  v_add_u32 v13, 53376, v13
  v_add_u32 v14, 53376, v14
  s_barrier
  v_mfma_f32_32x32x16_bf16 v[96:111], v[28:31], v[16:19], v[96:111]
  ds_read_b128 v[208:211], v2
  ds_read_b128 v[212:215], v6
  ds_read_b64_tr_b16 v[216:217], v10 offset:0
  v_mfma_f32_32x32x16_bf16 v[112:127], v[28:31], v[20:23], v[112:127]
  ds_read_b64_tr_b16 v[218:219], v10 offset:1152
  ds_read_b64_tr_b16 v[220:221], v11 offset:0
  ds_read_b64_tr_b16 v[222:223], v11 offset:1152
  v_mfma_f32_32x32x16_bf16 v[128:143], v[32:35], v[16:19], v[128:143]
  ds_read_b64_tr_b16 v[224:225], v12 offset:0
  ds_read_b64_tr_b16 v[226:227], v12 offset:1152
  ds_read_b64_tr_b16 v[228:229], v13 offset:0
  v_mfma_f32_32x32x16_bf16 v[144:159], v[32:35], v[20:23], v[144:159]
  ds_read_b64_tr_b16 v[230:231], v13 offset:1152
  ds_read_b64_tr_b16 v[232:233], v14 offset:0
  ds_read_b64_tr_b16 v[234:235], v14 offset:1152
  v_mfma_f32_32x32x16_bf16 v[160:175], v[36:39], v[16:19], v[160:175]
  v_mfma_f32_32x32x16_bf16 v[176:191], v[36:39], v[20:23], v[176:191]
  v_mfma_f32_32x32x16_bf16 v[192:207], v[40:43], v[16:19], v[192:207]
  s_waitcnt lgkmcnt(0)
  v_mfma_f32_32x32x16_bf16 v[64:79], v[216:219], v[208:211], v[64:79]
  ds_read_b128 v[16:19], v3
  ds_read_b128 v[20:23], v7
  v_mfma_f32_32x32x16_bf16 v[80:95], v[216:219], v[212:215], v[80:95]
  ds_read_b64_tr_b16 v[24:25], v10 offset:4608
  ds_read_b64_tr_b16 v[26:27], v10 offset:5760
  v_mfma_f32_32x32x16_bf16 v[96:111], v[220:223], v[208:211], v[96:111]
  ds_read_b64_tr_b16 v[28:29], v11 offset:4608
  ds_read_b64_tr_b16 v[30:31], v11 offset:5760
  v_mfma_f32_32x32x16_bf16 v[112:127], v[220:223], v[212:215], v[112:127]
  ds_read_b64_tr_b16 v[32:33], v12 offset:4608
  ds_read_b64_tr_b16 v[34:35], v12 offset:5760
  v_mfma_f32_32x32x16_bf16 v[128:143], v[224:227], v[208:211], v[128:143]
  ds_read_b64_tr_b16 v[36:37], v13 offset:4608
  ds_read_b64_tr_b16 v[38:39], v13 offset:5760
  v_mfma_f32_32x32x16_bf16 v[144:159], v[224:227], v[212:215], v[144:159]
  ds_read_b64_tr_b16 v[40:41], v14 offset:4608
  ds_read_b64_tr_b16 v[42:43], v14 offset:5760
  v_mfma_f32_32x32x16_bf16 v[160:175], v[228:231], v[208:211], v[160:175]
  v_mfma_f32_32x32x16_bf16 v[176:191], v[228:231], v[212:215], v[176:191]
  v_mfma_f32_32x32x16_bf16 v[192:207], v[232:235], v[208:211], v[192:207]
  s_waitcnt lgkmcnt(0)
  v_mfma_f32_32x32x16_bf16 v[64:79], v[24:27], v[16:19], v[64:79]
  ds_read_b128 v[208:211], v4
  ds_read_b128 v[212:215], v8
  v_mfma_f32_32x32x16_bf16 v[80:95], v[24:27], v[20:23], v[80:95]
  ds_read_b64_tr_b16 v[216:217], v10 offset:9216
  ds_read_b64_tr_b16 v[218:219], v10 offset:10368
  v_mfma_f32_32x32x16_bf16 v[96:111], v[28:31], v[16:19], v[96:111]
  ds_read_b64_tr_b16 v[220:221], v11 offset:9216
  ds_read_b64_tr_b16 v[222:223], v11 offset:10368
  v_mfma_f32_32x32x16_bf16 v[112:127], v[28:31], v[20:23], v[112:127]
  ds_read_b64_tr_b16 v[224:225], v12 offset:9216
  ds_read_b64_tr_b16 v[226:227], v12 offset:10368
  v_mfma_f32_32x32x16_bf16 v[128:143], v[32:35], v[16:19], v[128:143]
  ds_read_b64_tr_b16 v[228:229], v13 offset:9216
  ds_read_b64_tr_b16 v[230:231], v13 offset:10368
  v_mfma_f32_32x32x16_bf16 v[144:159], v[32:35], v[20:23], v[144:159]
  ds_read_b64_tr_b16 v[232:233], v14 offset:9216
  ds_read_b64_tr_b16 v[234:235], v14 offset:10368
  v_mfma_f32_32x32x16_bf16 v[160:175], v[36:39], v[16:19], v[160:175]
  v_mfma_f32_32x32x16_bf16 v[176:191], v[36:39], v[20:23], v[176:191]
  v_mfma_f32_32x32x16_bf16 v[192:207], v[40:43], v[16:19], v[192:207]
  s_waitcnt lgkmcnt(0)
  v_mfma_f32_32x32x16_bf16 v[64:79], v[216:219], v[208:211], v[64:79]
  ds_read_b128 v[16:19], v5
  ds_read_b128 v[20:23], v9
  v_mfma_f32_32x32x16_bf16 v[80:95], v[216:219], v[212:215], v[80:95]
  ds_read_b64_tr_b16 v[24:25], v10 offset:13824
  ds_read_b64_tr_b16 v[26:27], v10 offset:14976
  v_mfma_f32_32x32x16_bf16 v[96:111], v[220:223], v[208:211], v[96:111]
  ds_read_b64_tr_b16 v[28:29], v11 offset:13824
  ds_read_b64_tr_b16 v[30:31], v11 offset:14976
  v_mfma_f32_32x32x16_bf16 v[112:127], v[220:223], v[212:215], v[112:127]
  ds_read_b64_tr_b16 v[32:33], v12 offset:13824
  ds_read_b64_tr_b16 v[34:35], v12 offset:14976
  v_mfma_f32_32x32x16_bf16 v[128:143], v[224:227], v[208:211], v[128:143]
  ds_read_b64_tr_b16 v[36:37], v13 offset:13824
  ds_read_b64_tr_b16 v[38:39], v13 offset:14976
  v_mfma_f32_32x32x16_bf16 v[144:159], v[224:227], v[212:215], v[144:159]
  ds_read_b64_tr_b16 v[40:41], v14 offset:13824
  ds_read_b64_tr_b16 v[42:43], v14 offset:14976
  v_mfma_f32_32x32x16_bf16 v[160:175], v[228:231], v[208:211], v[160:175]
  v_mfma_f32_32x32x16_bf16 v[176:191], v[228:231], v[212:215], v[176:191]
  v_mfma_f32_32x32x16_bf16 v[192:207], v[232:235], v[208:211], v[192:207]
  s_waitcnt lgkmcnt(0)
  v_mfma_f32_32x32x16_bf16 v[64:79], v[24:27], v[16:19], v[64:79]
  v_add_u32 v2, 53376, v2
  v_add_u32 v3, 53376, v3
  v_add_u32 v4, 53376, v4
  v_add_u32 v5, 53376, v5
  v_add_u32 v6, 53376, v6
  v_add_u32 v7, 53376, v7
  v_add_u32 v8, 53376, v8
  v_mfma_f32_32x32x16_bf16 v[80:95], v[24:27], v[20:23], v[80:95]
  v_add_u32 v9, 53376, v9
  v_add_u32 v10, 53376, v10
  v_add_u32 v11, 53376, v11
  v_add_u32 v12, 53376, v12
  v_add_u32 v13, 53376, v13
  v_add_u32 v14, 53376, v14
  s_barrier
  v_mfma_f32_32x32x16_bf16 v[96:111], v[28:31], v[16:19], v[96:111]
  ds_read_b128 v[208:211], v2
  ds_read_b128 v[212:215], v6
  ds_read_b64_tr_b16 v[216:217], v10 offset:0
  v_mfma_f32_32x32x16_bf16 v[112:127], v[28:31], v[20:23], v[112:127]
  ds_read_b64_tr_b16 v[218:219], v10 offset:1152
  ds_read_b64_tr_b16 v[220:221], v11 offset:0
  ds_read_b64_tr_b16 v[222:223], v11 offset:1152
  v_mfma_f32_32x32x16_bf16 v[128:143], v[32:35], v[16:19], v[128:143]
  ds_read_b64_tr_b16 v[224:225], v12 offset:0
  ds_read_b64_tr_b16 v[226:227], v12 offset:1152
  ds_read_b64_tr_b16 v[228:229], v13 offset:0
  v_mfma_f32_32x32x16_bf16 v[144:159], v[32:35], v[20:23], v[144:159]
  ds_read_b64_tr_b16 v[230:231], v13 offset:1152
  ds_read_b64_tr_b16 v[232:233], v14 offset:0
  ds_read_b64_tr_b16 v[234:235], v14 offset:1152
  v_mfma_f32_32x32x16_bf16 v[160:175], v[36:39], v[16:19], v[160:175]
  v_mfma_f32_32x32x16_bf16 v[176:191], v[36:39], v[20:23], v[176:191]
  v_mfma_f32_32x32x16_bf16 v[192:207], v[40:43], v[16:19], v[192:207]
  s_waitcnt lgkmcnt(0)
  v_mfma_f32_32x32x16_bf16 v[64:79], v[216:219], v[208:211], v[64:79]
  ds_read_b128 v[16:19], v3
  ds_read_b128 v[20:23], v7
  v_mfma_f32_32x32x16_bf16 v[80:95], v[216:219], v[212:215], v[80:95]
  ds_read_b64_tr_b16 v[24:25], v10 offset:4608
  ds_read_b64_tr_b16 v[26:27], v10 offset:5760
  v_mfma_f32_32x32x16_bf16 v[96:111], v[220:223], v[208:211], v[96:111]
  ds_read_b64_tr_b16 v[28:29], v11 offset:4608
  ds_read_b64_tr_b16 v[30:31], v11 offset:5760
  v_mfma_f32_32x32x16_bf16 v[112:127], v[220:223], v[212:215], v[112:127]
  ds_read_b64_tr_b16 v[32:33], v12 offset:4608
  ds_read_b64_tr_b16 v[34:35], v12 offset:5760
  v_mfma_f32_32x32x16_bf16 v[128:143], v[224:227], v[208:211], v[128:143]
  ds_read_b64_tr_b16 v[36:37], v13 offset:4608
  ds_read_b64_tr_b16 v[38:39], v13 offset:5760
  v_mfma_f32_32x32x16_bf16 v[144:159], v[224:227], v[212:215], v[144:159]
  ds_read_b64_tr_b16 v[40:41], v14 offset:4608
  ds_read_b64_tr_b16 v[42:43], v14 offset:5760
  v_mfma_f32_32x32x16_bf16 v[160:175], v[228:231], v[208:211], v[160:175]
  v_mfma_f32_32x32x16_bf16 v[176:191], v[228:231], v[212:215], v[176:191]
  v_mfma_f32_32x32x16_bf16 v[192:207], v[232:235], v[208:211], v[192:207]
  s_waitcnt lgkmcnt(0)
  v_mfma_f32_32x32x16_bf16 v[64:79], v[24:27], v[16:19], v[64:79]
  ds_read_b128 v[208:211], v4
  ds_read_b128 v[212:215], v8
  v_mfma_f32_32x32x16_bf16 v[80:95], v[24:27], v[20:23], v[80:95]
  ds_read_b64_tr_b16 v[216:217], v10 offset:9216
  ds_read_b64_tr_b16 v[218:219], v10 offset:10368
  v_mfma_f32_32x32x16_bf16 v[96:111], v[28:31], v[16:19], v[96:111]
  ds_read_b64_tr_b16 v[220:221], v11 offset:9216
  ds_read_b64_tr_b16 v[222:223], v11 offset:10368
  v_mfma_f32_32x32x16_bf16 v[112:127], v[28:31], v[20:23], v[112:127]
  ds_read_b64_tr_b16 v[224:225], v12 offset:9216
  ds_read_b64_tr_b16 v[226:227], v12 offset:10368
  v_mfma_f32_32x32x16_bf16 v[128:143], v[32:35], v[16:19], v[128:143]
  ds_read_b64_tr_b16 v[228:229], v13 offset:9216
  ds_read_b64_tr_b16 v[230:231], v13 offset:10368
  v_mfma_f32_32x32x16_bf16 v[144:159], v[32:35], v[20:23], v[144:159]
  ds_read_b64_tr_b16 v[232:233], v14 offset:9216
  ds_read_b64_tr_b16 v[234:235], v14 offset:10368
  v_mfma_f32_32x32x16_bf16 v[160:175], v[36:39], v[16:19], v[160:175]
  v_mfma_f32_32x32x16_bf16 v[176:191], v[36:39], v[20:23], v[176:191]
  v_mfma_f32_32x32x16_bf16 v[192:207], v[40:43], v[16:19], v[192:207]
  s_waitcnt lgkmcnt(0)
  v_mfma_f32_32x32x16_bf16 v[64:79], v[216:219], v[208:211], v[64:79]
  ds_read_b128 v[16:19], v5
  ds_read_b128 v[20:23], v9
  v_mfma_f32_32x32x16_bf16 v[80:95], v[216:219], v[212:215], v[80:95]
  ds_read_b64_tr_b16 v[24:25], v10 offset:13824
  ds_read_b64_tr_b16 v[26:27], v10 offset:14976
  v_mfma_f32_32x32x16_bf16 v[96:111], v[220:223], v[208:211], v[96:111]
  ds_read_b64_tr_b16 v[28:29], v11 offset:13824
  ds_read_b64_tr_b16 v[30:31], v11 offset:14976
  v_mfma_f32_32x32x16_bf16 v[112:127], v[220:223], v[212:215], v[112:127]
  ds_read_b64_tr_b16 v[32:33], v12 offset:13824
  ds_read_b64_tr_b16 v[34:35], v12 offset:14976
  v_mfma_f32_32x32x16_bf16 v[128:143], v[224:227], v[208:211], v[128:143]
  ds_read_b64_tr_b16 v[36:37], v13 offset:13824
  ds_read_b64_tr_b16 v[38:39], v13 offset:14976
  v_mfma_f32_32x32x16_bf16 v[144:159], v[224:227], v[212:215], v[144:159]
  ds_read_b64_tr_b16 v[40:41], v14 offset:13824
  ds_read_b64_tr_b16 v[42:43], v14 offset:14976
  v_mfma_f32_32x32x16_bf16 v[160:175], v[228:231], v[208:211], v[160:175]
  v_mfma_f32_32x32x16_bf16 v[176:191], v[228:231], v[212:215], v[176:191]
  v_mfma_f32_32x32x16_bf16 v[192:207], v[232:235], v[208:211], v[192:207]
  s_waitcnt lgkmcnt(0)
  v_mfma_f32_32x32x16_bf16 v[64:79], v[24:27], v[16:19], v[64:79]
  v_subrev_u32 v2, 106752, v2
  v_subrev_u32 v3, 106752, v3
  v_subrev_u32 v4, 106752, v4
  v_subrev_u32 v5, 106752, v5
  v_subrev_u32 v6, 106752, v6
  v_subrev_u32 v7, 106752, v7
  v_subrev_u32 v8, 106752, v8
  v_mfma_f32_32x32x16_bf16 v[80:95], v[24:27], v[20:23], v[80:95]
  v_subrev_u32 v9, 106752, v9
  v_subrev_u32 v10, 106752, v10
  v_subrev_u32 v11, 106752, v11
  v_subrev_u32 v12, 106752, v12
  v_subrev_u32 v13, 106752, v13
  v_subrev_u32 v14, 106752, v14
  s_barrier
  v_mfma_f32_32x32x16_bf16 v[96:111], v[28:31], v[16:19], v[96:111]
  ds_read_b128 v[208:211], v2
  ds_read_b128 v[212:215], v6
  ds_read_b64_tr_b16 v[216:217], v10 offset:0
  v_mfma_f32_32x32x16_bf16 v[112:127], v[28:31], v[20:23], v[112:127]
  ds_read_b64_tr_b16 v[218:219], v10 offset:1152
  ds_read_b64_tr_b16 v[220:221], v11 offset:0
  ds_read_b64_tr_b16 v[222:223], v11 offset:1152
  v_mfma_f32_32x32x16_bf16 v[128:143], v[32:35], v[16:19], v[128:143]
  ds_read_b64_tr_b16 v[224:225], v12 offset:0
  ds_read_b64_tr_b16 v[226:227], v12 offset:1152
  ds_read_b64_tr_b16 v[228:229], v13 offset:0
  v_mfma_f32_32x32x16_bf16 v[144:159], v[32:35], v[20:23], v[144:159]
  ds_read_b64_tr_b16 v[230:231], v13 offset:1152
  ds_read_b64_tr_b16 v[232:233], v14 offset:0
  ds_read_b64_tr_b16 v[234:235], v14 offset:1152
  v_mfma_f32_32x32x16_bf16 v[160:175], v[36:39], v[16:19], v[160:175]
  v_mfma_f32_32x32x16_bf16 v[176:191], v[36:39], v[20:23], v[176:191]
  v_mfma_f32_32x32x16_bf16 v[192:207], v[40:43], v[16:19], v[192:207]
  s_waitcnt lgkmcnt(0)
  v_mfma_f32_32x32x16_bf16 v[64:79], v[216:219], v[208:211], v[64:79]
  ds_read_b128 v[16:19], v3
  ds_read_b128 v[20:23], v7
  v_mfma_f32_32x32x16_bf16 v[80:95], v[216:219], v[212:215], v[80:95]
  ds_read_b64_tr_b16 v[24:25], v10 offset:4608
  ds_read_b64_tr_b16 v[26:27], v10 offset:5760
  v_mfma_f32_32x32x16_bf16 v[96:111], v[220:223], v[208:211], v[96:111]
  ds_read_b64_tr_b16 v[28:29], v11 offset:4608
  ds_read_b64_tr_b16 v[30:31], v11 offset:5760
  v_mfma_f32_32x32x16_bf16 v[112:127], v[220:223], v[212:215], v[112:127]
  ds_read_b64_tr_b16 v[32:33], v12 offset:4608
  ds_read_b64_tr_b16 v[34:35], v12 offset:5760
  v_mfma_f32_32x32x16_bf16 v[128:143], v[224:227], v[208:211], v[128:143]
  ds_read_b64_tr_b16 v[36:37], v13 offset:4608
  ds_read_b64_tr_b16 v[38:39], v13 offset:5760
  v_mfma_f32_32x32x16_bf16 v[144:159], v[224:227], v[212:215], v[144:159]
  ds_read_b64_tr_b16 v[40:41], v14 offset:4608
  ds_read_b64_tr_b16 v[42:43], v14 offset:5760
  v_mfma_f32_32x32x16_bf16 v[160:175], v[228:231], v[208:211], v[160:175]
  v_mfma_f32_32x32x16_bf16 v[176:191], v[228:231], v[212:215], v[176:191]
  v_mfma_f32_32x32x16_bf16 v[192:207], v[232:235], v[208:211], v[192:207]
  s_waitcnt lgkmcnt(0)
  v_mfma_f32_32x32x16_bf16 v[64:79], v[24:27], v[16:19], v[64:79]
  ds_read_b128 v[208:211], v4
  ds_read_b128 v[212:215], v8
  v_mfma_f32_32x32x16_bf16 v[80:95], v[24:27], v[20:23], v[80:95]
  ds_read_b64_tr_b16 v[216:217], v10 offset:9216
  ds_read_b64_tr_b16 v[218:219], v10 offset:10368
  v_mfma_f32_32x32x16_bf16 v[96:111], v[28:31], v[16:19], v[96:111]
  ds_read_b64_tr_b16 v[220:221], v11 offset:9216
  ds_read_b64_tr_b16 v[222:223], v11 offset:10368
  v_mfma_f32_32x32x16_bf16 v[112:127], v[28:31], v[20:23], v[112:127]
  ds_read_b64_tr_b16 v[224:225], v12 offset:9216
  ds_read_b64_tr_b16 v[226:227], v12 offset:10368
  v_mfma_f32_32x32x16_bf16 v[128:143], v[32:35], v[16:19], v[128:143]
  ds_read_b64_tr_b16 v[228:229], v13 offset:9216
  ds_read_b64_tr_b16 v[230:231], v13 offset:10368
  v_mfma_f32_32x32x16_bf16 v[144:159], v[32:35], v[20:23], v[144:159]
  ds_read_b64_tr_b16 v[232:233], v14 offset:9216
  ds_read_b64_tr_b16 v[234:235], v14 offset:10368
  v_mfma_f32_32x32x16_bf16 v[160:175], v[36:39], v[16:19], v[160:175]
  v_mfma_f32_32x32x16_bf16 v[176:191], v[36:39], v[20:23], v[176:191]
  v_mfma_f32_32x32x16_bf16 v[192:207], v[40:43], v[16:19], v[192:207]
  s_waitcnt lgkmcnt(0)
  v_mfma_f32_32x32x16_bf16 v[64:79], v[216:219], v[208:211], v[64:79]
  ds_read_b128 v[16:19], v5
  ds_read_b128 v[20:23], v9
  v_mfma_f32_32x32x16_bf16 v[80:95], v[216:219], v[212:215], v[80:95]
  ds_read_b64_tr_b16 v[24:25], v10 offset:13824
  ds_read_b64_tr_b16 v[26:27], v10 offset:14976
  v_mfma_f32_32x32x16_bf16 v[96:111], v[220:223], v[208:211], v[96:111]
  ds_read_b64_tr_b16 v[28:29], v11 offset:13824
  ds_read_b64_tr_b16 v[30:31], v11 offset:14976
  v_mfma_f32_32x32x16_bf16 v[112:127], v[220:223], v[212:215], v[112:127]
  ds_read_b64_tr_b16 v[32:33], v12 offset:13824
  ds_read_b64_tr_b16 v[34:35], v12 offset:14976
  v_mfma_f32_32x32x16_bf16 v[128:143], v[224:227], v[208:211], v[128:143]
  ds_read_b64_tr_b16 v[36:37], v13 offset:13824
  ds_read_b64_tr_b16 v[38:39], v13 offset:14976
  v_mfma_f32_32x32x16_bf16 v[144:159], v[224:227], v[212:215], v[144:159]
  ds_read_b64_tr_b16 v[40:41], v14 offset:13824
  ds_read_b64_tr_b16 v[42:43], v14 offset:14976
  v_mfma_f32_32x32x16_bf16 v[160:175], v[228:231], v[208:211], v[160:175]
  v_mfma_f32_32x32x16_bf16 v[176:191], v[228:231], v[212:215], v[176:191]
  v_mfma_f32_32x32x16_bf16 v[192:207], v[232:235], v[208:211], v[192:207]
  s_waitcnt lgkmcnt(0)
  v_mfma_f32_32x32x16_bf16 v[64:79], v[24:27], v[16:19], v[64:79]
  v_add_u32 v2, 53376, v2
  v_add_u32 v3, 53376, v3
  v_add_u32 v4, 53376, v4
  v_add_u32 v5, 53376, v5
  v_add_u32 v6, 53376, v6
  v_add_u32 v7, 53376, v7
  v_add_u32 v8, 53376, v8
  v_mfma_f32_32x32x16_bf16 v[80:95], v[24:27], v[20:23], v[80:95]
  v_add_u32 v9, 53376, v9
  v_add_u32 v10, 53376, v10
  v_add_u32 v11, 53376, v11
  v_add_u32 v12, 53376, v12
  v_add_u32 v13, 53376, v13
  v_add_u32 v14, 53376, v14
  s_barrier
  v_mfma_f32_32x32x16_bf16 v[96:111], v[28:31], v[16:19], v[96:111]
  ds_read_b128 v[208:211], v2
  ds_read_b128 v[212:215], v6
  ds_read_b64_tr_b16 v[216:217], v10 offset:0
  v_mfma_f32_32x32x16_bf16 v[112:127], v[28:31], v[20:23], v[112:127]
  ds_read_b64_tr_b16 v[218:219], v10 offset:1152
  ds_read_b64_tr_b16 v[220:221], v11 offset:0
  ds_read_b64_tr_b16 v[222:223], v11 offset:1152
  v_mfma_f32_32x32x16_bf16 v[128:143], v[32:35], v[16:19], v[128:143]
  ds_read_b64_tr_b16 v[224:225], v12 offset:0
  ds_read_b64_tr_b16 v[226:227], v12 offset:1152
  ds_read_b64_tr_b16 v[228:229], v13 offset:0
  v_mfma_f32_32x32x16_bf16 v[144:159], v[32:35], v[20:23], v[144:159]
  ds_read_b64_tr_b16 v[230:231], v13 offset:1152
  ds_read_b64_tr_b16 v[232:233], v14 offset:0
  ds_read_b64_tr_b16 v[234:235], v14 offset:1152
  v_mfma_f32_32x32x16_bf16 v[160:175], v[36:39], v[16:19], v[160:175]
  v_mfma_f32_32x32x16_bf16 v[176:191], v[36:39], v[20:23], v[176:191]
  v_mfma_f32_32x32x16_bf16 v[192:207], v[40:43], v[16:19], v[192:207]
  s_waitcnt lgkmcnt(0)
  v_mfma_f32_32x32x16_bf16 v[64:79], v[216:219], v[208:211], v[64:79]
  ds_read_b128 v[16:19], v3
  ds_read_b128 v[20:23], v7
  v_mfma_f32_32x32x16_bf16 v[80:95], v[216:219], v[212:215], v[80:95]
  ds_read_b64_tr_b16 v[24:25], v10 offset:4608
  ds_read_b64_tr_b16 v[26:27], v10 offset:5760
  v_mfma_f32_32x32x16_bf16 v[96:111], v[220:223], v[208:211], v[96:111]
  ds_read_b64_tr_b16 v[28:29], v11 offset:4608
  ds_read_b64_tr_b16 v[30:31], v11 offset:5760
  v_mfma_f32_32x32x16_bf16 v[112:127], v[220:223], v[212:215], v[112:127]
  ds_read_b64_tr_b16 v[32:33], v12 offset:4608
  ds_read_b64_tr_b16 v[34:35], v12 offset:5760
  v_mfma_f32_32x32x16_bf16 v[128:143], v[224:227], v[208:211], v[128:143]
  ds_read_b64_tr_b16 v[36:37], v13 offset:4608
  ds_read_b64_tr_b16 v[38:39], v13 offset:5760
  v_mfma_f32_32x32x16_bf16 v[144:159], v[224:227], v[212:215], v[144:159]
  ds_read_b64_tr_b16 v[40:41], v14 offset:4608
  ds_read_b64_tr_b16 v[42:43], v14 offset:5760
  v_mfma_f32_32x32x16_bf16 v[160:175], v[228:231], v[208:211], v[160:175]
  v_mfma_f32_32x32x16_bf16 v[176:191], v[228:231], v[212:215], v[176:191]
  v_mfma_f32_32x32x16_bf16 v[192:207], v[232:235], v[208:211], v[192:207]
  s_waitcnt lgkmcnt(0)
  v_mfma_f32_32x32x16_bf16 v[64:79], v[24:27], v[16:19], v[64:79]
  ds_read_b128 v[208:211], v4
  ds_read_b128 v[212:215], v8
  v_mfma_f32_32x32x16_bf16 v[80:95], v[24:27], v[20:23], v[80:95]
  ds_read_b64_tr_b16 v[216:217], v10 offset:9216
  ds_read_b64_tr_b16 v[218:219], v10 offset:10368
  v_mfma_f32_32x32x16_bf16 v[96:111], v[28:31], v[16:19], v[96:111]
  ds_read_b64_tr_b16 v[220:221], v11 offset:9216
  ds_read_b64_tr_b16 v[222:223], v11 offset:10368
  v_mfma_f32_32x32x16_bf16 v[112:127], v[28:31], v[20:23], v[112:127]
  ds_read_b64_tr_b16 v[224:225], v12 offset:9216
  ds_read_b64_tr_b16 v[226:227], v12 offset:10368
  v_mfma_f32_32x32x16_bf16 v[128:143], v[32:35], v[16:19], v[128:143]
  ds_read_b64_tr_b16 v[228:229], v13 offset:9216
  ds_read_b64_tr_b16 v[230:231], v13 offset:10368
  v_mfma_f32_32x32x16_bf16 v[144:159], v[32:35], v[20:23], v[144:159]
  ds_read_b64_tr_b16 v[232:233], v14 offset:9216
  ds_read_b64_tr_b16 v[234:235], v14 offset:10368
  v_mfma_f32_32x32x16_bf16 v[160:175], v[36:39], v[16:19], v[160:175]
  v_mfma_f32_32x32x16_bf16 v[176:191], v[36:39], v[20:23], v[176:191]
  v_mfma_f32_32x32x16_bf16 v[192:207], v[40:43], v[16:19], v[192:207]
  s_waitcnt lgkmcnt(0)
  v_mfma_f32_32x32x16_bf16 v[64:79], v[216:219], v[208:211], v[64:79]
  ds_read_b128 v[16:19], v5
  ds_read_b128 v[20:23], v9
  v_mfma_f32_32x32x16_bf16 v[80:95], v[216:219], v[212:215], v[80:95]
  ds_read_b64_tr_b16 v[24:25], v10 offset:13824
  ds_read_b64_tr_b16 v[26:27], v10 offset:14976
  v_mfma_f32_32x32x16_bf16 v[96:111], v[220:223], v[208:211], v[96:111]
  ds_read_b64_tr_b16 v[28:29], v11 offset:13824
  ds_read_b64_tr_b16 v[30:31], v11 offset:14976
  v_mfma_f32_32x32x16_bf16 v[112:127], v[220:223], v[212:215], v[112:127]
  ds_read_b64_tr_b16 v[32:33], v12 offset:13824
  ds_read_b64_tr_b16 v[34:35], v12 offset:14976
  v_mfma_f32_32x32x16_bf16 v[128:143], v[224:227], v[208:211], v[128:143]
  ds_read_b64_tr_b16 v[36:37], v13 offset:13824
  ds_read_b64_tr_b16 v[38:39], v13 offset:14976
  v_mfma_f32_32x32x16_bf16 v[144:159], v[224:227], v[212:215], v[144:159]
  ds_read_b64_tr_b16 v[40:41], v14 offset:13824
  ds_read_b64_tr_b16 v[42:43], v14 offset:14976
  v_mfma_f32_32x32x16_bf16 v[160:175], v[228:231], v[208:211], v[160:175]
  v_mfma_f32_32x32x16_bf16 v[176:191], v[228:231], v[212:215], v[176:191]
  v_mfma_f32_32x32x16_bf16 v[192:207], v[232:235], v[208:211], v[192:207]
  s_waitcnt lgkmcnt(0)
  s_barrier
  v_mfma_f32_32x32x16_bf16 v[64:79], v[24:27], v[16:19], v[64:79]
  v_mfma_f32_32x32x16_bf16 v[80:95], v[24:27], v[20:23], v[80:95]
  v_mfma_f32_32x32x16_bf16 v[96:111], v[28:31], v[16:19], v[96:111]
  v_mfma_f32_32x32x16_bf16 v[112:127], v[28:31], v[20:23], v[112:127]
  v_mfma_f32_32x32x16_bf16 v[128:143], v[32:35], v[16:19], v[128:143]
  v_mfma_f32_32x32x16_bf16 v[144:159], v[32:35], v[20:23], v[144:159]
  v_mfma_f32_32x32x16_bf16 v[160:175], v[36:39], v[16:19], v[160:175]
  v_mfma_f32_32x32x16_bf16 v[176:191], v[36:39], v[20:23], v[176:191]
  v_mfma_f32_32x32x16_bf16 v[192:207], v[40:43], v[16:19], v[192:207]
  s_mov_b32 s44, s8
  s_mov_b32 s45, s9
  s_mov_b32 s46, 0x1500000
  s_mov_b32 s47, 0x20000

  s_nop 3
  v_lshlrev_b32 v2, 4, v0
  s_lshl_b32 s36, s26, 2
  s_add_u32 s37, s36, s32
  s_add_u32 s38, s36, s33
  v_and_b32 v3, 15, v0
  v_lshlrev_b32 v3, 4, v3
  v_lshrrev_b32 v4, 5, v0
  v_lshl_add_u32 v3, v4, 8, v3
  v_lshrrev_b32 v4, 4, v0
  v_and_b32 v4, 1, v4
  v_lshl_add_u32 v3, v4, 16, v3
  s_mul_i32 s50, s32, 9216
  s_mul_i32 s51, s33, 9216
  s_add_u32 s50, s50, 65536
  s_add_u32 s51, s51, 65536
  v_add_u32 v224, s50, v2
  v_add_u32 v225, s51, v2
  v_mov_b32 v56, 0x3eb8aa3b
  v_mov_b32 v57, 0x3eb8aa3b
  v_mov_b32 v220, 0xbfb8aa3b
  v_mov_b32 v221, 0xbfb8aa3b
  v_mov_b32 v222, 1.0
  v_mov_b32 v223, 1.0
  s_lshl_b32 s34, s31, 12
  v_add_u32 v226, s34, v224
  v_add_u32 v227, s34, v225
  v_pk_mul_f32 v[208:209], v[64:65], v[220:221]
  v_pk_mul_f32 v[210:211], v[66:67], v[220:221]
  v_pk_mul_f32 v[212:213], v[68:69], v[220:221]
  v_pk_mul_f32 v[214:215], v[70:71], v[220:221]
  v_exp_f32 v208, v208
  v_exp_f32 v209, v209
  v_exp_f32 v210, v210
  v_exp_f32 v211, v211
  v_exp_f32 v212, v212
  v_exp_f32 v213, v213
  v_exp_f32 v214, v214
  v_exp_f32 v215, v215
  v_pk_mul_f32 v[72:73], v[64:65], v[72:73]
  v_pk_mul_f32 v[74:75], v[66:67], v[74:75]
  v_pk_mul_f32 v[76:77], v[68:69], v[76:77]
  v_pk_mul_f32 v[78:79], v[70:71], v[78:79]
  v_pk_add_f32 v[208:209], v[208:209], v[222:223]
  v_pk_add_f32 v[210:211], v[210:211], v[222:223]
  v_pk_add_f32 v[212:213], v[212:213], v[222:223]
  v_pk_add_f32 v[214:215], v[214:215], v[222:223]
  v_rcp_f32 v208, v208
  v_rcp_f32 v209, v209
  v_rcp_f32 v210, v210
  v_rcp_f32 v211, v211
  v_rcp_f32 v212, v212
  v_rcp_f32 v213, v213
  v_rcp_f32 v214, v214
  v_rcp_f32 v215, v215
  s_nop 0
  v_pk_mul_f32 v[208:209], v[72:73], v[208:209]
  v_pk_mul_f32 v[210:211], v[74:75], v[210:211]
  v_pk_mul_f32 v[212:213], v[76:77], v[212:213]
  v_pk_mul_f32 v[214:215], v[78:79], v[214:215]
  v_cvt_pk_bf16_f32 v216, v208, v209
  v_cvt_pk_bf16_f32 v217, v210, v211
  v_cvt_pk_bf16_f32 v218, v212, v213
  v_cvt_pk_bf16_f32 v219, v214, v215
  ds_write_b128 v226, v[216:219] offset:0
  v_pk_mul_f32 v[208:209], v[80:81], v[220:221]
  v_pk_mul_f32 v[210:211], v[82:83], v[220:221]
  v_pk_mul_f32 v[212:213], v[84:85], v[220:221]
  v_pk_mul_f32 v[214:215], v[86:87], v[220:221]
  v_exp_f32 v208, v208
  v_exp_f32 v209, v209
  v_exp_f32 v210, v210
  v_exp_f32 v211, v211
  v_exp_f32 v212, v212
  v_exp_f32 v213, v213
  v_exp_f32 v214, v214
  v_exp_f32 v215, v215
  v_pk_mul_f32 v[88:89], v[80:81], v[88:89]
  v_pk_mul_f32 v[90:91], v[82:83], v[90:91]
  v_pk_mul_f32 v[92:93], v[84:85], v[92:93]
  v_pk_mul_f32 v[94:95], v[86:87], v[94:95]
  v_pk_add_f32 v[208:209], v[208:209], v[222:223]
  v_pk_add_f32 v[210:211], v[210:211], v[222:223]
  v_pk_add_f32 v[212:213], v[212:213], v[222:223]
  v_pk_add_f32 v[214:215], v[214:215], v[222:223]
  v_rcp_f32 v208, v208
  v_rcp_f32 v209, v209
  v_rcp_f32 v210, v210
  v_rcp_f32 v211, v211
  v_rcp_f32 v212, v212
  v_rcp_f32 v213, v213
  v_rcp_f32 v214, v214
  v_rcp_f32 v215, v215
  s_nop 0
  v_pk_mul_f32 v[208:209], v[88:89], v[208:209]
  v_pk_mul_f32 v[210:211], v[90:91], v[210:211]
  v_pk_mul_f32 v[212:213], v[92:93], v[212:213]
  v_pk_mul_f32 v[214:215], v[94:95], v[214:215]
  v_cvt_pk_bf16_f32 v216, v208, v209
  v_cvt_pk_bf16_f32 v217, v210, v211
  v_cvt_pk_bf16_f32 v218, v212, v213
  v_cvt_pk_bf16_f32 v219, v214, v215
  ds_write_b128 v227, v[216:219] offset:0
  v_pk_mul_f32 v[208:209], v[96:97], v[220:221]
  v_pk_mul_f32 v[210:211], v[98:99], v[220:221]
  v_pk_mul_f32 v[212:213], v[100:101], v[220:221]
  v_pk_mul_f32 v[214:215], v[102:103], v[220:221]
  v_exp_f32 v208, v208
  v_exp_f32 v209, v209
  v_exp_f32 v210, v210
  v_exp_f32 v211, v211
  v_exp_f32 v212, v212
  v_exp_f32 v213, v213
  v_exp_f32 v214, v214
  v_exp_f32 v215, v215
  v_pk_mul_f32 v[104:105], v[96:97], v[104:105]
  v_pk_mul_f32 v[106:107], v[98:99], v[106:107]
  v_pk_mul_f32 v[108:109], v[100:101], v[108:109]
  v_pk_mul_f32 v[110:111], v[102:103], v[110:111]
  v_pk_add_f32 v[208:209], v[208:209], v[222:223]
  v_pk_add_f32 v[210:211], v[210:211], v[222:223]
  v_pk_add_f32 v[212:213], v[212:213], v[222:223]
  v_pk_add_f32 v[214:215], v[214:215], v[222:223]
  v_rcp_f32 v208, v208
  v_rcp_f32 v209, v209
  v_rcp_f32 v210, v210
  v_rcp_f32 v211, v211
  v_rcp_f32 v212, v212
  v_rcp_f32 v213, v213
  v_rcp_f32 v214, v214
  v_rcp_f32 v215, v215
  s_nop 0
  v_pk_mul_f32 v[208:209], v[104:105], v[208:209]
  v_pk_mul_f32 v[210:211], v[106:107], v[210:211]
  v_pk_mul_f32 v[212:213], v[108:109], v[212:213]
  v_pk_mul_f32 v[214:215], v[110:111], v[214:215]
  v_cvt_pk_bf16_f32 v216, v208, v209
  v_cvt_pk_bf16_f32 v217, v210, v211
  v_cvt_pk_bf16_f32 v218, v212, v213
  v_cvt_pk_bf16_f32 v219, v214, v215
  ds_write_b128 v226, v[216:219] offset:1024
  v_pk_mul_f32 v[208:209], v[112:113], v[220:221]
  v_pk_mul_f32 v[210:211], v[114:115], v[220:221]
  v_pk_mul_f32 v[212:213], v[116:117], v[220:221]
  v_pk_mul_f32 v[214:215], v[118:119], v[220:221]
  v_exp_f32 v208, v208
  v_exp_f32 v209, v209
  v_exp_f32 v210, v210
  v_exp_f32 v211, v211
  v_exp_f32 v212, v212
  v_exp_f32 v213, v213
  v_exp_f32 v214, v214
  v_exp_f32 v215, v215
  v_pk_mul_f32 v[120:121], v[112:113], v[120:121]
  v_pk_mul_f32 v[122:123], v[114:115], v[122:123]
  v_pk_mul_f32 v[124:125], v[116:117], v[124:125]
  v_pk_mul_f32 v[126:127], v[118:119], v[126:127]
  v_pk_add_f32 v[208:209], v[208:209], v[222:223]
  v_pk_add_f32 v[210:211], v[210:211], v[222:223]
  v_pk_add_f32 v[212:213], v[212:213], v[222:223]
  v_pk_add_f32 v[214:215], v[214:215], v[222:223]
  v_rcp_f32 v208, v208
  v_rcp_f32 v209, v209
  v_rcp_f32 v210, v210
  v_rcp_f32 v211, v211
  v_rcp_f32 v212, v212
  v_rcp_f32 v213, v213
  v_rcp_f32 v214, v214
  v_rcp_f32 v215, v215
  s_nop 0
  v_pk_mul_f32 v[208:209], v[120:121], v[208:209]
  v_pk_mul_f32 v[210:211], v[122:123], v[210:211]
  v_pk_mul_f32 v[212:213], v[124:125], v[212:213]
  v_pk_mul_f32 v[214:215], v[126:127], v[214:215]
  v_cvt_pk_bf16_f32 v216, v208, v209
  v_cvt_pk_bf16_f32 v217, v210, v211
  v_cvt_pk_bf16_f32 v218, v212, v213
  v_cvt_pk_bf16_f32 v219, v214, v215
  ds_write_b128 v227, v[216:219] offset:1024
  v_pk_mul_f32 v[208:209], v[128:129], v[220:221]
  v_pk_mul_f32 v[210:211], v[130:131], v[220:221]
  v_pk_mul_f32 v[212:213], v[132:133], v[220:221]
  v_pk_mul_f32 v[214:215], v[134:135], v[220:221]
  v_exp_f32 v208, v208
  v_exp_f32 v209, v209
  v_exp_f32 v210, v210
  v_exp_f32 v211, v211
  v_exp_f32 v212, v212
  v_exp_f32 v213, v213
  v_exp_f32 v214, v214
  v_exp_f32 v215, v215
  v_pk_mul_f32 v[136:137], v[128:129], v[136:137]
  v_pk_mul_f32 v[138:139], v[130:131], v[138:139]
  v_pk_mul_f32 v[140:141], v[132:133], v[140:141]
  v_pk_mul_f32 v[142:143], v[134:135], v[142:143]
  v_pk_add_f32 v[208:209], v[208:209], v[222:223]
  v_pk_add_f32 v[210:211], v[210:211], v[222:223]
  v_pk_add_f32 v[212:213], v[212:213], v[222:223]
  v_pk_add_f32 v[214:215], v[214:215], v[222:223]
  v_rcp_f32 v208, v208
  v_rcp_f32 v209, v209
  v_rcp_f32 v210, v210
  v_rcp_f32 v211, v211
  v_rcp_f32 v212, v212
  v_rcp_f32 v213, v213
  v_rcp_f32 v214, v214
  v_rcp_f32 v215, v215
  s_nop 0
  v_pk_mul_f32 v[208:209], v[136:137], v[208:209]
  v_pk_mul_f32 v[210:211], v[138:139], v[210:211]
  v_pk_mul_f32 v[212:213], v[140:141], v[212:213]
  v_pk_mul_f32 v[214:215], v[142:143], v[214:215]
  v_cvt_pk_bf16_f32 v216, v208, v209
  v_cvt_pk_bf16_f32 v217, v210, v211
  v_cvt_pk_bf16_f32 v218, v212, v213
  v_cvt_pk_bf16_f32 v219, v214, v215
  ds_write_b128 v226, v[216:219] offset:2048
  v_pk_mul_f32 v[208:209], v[144:145], v[220:221]
  v_pk_mul_f32 v[210:211], v[146:147], v[220:221]
  v_pk_mul_f32 v[212:213], v[148:149], v[220:221]
  v_pk_mul_f32 v[214:215], v[150:151], v[220:221]
  v_exp_f32 v208, v208
  v_exp_f32 v209, v209
  v_exp_f32 v210, v210
  v_exp_f32 v211, v211
  v_exp_f32 v212, v212
  v_exp_f32 v213, v213
  v_exp_f32 v214, v214
  v_exp_f32 v215, v215
  v_pk_mul_f32 v[152:153], v[144:145], v[152:153]
  v_pk_mul_f32 v[154:155], v[146:147], v[154:155]
  v_pk_mul_f32 v[156:157], v[148:149], v[156:157]
  v_pk_mul_f32 v[158:159], v[150:151], v[158:159]
  v_pk_add_f32 v[208:209], v[208:209], v[222:223]
  v_pk_add_f32 v[210:211], v[210:211], v[222:223]
  v_pk_add_f32 v[212:213], v[212:213], v[222:223]
  v_pk_add_f32 v[214:215], v[214:215], v[222:223]
  v_rcp_f32 v208, v208
  v_rcp_f32 v209, v209
  v_rcp_f32 v210, v210
  v_rcp_f32 v211, v211
  v_rcp_f32 v212, v212
  v_rcp_f32 v213, v213
  v_rcp_f32 v214, v214
  v_rcp_f32 v215, v215
  s_nop 0
  v_pk_mul_f32 v[208:209], v[152:153], v[208:209]
  v_pk_mul_f32 v[210:211], v[154:155], v[210:211]
  v_pk_mul_f32 v[212:213], v[156:157], v[212:213]
  v_pk_mul_f32 v[214:215], v[158:159], v[214:215]
  v_cvt_pk_bf16_f32 v216, v208, v209
  v_cvt_pk_bf16_f32 v217, v210, v211
  v_cvt_pk_bf16_f32 v218, v212, v213
  v_cvt_pk_bf16_f32 v219, v214, v215
  ds_write_b128 v227, v[216:219] offset:2048
  v_pk_mul_f32 v[208:209], v[160:161], v[220:221]
  v_pk_mul_f32 v[210:211], v[162:163], v[220:221]
  v_pk_mul_f32 v[212:213], v[164:165], v[220:221]
  v_pk_mul_f32 v[214:215], v[166:167], v[220:221]
  v_exp_f32 v208, v208
  v_exp_f32 v209, v209
  v_exp_f32 v210, v210
  v_exp_f32 v211, v211
  v_exp_f32 v212, v212
  v_exp_f32 v213, v213
  v_exp_f32 v214, v214
  v_exp_f32 v215, v215
  v_pk_mul_f32 v[168:169], v[160:161], v[168:169]
  v_pk_mul_f32 v[170:171], v[162:163], v[170:171]
  v_pk_mul_f32 v[172:173], v[164:165], v[172:173]
  v_pk_mul_f32 v[174:175], v[166:167], v[174:175]
  v_pk_add_f32 v[208:209], v[208:209], v[222:223]
  v_pk_add_f32 v[210:211], v[210:211], v[222:223]
  v_pk_add_f32 v[212:213], v[212:213], v[222:223]
  v_pk_add_f32 v[214:215], v[214:215], v[222:223]
  v_rcp_f32 v208, v208
  v_rcp_f32 v209, v209
  v_rcp_f32 v210, v210
  v_rcp_f32 v211, v211
  v_rcp_f32 v212, v212
  v_rcp_f32 v213, v213
  v_rcp_f32 v214, v214
  v_rcp_f32 v215, v215
  s_nop 0
  v_pk_mul_f32 v[208:209], v[168:169], v[208:209]
  v_pk_mul_f32 v[210:211], v[170:171], v[210:211]
  v_pk_mul_f32 v[212:213], v[172:173], v[212:213]
  v_pk_mul_f32 v[214:215], v[174:175], v[214:215]
  v_cvt_pk_bf16_f32 v216, v208, v209
  v_cvt_pk_bf16_f32 v217, v210, v211
  v_cvt_pk_bf16_f32 v218, v212, v213
  v_cvt_pk_bf16_f32 v219, v214, v215
  ds_write_b128 v226, v[216:219] offset:3072
  v_pk_mul_f32 v[208:209], v[176:177], v[220:221]
  v_pk_mul_f32 v[210:211], v[178:179], v[220:221]
  v_pk_mul_f32 v[212:213], v[180:181], v[220:221]
  v_pk_mul_f32 v[214:215], v[182:183], v[220:221]
  v_exp_f32 v208, v208
  v_exp_f32 v209, v209
  v_exp_f32 v210, v210
  v_exp_f32 v211, v211
  v_exp_f32 v212, v212
  v_exp_f32 v213, v213
  v_exp_f32 v214, v214
  v_exp_f32 v215, v215
  v_pk_mul_f32 v[184:185], v[176:177], v[184:185]
  v_pk_mul_f32 v[186:187], v[178:179], v[186:187]
  v_pk_mul_f32 v[188:189], v[180:181], v[188:189]
  v_pk_mul_f32 v[190:191], v[182:183], v[190:191]
  v_pk_add_f32 v[208:209], v[208:209], v[222:223]
  v_pk_add_f32 v[210:211], v[210:211], v[222:223]
  v_pk_add_f32 v[212:213], v[212:213], v[222:223]
  v_pk_add_f32 v[214:215], v[214:215], v[222:223]
  v_rcp_f32 v208, v208
  v_rcp_f32 v209, v209
  v_rcp_f32 v210, v210
  v_rcp_f32 v211, v211
  v_rcp_f32 v212, v212
  v_rcp_f32 v213, v213
  v_rcp_f32 v214, v214
  v_rcp_f32 v215, v215
  s_nop 0
  v_pk_mul_f32 v[208:209], v[184:185], v[208:209]
  v_pk_mul_f32 v[210:211], v[186:187], v[210:211]
  v_pk_mul_f32 v[212:213], v[188:189], v[212:213]
  v_pk_mul_f32 v[214:215], v[190:191], v[214:215]
  v_cvt_pk_bf16_f32 v216, v208, v209
  v_cvt_pk_bf16_f32 v217, v210, v211
  v_cvt_pk_bf16_f32 v218, v212, v213
  v_cvt_pk_bf16_f32 v219, v214, v215
  ds_write_b128 v227, v[216:219] offset:3072
  v_pk_mul_f32 v[208:209], v[192:193], v[220:221]
  v_pk_mul_f32 v[210:211], v[194:195], v[220:221]
  v_pk_mul_f32 v[212:213], v[196:197], v[220:221]
  v_pk_mul_f32 v[214:215], v[198:199], v[220:221]
  v_exp_f32 v208, v208
  v_exp_f32 v209, v209
  v_exp_f32 v210, v210
  v_exp_f32 v211, v211
  v_exp_f32 v212, v212
  v_exp_f32 v213, v213
  v_exp_f32 v214, v214
  v_exp_f32 v215, v215
  v_pk_mul_f32 v[200:201], v[192:193], v[200:201]
  v_pk_mul_f32 v[202:203], v[194:195], v[202:203]
  v_pk_mul_f32 v[204:205], v[196:197], v[204:205]
  v_pk_mul_f32 v[206:207], v[198:199], v[206:207]
  v_pk_add_f32 v[208:209], v[208:209], v[222:223]
  v_pk_add_f32 v[210:211], v[210:211], v[222:223]
  v_pk_add_f32 v[212:213], v[212:213], v[222:223]
  v_pk_add_f32 v[214:215], v[214:215], v[222:223]
  v_rcp_f32 v208, v208
  v_rcp_f32 v209, v209
  v_rcp_f32 v210, v210
  v_rcp_f32 v211, v211
  v_rcp_f32 v212, v212
  v_rcp_f32 v213, v213
  v_rcp_f32 v214, v214
  v_rcp_f32 v215, v215
  s_nop 0
  v_pk_mul_f32 v[208:209], v[200:201], v[208:209]
  v_pk_mul_f32 v[210:211], v[202:203], v[210:211]
  v_pk_mul_f32 v[212:213], v[204:205], v[212:213]
  v_pk_mul_f32 v[214:215], v[206:207], v[214:215]
  v_cvt_pk_bf16_f32 v216, v208, v209
  v_cvt_pk_bf16_f32 v217, v210, v211
  v_cvt_pk_bf16_f32 v218, v212, v213
  v_cvt_pk_bf16_f32 v219, v214, v215
  ds_write_b128 v224, v[216:219] offset:8192
gated_mix__mha_block__swiglu_ffn__prompt_kernel_cdone:
  s_mov_b32 s20, s8
  s_mov_b32 s21, s9
  s_mov_b32 s22, 0x1500000
  s_mov_b32 s23, 0x20000

  s_mul_i32 s3, s3, 1664525
  s_add_u32 s3, s3, 1013904223
  s_lshr_b32 s28, s2, 3
  s_and_b32 s28, s28, 3
  s_lshl_b32 s29, s25, 2
  s_add_u32 s28, s28, s29
  s_lshr_b32 s29, s2, 5
  v_lshlrev_b32 v1, 4, v0
  v_and_b32 v2, 15, v0
  v_lshlrev_b32 v2, 4, v2
  v_lshrrev_b32 v3, 5, v0
  v_lshl_add_u32 v2, v3, 8, v2
  s_mov_b32 s36, 0x0000ffff
  s_mov_b32 s37, 0x0000ffff
  s_mov_b32 s39, 0x40000000
  s_lshl_b32 s33, s28, 16
  s_lshl_b32 s34, s29, 13
  s_add_u32 s34, s34, s33
  s_add_u32 s34, s34, 0x100000
  s_lshl_b32 s35, s24, 14
  s_add_u32 s35, s35, s33
  s_add_u32 s32, s35, 0x300000
  s_add_u32 s35, s35, 0x500000
  v_mov_b32 v4, 0x3f803f80
  v_and_b32 v5, 27, v0
  v_cmp_eq_u32 vcc, 16, v5
  v_mov_b32 v5, 0
  s_nop 0
  v_cndmask_b32 v4, v5, v4, vcc
  v_mov_b32 v24, v4
  v_mov_b32 v25, v4
  v_mov_b32 v26, v4
  v_mov_b32 v27, v4
  v_mov_b32 v28, v4
  v_mov_b32 v29, v4
  v_mov_b32 v30, v4
  v_mov_b32 v31, v4
  v_mov_b32 v232, v4
  v_mov_b32 v233, v4
  v_mov_b32 v234, v4
  v_mov_b32 v235, v4
  v_mov_b32 v236, v4
  v_mov_b32 v237, v4
  v_mov_b32 v238, v4
  v_mov_b32 v239, v4
  v_mov_b32 v240, v4
  v_mov_b32 v241, v4
  v_mov_b32 v242, v4
  v_mov_b32 v243, v4
  v_mov_b32 v244, v4
  v_mov_b32 v245, v4
  v_mov_b32 v246, v4
  v_mov_b32 v247, v4
  v_mov_b32 v248, v4
  v_mov_b32 v249, v4
  v_mov_b32 v250, v4
  v_mov_b32 v251, v4
  v_mov_b32 v252, v4
  v_mov_b32 v253, v4
  v_mov_b32 v254, v4
  v_mov_b32 v255, v4
  s_waitcnt vmcnt(0) lgkmcnt(0)
  s_barrier
  s_barrier

  s_setprio 1

  buffer_load_dwordx4 v[16:19], v1, s[20:23], s32 offen sc1
  buffer_load_dwordx4 v[32:35], v1, s[20:23], s34 offen sc1
  s_mov_b64 exec, s[36:37]
  buffer_load_dwordx4 v[24:27], v2, s[20:23], s35 offen sc1
  buffer_load_dwordx4 v[28:31], v2, s[20:23], s35 offen offset:512 sc1
  s_mov_b64 exec, -1
  buffer_load_dwordx4 v[36:39], v1, s[20:23], s34 offen offset:1024 sc1
  buffer_load_dwordx4 v[40:43], v1, s[20:23], s34 offen offset:2048 sc1
  buffer_load_dwordx4 v[44:47], v1, s[20:23], s34 offen offset:3072 sc1
  s_add_u32 s34, s34, 4096
  buffer_load_dwordx4 v[48:51], v1, s[20:23], s34 offen sc1
  buffer_load_dwordx4 v[52:55], v1, s[20:23], s34 offen offset:1024 sc1
  buffer_load_dwordx4 v[56:59], v1, s[20:23], s34 offen offset:2048 sc1
  buffer_load_dwordx4 v[60:63], v1, s[20:23], s34 offen offset:3072 sc1
  buffer_load_dwordx4 v[20:23], v1, s[20:23], s32 offen offset:1024 sc1
  s_mov_b64 exec, s[36:37]
  buffer_load_dwordx4 v[232:235], v2, s[20:23], s35 offen offset:1024 sc1
  buffer_load_dwordx4 v[236:239], v2, s[20:23], s35 offen offset:1536 sc1
  s_mov_b64 exec, -1
  buffer_load_dwordx4 v[8:11], v1, s[20:23], s32 offen offset:2048 sc1
  s_mov_b64 exec, s[36:37]
  buffer_load_dwordx4 v[240:243], v2, s[20:23], s35 offen offset:2048 sc1
  buffer_load_dwordx4 v[244:247], v2, s[20:23], s35 offen offset:2560 sc1
  s_mov_b64 exec, -1

  s_add_u32 s30, s32, 3072
  s_add_u32 s31, s35, 3072
  s_cmp_eq_u32 s62, 0
  s_cbranch_scc1 gated_mix__mha_block__swiglu_ffn__prompt_kernel_norest
gated_mix__mha_block__swiglu_ffn__prompt_kernel_norest:
  v_mov_b32 v222, 0
  v_mov_b32 v223, 0
  v_mov_b32 v224, 0
  v_mov_b32 v225, 0
  v_mov_b32 v226, 0
  v_mov_b32 v227, 0
  v_mov_b32 v228, 0
  v_mov_b32 v229, 0
  v_mov_b32 v230, 0
  v_mov_b32 v231, 0
  s_nop 1
  v_mfma_f32_32x32x16_bf16 v[64:79], v[224:227], v[228:231], 0
  v_mfma_f32_32x32x16_bf16 v[80:95], v[224:227], v[228:231], 0
  v_mfma_f32_32x32x16_bf16 v[96:111], v[224:227], v[228:231], 0
  v_mfma_f32_32x32x16_bf16 v[112:127], v[224:227], v[228:231], 0
  v_mfma_f32_32x32x16_bf16 v[128:143], v[224:227], v[228:231], 0
  v_mfma_f32_32x32x16_bf16 v[144:159], v[224:227], v[228:231], 0
  v_mfma_f32_32x32x16_bf16 v[160:175], v[224:227], v[228:231], 0
  v_mfma_f32_32x32x16_bf16 v[176:191], v[224:227], v[228:231], 0
  s_waitcnt vmcnt(6) lgkmcnt(0)
  s_barrier

  v_mfma_f32_32x32x16_bf16 v[192:207], v[16:19], v[32:35], 0
  s_mov_b32 s38, 0
  s_nop 7
  s_nop 3
.p2align 6
gated_mix__mha_block__swiglu_ffn__prompt_kernel_aloop:
  v_exp_f32 v192, v192
  v_cvt_pk_bf16_f32 v231, v222, v223
  v_exp_f32 v193, v193
  v_exp_f32 v194, v194
  v_exp_f32 v195, v195
  v_mfma_f32_32x32x16_bf16 v[176:191], v[252:255], v[228:231], v[176:191]
  buffer_load_dwordx4 v[12:15], v1, s[20:23], s30 offen sc1
  v_cvt_pk_bf16_f32 v224, v192, v193
  v_exp_f32 v196, v196
  v_exp_f32 v197, v197
  v_cvt_pk_bf16_f32 v225, v194, v195
  v_exp_f32 v198, v198
  v_exp_f32 v199, v199
  v_cvt_pk_bf16_f32 v226, v196, v197
  v_exp_f32 v200, v200
  v_mfma_f32_32x32x16_bf16 v[208:223], v[16:19], v[36:39], 0
  s_mov_b64 exec, s[36:37]
  buffer_load_dwordx4 v[248:251], v2, s[20:23], s31 offen sc1
  buffer_load_dwordx4 v[252:255], v2, s[20:23], s31 offen offset:512 sc1
  s_mov_b64 exec, -1
  v_exp_f32 v201, v201
  v_cvt_pk_bf16_f32 v227, v198, v199
  v_exp_f32 v202, v202
  v_exp_f32 v203, v203
  v_cvt_pk_bf16_f32 v228, v200, v201
  v_exp_f32 v204, v204
  v_exp_f32 v205, v205
  v_mfma_f32_32x32x16_bf16 v[64:79], v[24:27], v[224:227], v[64:79]
  v_cvt_pk_bf16_f32 v229, v202, v203
  v_exp_f32 v206, v206
  v_exp_f32 v207, v207
  v_cvt_pk_bf16_f32 v230, v204, v205
  v_exp_f32 v208, v208
  v_cvt_pk_bf16_f32 v231, v206, v207
  v_exp_f32 v209, v209
  v_exp_f32 v210, v210
  v_exp_f32 v211, v211
  v_mfma_f32_32x32x16_bf16 v[64:79], v[28:31], v[228:231], v[64:79]
  s_add_u32 s30, s30, 1024
  v_cvt_pk_bf16_f32 v224, v208, v209
  v_exp_f32 v212, v212
  v_exp_f32 v213, v213
  v_cvt_pk_bf16_f32 v225, v210, v211
  v_exp_f32 v214, v214
  v_exp_f32 v215, v215
  v_cvt_pk_bf16_f32 v226, v212, v213
  v_exp_f32 v216, v216
  v_mfma_f32_32x32x16_bf16 v[192:207], v[16:19], v[40:43], 0
  s_add_u32 s31, s31, 1024
  v_exp_f32 v217, v217
  v_cvt_pk_bf16_f32 v227, v214, v215
  v_exp_f32 v218, v218
  v_exp_f32 v219, v219
  v_cvt_pk_bf16_f32 v228, v216, v217
  v_exp_f32 v220, v220
  v_exp_f32 v221, v221
  v_mfma_f32_32x32x16_bf16 v[80:95], v[24:27], v[224:227], v[80:95]
  v_cvt_pk_bf16_f32 v229, v218, v219
  v_exp_f32 v222, v222
  v_exp_f32 v223, v223
  v_cvt_pk_bf16_f32 v230, v220, v221
  v_exp_f32 v192, v192
  v_cvt_pk_bf16_f32 v231, v222, v223
  v_exp_f32 v193, v193
  v_exp_f32 v194, v194
  v_exp_f32 v195, v195
  v_mfma_f32_32x32x16_bf16 v[80:95], v[28:31], v[228:231], v[80:95]
  v_cvt_pk_bf16_f32 v224, v192, v193
  v_exp_f32 v196, v196
  v_exp_f32 v197, v197
  v_cvt_pk_bf16_f32 v225, v194, v195
  v_exp_f32 v198, v198
  v_exp_f32 v199, v199
  v_cvt_pk_bf16_f32 v226, v196, v197
  v_exp_f32 v200, v200
  v_mfma_f32_32x32x16_bf16 v[208:223], v[16:19], v[44:47], 0
  v_exp_f32 v201, v201
  v_cvt_pk_bf16_f32 v227, v198, v199
  v_exp_f32 v202, v202
  v_exp_f32 v203, v203
  v_cvt_pk_bf16_f32 v228, v200, v201
  v_exp_f32 v204, v204
  v_exp_f32 v205, v205
  v_mfma_f32_32x32x16_bf16 v[96:111], v[24:27], v[224:227], v[96:111]
  v_cvt_pk_bf16_f32 v229, v202, v203
  v_exp_f32 v206, v206
  v_exp_f32 v207, v207
  v_cvt_pk_bf16_f32 v230, v204, v205
  v_exp_f32 v208, v208
  v_cvt_pk_bf16_f32 v231, v206, v207
  v_exp_f32 v209, v209
  v_exp_f32 v210, v210
  v_exp_f32 v211, v211
  v_mfma_f32_32x32x16_bf16 v[96:111], v[28:31], v[228:231], v[96:111]
  v_cvt_pk_bf16_f32 v224, v208, v209
  v_exp_f32 v212, v212
  v_exp_f32 v213, v213
  v_cvt_pk_bf16_f32 v225, v210, v211
  v_exp_f32 v214, v214
  v_exp_f32 v215, v215
  v_cvt_pk_bf16_f32 v226, v212, v213
  v_exp_f32 v216, v216
  v_mfma_f32_32x32x16_bf16 v[192:207], v[16:19], v[48:51], 0
  v_exp_f32 v217, v217
  v_cvt_pk_bf16_f32 v227, v214, v215
  v_exp_f32 v218, v218
  v_exp_f32 v219, v219
  v_cvt_pk_bf16_f32 v228, v216, v217
  v_exp_f32 v220, v220
  v_exp_f32 v221, v221
  v_mfma_f32_32x32x16_bf16 v[112:127], v[24:27], v[224:227], v[112:127]
  v_cvt_pk_bf16_f32 v229, v218, v219
  v_exp_f32 v222, v222
  v_exp_f32 v223, v223
  v_cvt_pk_bf16_f32 v230, v220, v221
  v_exp_f32 v192, v192
  v_cvt_pk_bf16_f32 v231, v222, v223
  v_exp_f32 v193, v193
  v_exp_f32 v194, v194
  v_exp_f32 v195, v195
  v_mfma_f32_32x32x16_bf16 v[112:127], v[28:31], v[228:231], v[112:127]
  v_cvt_pk_bf16_f32 v224, v192, v193
  v_exp_f32 v196, v196
  v_exp_f32 v197, v197
  v_cvt_pk_bf16_f32 v225, v194, v195
  v_exp_f32 v198, v198
  v_exp_f32 v199, v199
  v_cvt_pk_bf16_f32 v226, v196, v197
  v_exp_f32 v200, v200
  v_mfma_f32_32x32x16_bf16 v[208:223], v[16:19], v[52:55], 0
  v_exp_f32 v201, v201
  v_cvt_pk_bf16_f32 v227, v198, v199
  v_exp_f32 v202, v202
  v_exp_f32 v203, v203
  v_cvt_pk_bf16_f32 v228, v200, v201
  v_exp_f32 v204, v204
  v_exp_f32 v205, v205
  v_mfma_f32_32x32x16_bf16 v[128:143], v[24:27], v[224:227], v[128:143]
  v_cvt_pk_bf16_f32 v229, v202, v203
  v_exp_f32 v206, v206
  v_exp_f32 v207, v207
  v_cvt_pk_bf16_f32 v230, v204, v205
  v_exp_f32 v208, v208
  v_cvt_pk_bf16_f32 v231, v206, v207
  v_exp_f32 v209, v209
  v_exp_f32 v210, v210
  v_exp_f32 v211, v211
  v_mfma_f32_32x32x16_bf16 v[128:143], v[28:31], v[228:231], v[128:143]
  v_cvt_pk_bf16_f32 v224, v208, v209
  v_exp_f32 v212, v212
  v_exp_f32 v213, v213
  v_cvt_pk_bf16_f32 v225, v210, v211
  v_exp_f32 v214, v214
  v_exp_f32 v215, v215
  v_cvt_pk_bf16_f32 v226, v212, v213
  v_exp_f32 v216, v216
  v_mfma_f32_32x32x16_bf16 v[192:207], v[16:19], v[56:59], 0
  v_exp_f32 v217, v217
  v_cvt_pk_bf16_f32 v227, v214, v215
  v_exp_f32 v218, v218
  v_exp_f32 v219, v219
  v_cvt_pk_bf16_f32 v228, v216, v217
  v_exp_f32 v220, v220
  v_exp_f32 v221, v221
  v_mfma_f32_32x32x16_bf16 v[144:159], v[24:27], v[224:227], v[144:159]
  v_cvt_pk_bf16_f32 v229, v218, v219
  v_exp_f32 v222, v222
  v_exp_f32 v223, v223
  v_cvt_pk_bf16_f32 v230, v220, v221
  v_exp_f32 v192, v192
  v_cvt_pk_bf16_f32 v231, v222, v223
  v_exp_f32 v193, v193
  v_exp_f32 v194, v194
  v_exp_f32 v195, v195
  v_mfma_f32_32x32x16_bf16 v[144:159], v[28:31], v[228:231], v[144:159]
  v_cvt_pk_bf16_f32 v224, v192, v193
  v_exp_f32 v196, v196
  v_exp_f32 v197, v197
  v_cvt_pk_bf16_f32 v225, v194, v195
  v_exp_f32 v198, v198
  v_exp_f32 v199, v199
  v_cvt_pk_bf16_f32 v226, v196, v197
  v_exp_f32 v200, v200
  v_mfma_f32_32x32x16_bf16 v[208:223], v[16:19], v[60:63], 0
  v_exp_f32 v201, v201
  v_cvt_pk_bf16_f32 v227, v198, v199
  v_exp_f32 v202, v202
  v_exp_f32 v203, v203
  v_cvt_pk_bf16_f32 v228, v200, v201
  v_exp_f32 v204, v204
  v_exp_f32 v205, v205
  v_mfma_f32_32x32x16_bf16 v[160:175], v[24:27], v[224:227], v[160:175]
  v_cvt_pk_bf16_f32 v229, v202, v203
  v_exp_f32 v206, v206
  v_exp_f32 v207, v207
  v_cvt_pk_bf16_f32 v230, v204, v205
  v_exp_f32 v208, v208
  v_cvt_pk_bf16_f32 v231, v206, v207
  v_exp_f32 v209, v209
  v_exp_f32 v210, v210
  v_exp_f32 v211, v211
  v_mfma_f32_32x32x16_bf16 v[160:175], v[28:31], v[228:231], v[160:175]
  v_cvt_pk_bf16_f32 v224, v208, v209
  v_exp_f32 v212, v212
  v_exp_f32 v213, v213
  v_cvt_pk_bf16_f32 v225, v210, v211
  v_exp_f32 v214, v214
  v_exp_f32 v215, v215
  v_cvt_pk_bf16_f32 v226, v212, v213
  v_exp_f32 v216, v216
  s_waitcnt vmcnt(6)
  v_mfma_f32_32x32x16_bf16 v[192:207], v[20:23], v[32:35], 0
  v_exp_f32 v217, v217
  v_cvt_pk_bf16_f32 v227, v214, v215
  v_exp_f32 v218, v218
  v_exp_f32 v219, v219
  v_cvt_pk_bf16_f32 v228, v216, v217
  v_exp_f32 v220, v220
  v_exp_f32 v221, v221
  v_mfma_f32_32x32x16_bf16 v[176:191], v[24:27], v[224:227], v[176:191]
  v_cvt_pk_bf16_f32 v229, v218, v219
  v_exp_f32 v222, v222
  v_exp_f32 v223, v223
  v_cvt_pk_bf16_f32 v230, v220, v221
  v_exp_f32 v192, v192
  v_cvt_pk_bf16_f32 v231, v222, v223
  v_exp_f32 v193, v193
  v_exp_f32 v194, v194
  v_exp_f32 v195, v195
  v_mfma_f32_32x32x16_bf16 v[176:191], v[28:31], v[228:231], v[176:191]
  buffer_load_dwordx4 v[16:19], v1, s[20:23], s30 offen sc1
  v_cvt_pk_bf16_f32 v224, v192, v193
  v_exp_f32 v196, v196
  v_exp_f32 v197, v197
  v_cvt_pk_bf16_f32 v225, v194, v195
  v_exp_f32 v198, v198
  v_exp_f32 v199, v199
  v_cvt_pk_bf16_f32 v226, v196, v197
  v_exp_f32 v200, v200
  v_mfma_f32_32x32x16_bf16 v[208:223], v[20:23], v[36:39], 0
  s_mov_b64 exec, s[36:37]
  buffer_load_dwordx4 v[24:27], v2, s[20:23], s31 offen sc1
  buffer_load_dwordx4 v[28:31], v2, s[20:23], s31 offen offset:512 sc1
  s_mov_b64 exec, -1
  v_exp_f32 v201, v201
  v_cvt_pk_bf16_f32 v227, v198, v199
  v_exp_f32 v202, v202
  v_exp_f32 v203, v203
  v_cvt_pk_bf16_f32 v228, v200, v201
  v_exp_f32 v204, v204
  v_exp_f32 v205, v205
  v_mfma_f32_32x32x16_bf16 v[64:79], v[232:235], v[224:227], v[64:79]
  v_cvt_pk_bf16_f32 v229, v202, v203
  v_exp_f32 v206, v206
  v_exp_f32 v207, v207
  v_cvt_pk_bf16_f32 v230, v204, v205
  v_exp_f32 v208, v208
  v_cvt_pk_bf16_f32 v231, v206, v207
  v_exp_f32 v209, v209
  v_exp_f32 v210, v210
  v_exp_f32 v211, v211
  v_mfma_f32_32x32x16_bf16 v[64:79], v[236:239], v[228:231], v[64:79]
  s_add_u32 s30, s30, 1024
  v_cvt_pk_bf16_f32 v224, v208, v209
  v_exp_f32 v212, v212
  v_exp_f32 v213, v213
  v_cvt_pk_bf16_f32 v225, v210, v211
  v_exp_f32 v214, v214
  v_exp_f32 v215, v215
  v_cvt_pk_bf16_f32 v226, v212, v213
  v_exp_f32 v216, v216
  v_mfma_f32_32x32x16_bf16 v[192:207], v[20:23], v[40:43], 0
  s_add_u32 s31, s31, 1024
  v_exp_f32 v217, v217
  v_cvt_pk_bf16_f32 v227, v214, v215
  v_exp_f32 v218, v218
  v_exp_f32 v219, v219
  v_cvt_pk_bf16_f32 v228, v216, v217
  v_exp_f32 v220, v220
  v_exp_f32 v221, v221
  v_mfma_f32_32x32x16_bf16 v[80:95], v[232:235], v[224:227], v[80:95]
  v_cvt_pk_bf16_f32 v229, v218, v219
  v_exp_f32 v222, v222
  v_exp_f32 v223, v223
  v_cvt_pk_bf16_f32 v230, v220, v221
  v_exp_f32 v192, v192
  v_cvt_pk_bf16_f32 v231, v222, v223
  v_exp_f32 v193, v193
  v_exp_f32 v194, v194
  v_exp_f32 v195, v195
  v_mfma_f32_32x32x16_bf16 v[80:95], v[236:239], v[228:231], v[80:95]
  v_cvt_pk_bf16_f32 v224, v192, v193
  v_exp_f32 v196, v196
  v_exp_f32 v197, v197
  v_cvt_pk_bf16_f32 v225, v194, v195
  v_exp_f32 v198, v198
  v_exp_f32 v199, v199
  v_cvt_pk_bf16_f32 v226, v196, v197
  v_exp_f32 v200, v200
  v_mfma_f32_32x32x16_bf16 v[208:223], v[20:23], v[44:47], 0
  v_exp_f32 v201, v201
  v_cvt_pk_bf16_f32 v227, v198, v199
  v_exp_f32 v202, v202
  v_exp_f32 v203, v203
  v_cvt_pk_bf16_f32 v228, v200, v201
  v_exp_f32 v204, v204
  v_exp_f32 v205, v205
  v_mfma_f32_32x32x16_bf16 v[96:111], v[232:235], v[224:227], v[96:111]
  v_cvt_pk_bf16_f32 v229, v202, v203
  v_exp_f32 v206, v206
  v_exp_f32 v207, v207
  v_cvt_pk_bf16_f32 v230, v204, v205
  v_exp_f32 v208, v208
  v_cvt_pk_bf16_f32 v231, v206, v207
  v_exp_f32 v209, v209
  v_exp_f32 v210, v210
  v_exp_f32 v211, v211
  v_mfma_f32_32x32x16_bf16 v[96:111], v[236:239], v[228:231], v[96:111]
  v_cvt_pk_bf16_f32 v224, v208, v209
  v_exp_f32 v212, v212
  v_exp_f32 v213, v213
  v_cvt_pk_bf16_f32 v225, v210, v211
  v_exp_f32 v214, v214
  v_exp_f32 v215, v215
  v_cvt_pk_bf16_f32 v226, v212, v213
  v_exp_f32 v216, v216
  v_mfma_f32_32x32x16_bf16 v[192:207], v[20:23], v[48:51], 0
  v_exp_f32 v217, v217
  v_cvt_pk_bf16_f32 v227, v214, v215
  v_exp_f32 v218, v218
  v_exp_f32 v219, v219
  v_cvt_pk_bf16_f32 v228, v216, v217
  v_exp_f32 v220, v220
  v_exp_f32 v221, v221
  v_mfma_f32_32x32x16_bf16 v[112:127], v[232:235], v[224:227], v[112:127]
  v_cvt_pk_bf16_f32 v229, v218, v219
  v_exp_f32 v222, v222
  v_exp_f32 v223, v223
  v_cvt_pk_bf16_f32 v230, v220, v221
  v_exp_f32 v192, v192
  v_cvt_pk_bf16_f32 v231, v222, v223
  v_exp_f32 v193, v193
  v_exp_f32 v194, v194
  v_exp_f32 v195, v195
  v_mfma_f32_32x32x16_bf16 v[112:127], v[236:239], v[228:231], v[112:127]
  v_cvt_pk_bf16_f32 v224, v192, v193
  v_exp_f32 v196, v196
  v_exp_f32 v197, v197
  v_cvt_pk_bf16_f32 v225, v194, v195
  v_exp_f32 v198, v198
  v_exp_f32 v199, v199
  v_cvt_pk_bf16_f32 v226, v196, v197
  v_exp_f32 v200, v200
  v_mfma_f32_32x32x16_bf16 v[208:223], v[20:23], v[52:55], 0
  v_exp_f32 v201, v201
  v_cvt_pk_bf16_f32 v227, v198, v199
  v_exp_f32 v202, v202
  v_exp_f32 v203, v203
  v_cvt_pk_bf16_f32 v228, v200, v201
  v_exp_f32 v204, v204
  v_exp_f32 v205, v205
  v_mfma_f32_32x32x16_bf16 v[128:143], v[232:235], v[224:227], v[128:143]
  v_cvt_pk_bf16_f32 v229, v202, v203
  v_exp_f32 v206, v206
  v_exp_f32 v207, v207
  v_cvt_pk_bf16_f32 v230, v204, v205
  v_exp_f32 v208, v208
  v_cvt_pk_bf16_f32 v231, v206, v207
  v_exp_f32 v209, v209
  v_exp_f32 v210, v210
  v_exp_f32 v211, v211
  v_mfma_f32_32x32x16_bf16 v[128:143], v[236:239], v[228:231], v[128:143]
  v_cvt_pk_bf16_f32 v224, v208, v209
  v_exp_f32 v212, v212
  v_exp_f32 v213, v213
  v_cvt_pk_bf16_f32 v225, v210, v211
  v_exp_f32 v214, v214
  v_exp_f32 v215, v215
  v_cvt_pk_bf16_f32 v226, v212, v213
  v_exp_f32 v216, v216
  v_mfma_f32_32x32x16_bf16 v[192:207], v[20:23], v[56:59], 0
  v_exp_f32 v217, v217
  v_cvt_pk_bf16_f32 v227, v214, v215
  v_exp_f32 v218, v218
  v_exp_f32 v219, v219
  v_cvt_pk_bf16_f32 v228, v216, v217
  v_exp_f32 v220, v220
  v_exp_f32 v221, v221
  v_mfma_f32_32x32x16_bf16 v[144:159], v[232:235], v[224:227], v[144:159]
  v_cvt_pk_bf16_f32 v229, v218, v219
  v_exp_f32 v222, v222
  v_exp_f32 v223, v223
  v_cvt_pk_bf16_f32 v230, v220, v221
  v_exp_f32 v192, v192
  v_cvt_pk_bf16_f32 v231, v222, v223
  v_exp_f32 v193, v193
  v_exp_f32 v194, v194
  v_exp_f32 v195, v195
  v_mfma_f32_32x32x16_bf16 v[144:159], v[236:239], v[228:231], v[144:159]
  v_cvt_pk_bf16_f32 v224, v192, v193
  v_exp_f32 v196, v196
  v_exp_f32 v197, v197
  v_cvt_pk_bf16_f32 v225, v194, v195
  v_exp_f32 v198, v198
  v_exp_f32 v199, v199
  v_cvt_pk_bf16_f32 v226, v196, v197
  v_exp_f32 v200, v200
  v_mfma_f32_32x32x16_bf16 v[208:223], v[20:23], v[60:63], 0
  v_exp_f32 v201, v201
  v_cvt_pk_bf16_f32 v227, v198, v199
  v_exp_f32 v202, v202
  v_exp_f32 v203, v203
  v_cvt_pk_bf16_f32 v228, v200, v201
  v_exp_f32 v204, v204
  v_exp_f32 v205, v205
  v_mfma_f32_32x32x16_bf16 v[160:175], v[232:235], v[224:227], v[160:175]
  v_cvt_pk_bf16_f32 v229, v202, v203
  v_exp_f32 v206, v206
  v_exp_f32 v207, v207
  v_cvt_pk_bf16_f32 v230, v204, v205
  v_exp_f32 v208, v208
  v_cvt_pk_bf16_f32 v231, v206, v207
  v_exp_f32 v209, v209
  v_exp_f32 v210, v210
  v_exp_f32 v211, v211
  v_mfma_f32_32x32x16_bf16 v[160:175], v[236:239], v[228:231], v[160:175]
  v_cvt_pk_bf16_f32 v224, v208, v209
  v_exp_f32 v212, v212
  v_exp_f32 v213, v213
  v_cvt_pk_bf16_f32 v225, v210, v211
  v_exp_f32 v214, v214
  v_exp_f32 v215, v215
  v_cvt_pk_bf16_f32 v226, v212, v213
  v_exp_f32 v216, v216
  s_waitcnt vmcnt(6)
  v_mfma_f32_32x32x16_bf16 v[192:207], v[8:11], v[32:35], 0
  v_exp_f32 v217, v217
  v_cvt_pk_bf16_f32 v227, v214, v215
  v_exp_f32 v218, v218
  v_exp_f32 v219, v219
  v_cvt_pk_bf16_f32 v228, v216, v217
  v_exp_f32 v220, v220
  v_exp_f32 v221, v221
  v_mfma_f32_32x32x16_bf16 v[176:191], v[232:235], v[224:227], v[176:191]
  v_cvt_pk_bf16_f32 v229, v218, v219
  v_exp_f32 v222, v222
  v_exp_f32 v223, v223
  v_cvt_pk_bf16_f32 v230, v220, v221
  v_exp_f32 v192, v192
  v_cvt_pk_bf16_f32 v231, v222, v223
  v_exp_f32 v193, v193
  v_exp_f32 v194, v194
  v_exp_f32 v195, v195
  v_mfma_f32_32x32x16_bf16 v[176:191], v[236:239], v[228:231], v[176:191]
  buffer_load_dwordx4 v[20:23], v1, s[20:23], s30 offen sc1
  v_cvt_pk_bf16_f32 v224, v192, v193
  v_exp_f32 v196, v196
  v_exp_f32 v197, v197
  v_cvt_pk_bf16_f32 v225, v194, v195
  v_exp_f32 v198, v198
  v_exp_f32 v199, v199
  v_cvt_pk_bf16_f32 v226, v196, v197
  v_exp_f32 v200, v200
  v_mfma_f32_32x32x16_bf16 v[208:223], v[8:11], v[36:39], 0
  s_mov_b64 exec, s[36:37]
  buffer_load_dwordx4 v[232:235], v2, s[20:23], s31 offen sc1
  buffer_load_dwordx4 v[236:239], v2, s[20:23], s31 offen offset:512 sc1
  s_mov_b64 exec, -1
  v_exp_f32 v201, v201
  v_cvt_pk_bf16_f32 v227, v198, v199
  v_exp_f32 v202, v202
  v_exp_f32 v203, v203
  v_cvt_pk_bf16_f32 v228, v200, v201
  v_exp_f32 v204, v204
  v_exp_f32 v205, v205
  v_mfma_f32_32x32x16_bf16 v[64:79], v[240:243], v[224:227], v[64:79]
  v_cvt_pk_bf16_f32 v229, v202, v203
  v_exp_f32 v206, v206
  v_exp_f32 v207, v207
  v_cvt_pk_bf16_f32 v230, v204, v205
  v_exp_f32 v208, v208
  v_cvt_pk_bf16_f32 v231, v206, v207
  v_exp_f32 v209, v209
  v_exp_f32 v210, v210
  v_exp_f32 v211, v211
  v_mfma_f32_32x32x16_bf16 v[64:79], v[244:247], v[228:231], v[64:79]
  s_add_u32 s30, s30, 1024
  v_cvt_pk_bf16_f32 v224, v208, v209
  v_exp_f32 v212, v212
  v_exp_f32 v213, v213
  v_cvt_pk_bf16_f32 v225, v210, v211
  v_exp_f32 v214, v214
  v_exp_f32 v215, v215
  v_cvt_pk_bf16_f32 v226, v212, v213
  v_exp_f32 v216, v216
  v_mfma_f32_32x32x16_bf16 v[192:207], v[8:11], v[40:43], 0
  s_add_u32 s31, s31, 1024
  v_exp_f32 v217, v217
  v_cvt_pk_bf16_f32 v227, v214, v215
  v_exp_f32 v218, v218
  v_exp_f32 v219, v219
  v_cvt_pk_bf16_f32 v228, v216, v217
  v_exp_f32 v220, v220
  v_exp_f32 v221, v221
  v_mfma_f32_32x32x16_bf16 v[80:95], v[240:243], v[224:227], v[80:95]
  v_cvt_pk_bf16_f32 v229, v218, v219
  v_exp_f32 v222, v222
  v_exp_f32 v223, v223
  v_cvt_pk_bf16_f32 v230, v220, v221
  v_exp_f32 v192, v192
  v_cvt_pk_bf16_f32 v231, v222, v223
  v_exp_f32 v193, v193
  v_exp_f32 v194, v194
  v_exp_f32 v195, v195
  v_mfma_f32_32x32x16_bf16 v[80:95], v[244:247], v[228:231], v[80:95]
  v_cvt_pk_bf16_f32 v224, v192, v193
  v_exp_f32 v196, v196
  v_exp_f32 v197, v197
  v_cvt_pk_bf16_f32 v225, v194, v195
  v_exp_f32 v198, v198
  v_exp_f32 v199, v199
  v_cvt_pk_bf16_f32 v226, v196, v197
  v_exp_f32 v200, v200
  v_mfma_f32_32x32x16_bf16 v[208:223], v[8:11], v[44:47], 0
  v_exp_f32 v201, v201
  v_cvt_pk_bf16_f32 v227, v198, v199
  v_exp_f32 v202, v202
  v_exp_f32 v203, v203
  v_cvt_pk_bf16_f32 v228, v200, v201
  v_exp_f32 v204, v204
  v_exp_f32 v205, v205
  v_mfma_f32_32x32x16_bf16 v[96:111], v[240:243], v[224:227], v[96:111]
  v_cvt_pk_bf16_f32 v229, v202, v203
  v_exp_f32 v206, v206
  v_exp_f32 v207, v207
  v_cvt_pk_bf16_f32 v230, v204, v205
  v_exp_f32 v208, v208
  v_cvt_pk_bf16_f32 v231, v206, v207
  v_exp_f32 v209, v209
  v_exp_f32 v210, v210
  v_exp_f32 v211, v211
  v_mfma_f32_32x32x16_bf16 v[96:111], v[244:247], v[228:231], v[96:111]
  v_cvt_pk_bf16_f32 v224, v208, v209
  v_exp_f32 v212, v212
  v_exp_f32 v213, v213
  v_cvt_pk_bf16_f32 v225, v210, v211
  v_exp_f32 v214, v214
  v_exp_f32 v215, v215
  v_cvt_pk_bf16_f32 v226, v212, v213
  v_exp_f32 v216, v216
  v_mfma_f32_32x32x16_bf16 v[192:207], v[8:11], v[48:51], 0
  v_exp_f32 v217, v217
  v_cvt_pk_bf16_f32 v227, v214, v215
  v_exp_f32 v218, v218
  v_exp_f32 v219, v219
  v_cvt_pk_bf16_f32 v228, v216, v217
  v_exp_f32 v220, v220
  v_exp_f32 v221, v221
  v_mfma_f32_32x32x16_bf16 v[112:127], v[240:243], v[224:227], v[112:127]
  v_cvt_pk_bf16_f32 v229, v218, v219
  v_exp_f32 v222, v222
  v_exp_f32 v223, v223
  v_cvt_pk_bf16_f32 v230, v220, v221
  v_exp_f32 v192, v192
  v_cvt_pk_bf16_f32 v231, v222, v223
  v_exp_f32 v193, v193
  v_exp_f32 v194, v194
  v_exp_f32 v195, v195
  v_mfma_f32_32x32x16_bf16 v[112:127], v[244:247], v[228:231], v[112:127]
  v_cvt_pk_bf16_f32 v224, v192, v193
  v_exp_f32 v196, v196
  v_exp_f32 v197, v197
  v_cvt_pk_bf16_f32 v225, v194, v195
  v_exp_f32 v198, v198
  v_exp_f32 v199, v199
  v_cvt_pk_bf16_f32 v226, v196, v197
  v_exp_f32 v200, v200
  v_mfma_f32_32x32x16_bf16 v[208:223], v[8:11], v[52:55], 0
  v_exp_f32 v201, v201
  v_cvt_pk_bf16_f32 v227, v198, v199
  v_exp_f32 v202, v202
  v_exp_f32 v203, v203
  v_cvt_pk_bf16_f32 v228, v200, v201
  v_exp_f32 v204, v204
  v_exp_f32 v205, v205
  v_mfma_f32_32x32x16_bf16 v[128:143], v[240:243], v[224:227], v[128:143]
  v_cvt_pk_bf16_f32 v229, v202, v203
  v_exp_f32 v206, v206
  v_exp_f32 v207, v207
  v_cvt_pk_bf16_f32 v230, v204, v205
  v_exp_f32 v208, v208
  v_cvt_pk_bf16_f32 v231, v206, v207
  v_exp_f32 v209, v209
  v_exp_f32 v210, v210
  v_exp_f32 v211, v211
  v_mfma_f32_32x32x16_bf16 v[128:143], v[244:247], v[228:231], v[128:143]
  v_cvt_pk_bf16_f32 v224, v208, v209
  v_exp_f32 v212, v212
  v_exp_f32 v213, v213
  v_cvt_pk_bf16_f32 v225, v210, v211
  v_exp_f32 v214, v214
  v_exp_f32 v215, v215
  v_cvt_pk_bf16_f32 v226, v212, v213
  v_exp_f32 v216, v216
  v_mfma_f32_32x32x16_bf16 v[192:207], v[8:11], v[56:59], 0
  v_exp_f32 v217, v217
  v_cvt_pk_bf16_f32 v227, v214, v215
  v_exp_f32 v218, v218
  v_exp_f32 v219, v219
  v_cvt_pk_bf16_f32 v228, v216, v217
  v_exp_f32 v220, v220
  v_exp_f32 v221, v221
  v_mfma_f32_32x32x16_bf16 v[144:159], v[240:243], v[224:227], v[144:159]
  v_cvt_pk_bf16_f32 v229, v218, v219
  v_exp_f32 v222, v222
  v_exp_f32 v223, v223
  v_cvt_pk_bf16_f32 v230, v220, v221
  v_exp_f32 v192, v192
  v_cvt_pk_bf16_f32 v231, v222, v223
  v_exp_f32 v193, v193
  v_exp_f32 v194, v194
  v_exp_f32 v195, v195
  v_mfma_f32_32x32x16_bf16 v[144:159], v[244:247], v[228:231], v[144:159]
  v_cvt_pk_bf16_f32 v224, v192, v193
  v_exp_f32 v196, v196
  v_exp_f32 v197, v197
  v_cvt_pk_bf16_f32 v225, v194, v195
  v_exp_f32 v198, v198
  v_exp_f32 v199, v199
  v_cvt_pk_bf16_f32 v226, v196, v197
  v_exp_f32 v200, v200
  v_mfma_f32_32x32x16_bf16 v[208:223], v[8:11], v[60:63], 0
  v_exp_f32 v201, v201
  v_cvt_pk_bf16_f32 v227, v198, v199
  v_exp_f32 v202, v202
  v_exp_f32 v203, v203
  v_cvt_pk_bf16_f32 v228, v200, v201
  v_exp_f32 v204, v204
  v_exp_f32 v205, v205
  v_mfma_f32_32x32x16_bf16 v[160:175], v[240:243], v[224:227], v[160:175]
  v_cvt_pk_bf16_f32 v229, v202, v203
  v_exp_f32 v206, v206
  v_exp_f32 v207, v207
  v_cvt_pk_bf16_f32 v230, v204, v205
  v_exp_f32 v208, v208
  v_cvt_pk_bf16_f32 v231, v206, v207
  v_exp_f32 v209, v209
  v_exp_f32 v210, v210
  v_exp_f32 v211, v211
  v_mfma_f32_32x32x16_bf16 v[160:175], v[244:247], v[228:231], v[160:175]
  v_cvt_pk_bf16_f32 v224, v208, v209
  v_exp_f32 v212, v212
  v_exp_f32 v213, v213
  v_cvt_pk_bf16_f32 v225, v210, v211
  v_exp_f32 v214, v214
  v_exp_f32 v215, v215
  v_cvt_pk_bf16_f32 v226, v212, v213
  v_exp_f32 v216, v216
  s_waitcnt vmcnt(6)
  v_mfma_f32_32x32x16_bf16 v[192:207], v[12:15], v[32:35], 0
  v_exp_f32 v217, v217
  v_cvt_pk_bf16_f32 v227, v214, v215
  v_exp_f32 v218, v218
  v_exp_f32 v219, v219
  v_cvt_pk_bf16_f32 v228, v216, v217
  v_exp_f32 v220, v220
  v_exp_f32 v221, v221
  v_mfma_f32_32x32x16_bf16 v[176:191], v[240:243], v[224:227], v[176:191]
  v_cvt_pk_bf16_f32 v229, v218, v219
  v_exp_f32 v222, v222
  v_exp_f32 v223, v223
  v_cvt_pk_bf16_f32 v230, v220, v221
  v_exp_f32 v192, v192
  v_cvt_pk_bf16_f32 v231, v222, v223
  v_exp_f32 v193, v193
  v_exp_f32 v194, v194
  v_exp_f32 v195, v195
  v_mfma_f32_32x32x16_bf16 v[176:191], v[244:247], v[228:231], v[176:191]
  buffer_load_dwordx4 v[8:11], v1, s[20:23], s30 offen sc1
  v_cvt_pk_bf16_f32 v224, v192, v193
  v_exp_f32 v196, v196
  v_exp_f32 v197, v197
  v_cvt_pk_bf16_f32 v225, v194, v195
  v_exp_f32 v198, v198
  v_exp_f32 v199, v199
  v_cvt_pk_bf16_f32 v226, v196, v197
  v_exp_f32 v200, v200
  v_mfma_f32_32x32x16_bf16 v[208:223], v[12:15], v[36:39], 0
  s_mov_b64 exec, s[36:37]
  buffer_load_dwordx4 v[240:243], v2, s[20:23], s31 offen sc1
  buffer_load_dwordx4 v[244:247], v2, s[20:23], s31 offen offset:512 sc1
  s_mov_b64 exec, -1
  v_exp_f32 v201, v201
  v_cvt_pk_bf16_f32 v227, v198, v199
  v_exp_f32 v202, v202
  v_exp_f32 v203, v203
  v_cvt_pk_bf16_f32 v228, v200, v201
  v_exp_f32 v204, v204
  v_exp_f32 v205, v205
  v_mfma_f32_32x32x16_bf16 v[64:79], v[248:251], v[224:227], v[64:79]
  v_cvt_pk_bf16_f32 v229, v202, v203
  v_exp_f32 v206, v206
  v_exp_f32 v207, v207
  v_cvt_pk_bf16_f32 v230, v204, v205
  v_exp_f32 v208, v208
  v_cvt_pk_bf16_f32 v231, v206, v207
  v_exp_f32 v209, v209
  v_exp_f32 v210, v210
  v_exp_f32 v211, v211
  v_mfma_f32_32x32x16_bf16 v[64:79], v[252:255], v[228:231], v[64:79]
  s_add_u32 s30, s30, 1024
  v_cvt_pk_bf16_f32 v224, v208, v209
  v_exp_f32 v212, v212
  v_exp_f32 v213, v213
  v_cvt_pk_bf16_f32 v225, v210, v211
  v_exp_f32 v214, v214
  v_exp_f32 v215, v215
  v_cvt_pk_bf16_f32 v226, v212, v213
  v_exp_f32 v216, v216
  v_mfma_f32_32x32x16_bf16 v[192:207], v[12:15], v[40:43], 0
  s_add_u32 s31, s31, 1024
  v_exp_f32 v217, v217
  v_cvt_pk_bf16_f32 v227, v214, v215
  v_exp_f32 v218, v218
  v_exp_f32 v219, v219
  v_cvt_pk_bf16_f32 v228, v216, v217
  v_exp_f32 v220, v220
  v_exp_f32 v221, v221
  v_mfma_f32_32x32x16_bf16 v[80:95], v[248:251], v[224:227], v[80:95]
  v_cvt_pk_bf16_f32 v229, v218, v219
  v_exp_f32 v222, v222
  v_exp_f32 v223, v223
  v_cvt_pk_bf16_f32 v230, v220, v221
  v_exp_f32 v192, v192
  v_cvt_pk_bf16_f32 v231, v222, v223
  v_exp_f32 v193, v193
  v_exp_f32 v194, v194
  v_exp_f32 v195, v195
  v_mfma_f32_32x32x16_bf16 v[80:95], v[252:255], v[228:231], v[80:95]
  v_cvt_pk_bf16_f32 v224, v192, v193
  v_exp_f32 v196, v196
  v_exp_f32 v197, v197
  v_cvt_pk_bf16_f32 v225, v194, v195
  v_exp_f32 v198, v198
  v_exp_f32 v199, v199
  v_cvt_pk_bf16_f32 v226, v196, v197
  v_exp_f32 v200, v200
  v_mfma_f32_32x32x16_bf16 v[208:223], v[12:15], v[44:47], 0
  v_exp_f32 v201, v201
  v_cvt_pk_bf16_f32 v227, v198, v199
  v_exp_f32 v202, v202
  v_exp_f32 v203, v203
  v_cvt_pk_bf16_f32 v228, v200, v201
  v_exp_f32 v204, v204
  v_exp_f32 v205, v205
  v_mfma_f32_32x32x16_bf16 v[96:111], v[248:251], v[224:227], v[96:111]
  v_cvt_pk_bf16_f32 v229, v202, v203
  v_exp_f32 v206, v206
  v_exp_f32 v207, v207
  v_cvt_pk_bf16_f32 v230, v204, v205
  v_exp_f32 v208, v208
  v_cvt_pk_bf16_f32 v231, v206, v207
  v_exp_f32 v209, v209
  v_exp_f32 v210, v210
  v_exp_f32 v211, v211
  v_mfma_f32_32x32x16_bf16 v[96:111], v[252:255], v[228:231], v[96:111]
  v_cvt_pk_bf16_f32 v224, v208, v209
  v_exp_f32 v212, v212
  v_exp_f32 v213, v213
  v_cvt_pk_bf16_f32 v225, v210, v211
  v_exp_f32 v214, v214
  v_exp_f32 v215, v215
  v_cvt_pk_bf16_f32 v226, v212, v213
  v_exp_f32 v216, v216
  v_mfma_f32_32x32x16_bf16 v[192:207], v[12:15], v[48:51], 0
  v_exp_f32 v217, v217
  v_cvt_pk_bf16_f32 v227, v214, v215
  v_exp_f32 v218, v218
  v_exp_f32 v219, v219
  v_cvt_pk_bf16_f32 v228, v216, v217
  v_exp_f32 v220, v220
  v_exp_f32 v221, v221
  v_mfma_f32_32x32x16_bf16 v[112:127], v[248:251], v[224:227], v[112:127]
  v_cvt_pk_bf16_f32 v229, v218, v219
  v_exp_f32 v222, v222
  v_exp_f32 v223, v223
  v_cvt_pk_bf16_f32 v230, v220, v221
  v_exp_f32 v192, v192
  v_cvt_pk_bf16_f32 v231, v222, v223
  v_exp_f32 v193, v193
  v_exp_f32 v194, v194
  v_exp_f32 v195, v195
  v_mfma_f32_32x32x16_bf16 v[112:127], v[252:255], v[228:231], v[112:127]
  v_cvt_pk_bf16_f32 v224, v192, v193
  v_exp_f32 v196, v196
  v_exp_f32 v197, v197
  v_cvt_pk_bf16_f32 v225, v194, v195
  v_exp_f32 v198, v198
  v_exp_f32 v199, v199
  v_cvt_pk_bf16_f32 v226, v196, v197
  v_exp_f32 v200, v200
  v_mfma_f32_32x32x16_bf16 v[208:223], v[12:15], v[52:55], 0
  v_exp_f32 v201, v201
  v_cvt_pk_bf16_f32 v227, v198, v199
  v_exp_f32 v202, v202
  v_exp_f32 v203, v203
  v_cvt_pk_bf16_f32 v228, v200, v201
  v_exp_f32 v204, v204
  v_exp_f32 v205, v205
  v_mfma_f32_32x32x16_bf16 v[128:143], v[248:251], v[224:227], v[128:143]
  v_cvt_pk_bf16_f32 v229, v202, v203
  v_exp_f32 v206, v206
  v_exp_f32 v207, v207
  v_cvt_pk_bf16_f32 v230, v204, v205
  v_exp_f32 v208, v208
  v_cvt_pk_bf16_f32 v231, v206, v207
  v_exp_f32 v209, v209
  v_exp_f32 v210, v210
  v_exp_f32 v211, v211
  v_mfma_f32_32x32x16_bf16 v[128:143], v[252:255], v[228:231], v[128:143]
  v_cvt_pk_bf16_f32 v224, v208, v209
  v_exp_f32 v212, v212
  v_exp_f32 v213, v213
  v_cvt_pk_bf16_f32 v225, v210, v211
  v_exp_f32 v214, v214
  v_exp_f32 v215, v215
  v_cvt_pk_bf16_f32 v226, v212, v213
  v_exp_f32 v216, v216
  v_mfma_f32_32x32x16_bf16 v[192:207], v[12:15], v[56:59], 0
  v_exp_f32 v217, v217
  v_cvt_pk_bf16_f32 v227, v214, v215
  v_exp_f32 v218, v218
  v_exp_f32 v219, v219
  v_cvt_pk_bf16_f32 v228, v216, v217
  v_exp_f32 v220, v220
  v_exp_f32 v221, v221
  v_mfma_f32_32x32x16_bf16 v[144:159], v[248:251], v[224:227], v[144:159]
  v_cvt_pk_bf16_f32 v229, v218, v219
  v_exp_f32 v222, v222
  v_exp_f32 v223, v223
  v_cvt_pk_bf16_f32 v230, v220, v221
  v_exp_f32 v192, v192
  v_cvt_pk_bf16_f32 v231, v222, v223
  v_exp_f32 v193, v193
  v_exp_f32 v194, v194
  v_exp_f32 v195, v195
  v_mfma_f32_32x32x16_bf16 v[144:159], v[252:255], v[228:231], v[144:159]
  v_cvt_pk_bf16_f32 v224, v192, v193
  v_exp_f32 v196, v196
  v_exp_f32 v197, v197
  v_cvt_pk_bf16_f32 v225, v194, v195
  v_exp_f32 v198, v198
  v_exp_f32 v199, v199
  v_cvt_pk_bf16_f32 v226, v196, v197
  v_exp_f32 v200, v200
  v_mfma_f32_32x32x16_bf16 v[208:223], v[12:15], v[60:63], 0
  v_exp_f32 v201, v201
  v_cvt_pk_bf16_f32 v227, v198, v199
  v_exp_f32 v202, v202
  v_exp_f32 v203, v203
  v_cvt_pk_bf16_f32 v228, v200, v201
  v_exp_f32 v204, v204
  v_exp_f32 v205, v205
  v_mfma_f32_32x32x16_bf16 v[160:175], v[248:251], v[224:227], v[160:175]
  v_cvt_pk_bf16_f32 v229, v202, v203
  v_exp_f32 v206, v206
  v_exp_f32 v207, v207
  v_cvt_pk_bf16_f32 v230, v204, v205
  v_exp_f32 v208, v208
  v_cvt_pk_bf16_f32 v231, v206, v207
  v_exp_f32 v209, v209
  v_exp_f32 v210, v210
  v_exp_f32 v211, v211
  v_mfma_f32_32x32x16_bf16 v[160:175], v[252:255], v[228:231], v[160:175]
  v_cvt_pk_bf16_f32 v224, v208, v209
  v_exp_f32 v212, v212
  v_exp_f32 v213, v213
  v_cvt_pk_bf16_f32 v225, v210, v211
  v_exp_f32 v214, v214
  v_exp_f32 v215, v215
  v_cvt_pk_bf16_f32 v226, v212, v213
  v_exp_f32 v216, v216
  s_waitcnt vmcnt(6)
  v_mfma_f32_32x32x16_bf16 v[192:207], v[16:19], v[32:35], 0
  v_exp_f32 v217, v217
  v_cvt_pk_bf16_f32 v227, v214, v215
  v_exp_f32 v218, v218
  v_exp_f32 v219, v219
  v_cvt_pk_bf16_f32 v228, v216, v217
  v_exp_f32 v220, v220
  v_exp_f32 v221, v221
  v_mfma_f32_32x32x16_bf16 v[176:191], v[248:251], v[224:227], v[176:191]
  v_cvt_pk_bf16_f32 v229, v218, v219
  v_exp_f32 v222, v222
  v_exp_f32 v223, v223
  v_cvt_pk_bf16_f32 v230, v220, v221

  s_add_u32 s38, s38, 1
  s_cmp_lt_u32 s38, 3
  s_cbranch_scc1 gated_mix__mha_block__swiglu_ffn__prompt_kernel_aloop
  v_exp_f32 v192, v192
  v_cvt_pk_bf16_f32 v231, v222, v223
  v_exp_f32 v193, v193
  v_exp_f32 v194, v194
  v_exp_f32 v195, v195
  v_mfma_f32_32x32x16_bf16 v[176:191], v[252:255], v[228:231], v[176:191]
  buffer_load_dwordx4 v[12:15], v1, s[20:23], s30 offen sc1
  v_cvt_pk_bf16_f32 v224, v192, v193
  v_exp_f32 v196, v196
  v_exp_f32 v197, v197
  v_cvt_pk_bf16_f32 v225, v194, v195
  v_exp_f32 v198, v198
  v_exp_f32 v199, v199
  v_cvt_pk_bf16_f32 v226, v196, v197
  v_exp_f32 v200, v200
  v_mfma_f32_32x32x16_bf16 v[208:223], v[16:19], v[36:39], 0
  s_mov_b64 exec, s[36:37]
  buffer_load_dwordx4 v[248:251], v2, s[20:23], s31 offen sc1
  buffer_load_dwordx4 v[252:255], v2, s[20:23], s31 offen offset:512 sc1
  s_mov_b64 exec, -1
  v_exp_f32 v201, v201
  v_cvt_pk_bf16_f32 v227, v198, v199
  v_exp_f32 v202, v202
  v_exp_f32 v203, v203
  v_cvt_pk_bf16_f32 v228, v200, v201
  v_exp_f32 v204, v204
  v_exp_f32 v205, v205
  v_mfma_f32_32x32x16_bf16 v[64:79], v[24:27], v[224:227], v[64:79]
  v_cvt_pk_bf16_f32 v229, v202, v203
  v_exp_f32 v206, v206
  v_exp_f32 v207, v207
  v_cvt_pk_bf16_f32 v230, v204, v205
  v_exp_f32 v208, v208
  v_cvt_pk_bf16_f32 v231, v206, v207
  v_exp_f32 v209, v209
  v_exp_f32 v210, v210
  v_exp_f32 v211, v211
  v_mfma_f32_32x32x16_bf16 v[64:79], v[28:31], v[228:231], v[64:79]
  v_cvt_pk_bf16_f32 v224, v208, v209
  v_exp_f32 v212, v212
  v_exp_f32 v213, v213
  v_cvt_pk_bf16_f32 v225, v210, v211
  v_exp_f32 v214, v214
  v_exp_f32 v215, v215
  v_cvt_pk_bf16_f32 v226, v212, v213
  v_exp_f32 v216, v216
  v_mfma_f32_32x32x16_bf16 v[192:207], v[16:19], v[40:43], 0
  v_exp_f32 v217, v217
  v_cvt_pk_bf16_f32 v227, v214, v215
  v_exp_f32 v218, v218
  v_exp_f32 v219, v219
  v_cvt_pk_bf16_f32 v228, v216, v217
  v_exp_f32 v220, v220
  v_exp_f32 v221, v221
  v_mfma_f32_32x32x16_bf16 v[80:95], v[24:27], v[224:227], v[80:95]
  v_cvt_pk_bf16_f32 v229, v218, v219
  v_exp_f32 v222, v222
  v_exp_f32 v223, v223
  v_cvt_pk_bf16_f32 v230, v220, v221
  v_exp_f32 v192, v192
  v_cvt_pk_bf16_f32 v231, v222, v223
  v_exp_f32 v193, v193
  v_exp_f32 v194, v194
  v_exp_f32 v195, v195
  v_mfma_f32_32x32x16_bf16 v[80:95], v[28:31], v[228:231], v[80:95]
  v_cvt_pk_bf16_f32 v224, v192, v193
  v_exp_f32 v196, v196
  v_exp_f32 v197, v197
  v_cvt_pk_bf16_f32 v225, v194, v195
  v_exp_f32 v198, v198
  v_exp_f32 v199, v199
  v_cvt_pk_bf16_f32 v226, v196, v197
  v_exp_f32 v200, v200
  v_mfma_f32_32x32x16_bf16 v[208:223], v[16:19], v[44:47], 0
  v_exp_f32 v201, v201
  v_cvt_pk_bf16_f32 v227, v198, v199
  v_exp_f32 v202, v202
  v_exp_f32 v203, v203
  v_cvt_pk_bf16_f32 v228, v200, v201
  v_exp_f32 v204, v204
  v_exp_f32 v205, v205
  v_mfma_f32_32x32x16_bf16 v[96:111], v[24:27], v[224:227], v[96:111]
  v_cvt_pk_bf16_f32 v229, v202, v203
  v_exp_f32 v206, v206
  v_exp_f32 v207, v207
  v_cvt_pk_bf16_f32 v230, v204, v205
  v_exp_f32 v208, v208
  v_cvt_pk_bf16_f32 v231, v206, v207
  v_exp_f32 v209, v209
  v_exp_f32 v210, v210
  v_exp_f32 v211, v211
  v_mfma_f32_32x32x16_bf16 v[96:111], v[28:31], v[228:231], v[96:111]
  v_cvt_pk_bf16_f32 v224, v208, v209
  v_exp_f32 v212, v212
  v_exp_f32 v213, v213
  v_cvt_pk_bf16_f32 v225, v210, v211
  v_exp_f32 v214, v214
  v_exp_f32 v215, v215
  v_cvt_pk_bf16_f32 v226, v212, v213
  v_exp_f32 v216, v216
  v_mfma_f32_32x32x16_bf16 v[192:207], v[16:19], v[48:51], 0
  v_exp_f32 v217, v217
  v_cvt_pk_bf16_f32 v227, v214, v215
  v_exp_f32 v218, v218
  v_exp_f32 v219, v219
  v_cvt_pk_bf16_f32 v228, v216, v217
  v_exp_f32 v220, v220
  v_exp_f32 v221, v221
  v_mfma_f32_32x32x16_bf16 v[112:127], v[24:27], v[224:227], v[112:127]
  v_cvt_pk_bf16_f32 v229, v218, v219
  v_exp_f32 v222, v222
  v_exp_f32 v223, v223
  v_cvt_pk_bf16_f32 v230, v220, v221
  v_exp_f32 v192, v192
  v_cvt_pk_bf16_f32 v231, v222, v223
  v_exp_f32 v193, v193
  v_exp_f32 v194, v194
  v_exp_f32 v195, v195
  v_mfma_f32_32x32x16_bf16 v[112:127], v[28:31], v[228:231], v[112:127]
  v_cvt_pk_bf16_f32 v224, v192, v193
  v_exp_f32 v196, v196
  v_exp_f32 v197, v197
  v_cvt_pk_bf16_f32 v225, v194, v195
  v_exp_f32 v198, v198
  v_exp_f32 v199, v199
  v_cvt_pk_bf16_f32 v226, v196, v197
  v_exp_f32 v200, v200
  v_mfma_f32_32x32x16_bf16 v[208:223], v[16:19], v[52:55], 0
  v_exp_f32 v201, v201
  v_cvt_pk_bf16_f32 v227, v198, v199
  v_exp_f32 v202, v202
  v_exp_f32 v203, v203
  v_cvt_pk_bf16_f32 v228, v200, v201
  v_exp_f32 v204, v204
  v_exp_f32 v205, v205
  v_mfma_f32_32x32x16_bf16 v[128:143], v[24:27], v[224:227], v[128:143]
  v_cvt_pk_bf16_f32 v229, v202, v203
  v_exp_f32 v206, v206
  v_exp_f32 v207, v207
  v_cvt_pk_bf16_f32 v230, v204, v205
  v_exp_f32 v208, v208
  v_cvt_pk_bf16_f32 v231, v206, v207
  v_exp_f32 v209, v209
  v_exp_f32 v210, v210
  v_exp_f32 v211, v211
  v_mfma_f32_32x32x16_bf16 v[128:143], v[28:31], v[228:231], v[128:143]
  v_cvt_pk_bf16_f32 v224, v208, v209
  v_exp_f32 v212, v212
  v_exp_f32 v213, v213
  v_cvt_pk_bf16_f32 v225, v210, v211
  v_exp_f32 v214, v214
  v_exp_f32 v215, v215
  v_cvt_pk_bf16_f32 v226, v212, v213
  v_exp_f32 v216, v216
  v_mfma_f32_32x32x16_bf16 v[192:207], v[16:19], v[56:59], 0
  v_exp_f32 v217, v217
  v_cvt_pk_bf16_f32 v227, v214, v215
  v_exp_f32 v218, v218
  v_exp_f32 v219, v219
  v_cvt_pk_bf16_f32 v228, v216, v217
  v_exp_f32 v220, v220
  v_exp_f32 v221, v221
  v_mfma_f32_32x32x16_bf16 v[144:159], v[24:27], v[224:227], v[144:159]
  v_cvt_pk_bf16_f32 v229, v218, v219
  v_exp_f32 v222, v222
  v_exp_f32 v223, v223
  v_cvt_pk_bf16_f32 v230, v220, v221
  v_exp_f32 v192, v192
  v_cvt_pk_bf16_f32 v231, v222, v223
  v_exp_f32 v193, v193
  v_exp_f32 v194, v194
  v_exp_f32 v195, v195
  v_mfma_f32_32x32x16_bf16 v[144:159], v[28:31], v[228:231], v[144:159]
  v_cvt_pk_bf16_f32 v224, v192, v193
  v_exp_f32 v196, v196
  v_exp_f32 v197, v197
  v_cvt_pk_bf16_f32 v225, v194, v195
  v_exp_f32 v198, v198
  v_exp_f32 v199, v199
  v_cvt_pk_bf16_f32 v226, v196, v197
  v_exp_f32 v200, v200
  v_mfma_f32_32x32x16_bf16 v[208:223], v[16:19], v[60:63], 0
  v_exp_f32 v201, v201
  v_cvt_pk_bf16_f32 v227, v198, v199
  v_exp_f32 v202, v202
  v_exp_f32 v203, v203
  v_cvt_pk_bf16_f32 v228, v200, v201
  v_exp_f32 v204, v204
  v_exp_f32 v205, v205
  v_mfma_f32_32x32x16_bf16 v[160:175], v[24:27], v[224:227], v[160:175]
  v_cvt_pk_bf16_f32 v229, v202, v203
  v_exp_f32 v206, v206
  v_exp_f32 v207, v207
  v_cvt_pk_bf16_f32 v230, v204, v205
  v_exp_f32 v208, v208
  v_cvt_pk_bf16_f32 v231, v206, v207
  v_exp_f32 v209, v209
  v_exp_f32 v210, v210
  v_exp_f32 v211, v211
  v_mfma_f32_32x32x16_bf16 v[160:175], v[28:31], v[228:231], v[160:175]
  v_cvt_pk_bf16_f32 v224, v208, v209
  v_exp_f32 v212, v212
  v_exp_f32 v213, v213
  v_cvt_pk_bf16_f32 v225, v210, v211
  v_exp_f32 v214, v214
  v_exp_f32 v215, v215
  v_cvt_pk_bf16_f32 v226, v212, v213
  v_exp_f32 v216, v216
  s_waitcnt vmcnt(6)
  v_mfma_f32_32x32x16_bf16 v[192:207], v[20:23], v[32:35], 0
  v_exp_f32 v217, v217
  v_cvt_pk_bf16_f32 v227, v214, v215
  v_exp_f32 v218, v218
  v_exp_f32 v219, v219
  v_cvt_pk_bf16_f32 v228, v216, v217
  v_exp_f32 v220, v220
  v_exp_f32 v221, v221
  v_mfma_f32_32x32x16_bf16 v[176:191], v[24:27], v[224:227], v[176:191]
  v_cvt_pk_bf16_f32 v229, v218, v219
  v_exp_f32 v222, v222
  v_exp_f32 v223, v223
  v_cvt_pk_bf16_f32 v230, v220, v221
  v_exp_f32 v192, v192
  v_cvt_pk_bf16_f32 v231, v222, v223
  v_exp_f32 v193, v193
  v_exp_f32 v194, v194
  v_exp_f32 v195, v195
  v_mfma_f32_32x32x16_bf16 v[176:191], v[28:31], v[228:231], v[176:191]
  v_cvt_pk_bf16_f32 v224, v192, v193
  v_exp_f32 v196, v196
  v_exp_f32 v197, v197
  v_cvt_pk_bf16_f32 v225, v194, v195
  v_exp_f32 v198, v198
  v_exp_f32 v199, v199
  v_cvt_pk_bf16_f32 v226, v196, v197
  v_exp_f32 v200, v200
  v_mfma_f32_32x32x16_bf16 v[208:223], v[20:23], v[36:39], 0
  v_exp_f32 v201, v201
  v_cvt_pk_bf16_f32 v227, v198, v199
  v_exp_f32 v202, v202
  v_exp_f32 v203, v203
  v_cvt_pk_bf16_f32 v228, v200, v201
  v_exp_f32 v204, v204
  v_exp_f32 v205, v205
  v_mfma_f32_32x32x16_bf16 v[64:79], v[232:235], v[224:227], v[64:79]
  v_cvt_pk_bf16_f32 v229, v202, v203
  v_exp_f32 v206, v206
  v_exp_f32 v207, v207
  v_cvt_pk_bf16_f32 v230, v204, v205
  v_exp_f32 v208, v208
  v_cvt_pk_bf16_f32 v231, v206, v207
  v_exp_f32 v209, v209
  v_exp_f32 v210, v210
  v_exp_f32 v211, v211
  v_mfma_f32_32x32x16_bf16 v[64:79], v[236:239], v[228:231], v[64:79]
  v_cvt_pk_bf16_f32 v224, v208, v209
  v_exp_f32 v212, v212
  v_exp_f32 v213, v213
  v_cvt_pk_bf16_f32 v225, v210, v211
  v_exp_f32 v214, v214
  v_exp_f32 v215, v215
  v_cvt_pk_bf16_f32 v226, v212, v213
  v_exp_f32 v216, v216
  v_mfma_f32_32x32x16_bf16 v[192:207], v[20:23], v[40:43], 0
  v_exp_f32 v217, v217
  v_cvt_pk_bf16_f32 v227, v214, v215
  v_exp_f32 v218, v218
  v_exp_f32 v219, v219
  v_cvt_pk_bf16_f32 v228, v216, v217
  v_exp_f32 v220, v220
  v_exp_f32 v221, v221
  v_mfma_f32_32x32x16_bf16 v[80:95], v[232:235], v[224:227], v[80:95]
  v_cvt_pk_bf16_f32 v229, v218, v219
  v_exp_f32 v222, v222
  v_exp_f32 v223, v223
  v_cvt_pk_bf16_f32 v230, v220, v221
  v_exp_f32 v192, v192
  v_cvt_pk_bf16_f32 v231, v222, v223
  v_exp_f32 v193, v193
  v_exp_f32 v194, v194
  v_exp_f32 v195, v195
  v_mfma_f32_32x32x16_bf16 v[80:95], v[236:239], v[228:231], v[80:95]
  v_cvt_pk_bf16_f32 v224, v192, v193
  v_exp_f32 v196, v196
  v_exp_f32 v197, v197
  v_cvt_pk_bf16_f32 v225, v194, v195
  v_exp_f32 v198, v198
  v_exp_f32 v199, v199
  v_cvt_pk_bf16_f32 v226, v196, v197
  v_exp_f32 v200, v200
  v_mfma_f32_32x32x16_bf16 v[208:223], v[20:23], v[44:47], 0
  v_exp_f32 v201, v201
  v_cvt_pk_bf16_f32 v227, v198, v199
  v_exp_f32 v202, v202
  v_exp_f32 v203, v203
  v_cvt_pk_bf16_f32 v228, v200, v201
  v_exp_f32 v204, v204
  v_exp_f32 v205, v205
  v_mfma_f32_32x32x16_bf16 v[96:111], v[232:235], v[224:227], v[96:111]
  v_cvt_pk_bf16_f32 v229, v202, v203
  v_exp_f32 v206, v206
  v_exp_f32 v207, v207
  v_cvt_pk_bf16_f32 v230, v204, v205
  v_exp_f32 v208, v208
  v_cvt_pk_bf16_f32 v231, v206, v207
  v_exp_f32 v209, v209
  v_exp_f32 v210, v210
  v_exp_f32 v211, v211
  v_mfma_f32_32x32x16_bf16 v[96:111], v[236:239], v[228:231], v[96:111]
  v_cvt_pk_bf16_f32 v224, v208, v209
  v_exp_f32 v212, v212
  v_exp_f32 v213, v213
  v_cvt_pk_bf16_f32 v225, v210, v211
  v_exp_f32 v214, v214
  v_exp_f32 v215, v215
  v_cvt_pk_bf16_f32 v226, v212, v213
  v_exp_f32 v216, v216
  v_mfma_f32_32x32x16_bf16 v[192:207], v[20:23], v[48:51], 0
  v_exp_f32 v217, v217
  v_cvt_pk_bf16_f32 v227, v214, v215
  v_exp_f32 v218, v218
  v_exp_f32 v219, v219
  v_cvt_pk_bf16_f32 v228, v216, v217
  v_exp_f32 v220, v220
  v_exp_f32 v221, v221
  v_mfma_f32_32x32x16_bf16 v[112:127], v[232:235], v[224:227], v[112:127]
  v_cvt_pk_bf16_f32 v229, v218, v219
  v_exp_f32 v222, v222
  v_exp_f32 v223, v223
  v_cvt_pk_bf16_f32 v230, v220, v221
  v_exp_f32 v192, v192
  v_cvt_pk_bf16_f32 v231, v222, v223
  v_exp_f32 v193, v193
  v_exp_f32 v194, v194
  v_exp_f32 v195, v195
  v_mfma_f32_32x32x16_bf16 v[112:127], v[236:239], v[228:231], v[112:127]
  v_cvt_pk_bf16_f32 v224, v192, v193
  v_exp_f32 v196, v196
  v_exp_f32 v197, v197
  v_cvt_pk_bf16_f32 v225, v194, v195
  v_exp_f32 v198, v198
  v_exp_f32 v199, v199
  v_cvt_pk_bf16_f32 v226, v196, v197
  v_exp_f32 v200, v200
  v_mfma_f32_32x32x16_bf16 v[208:223], v[20:23], v[52:55], 0
  v_exp_f32 v201, v201
  v_cvt_pk_bf16_f32 v227, v198, v199
  v_exp_f32 v202, v202
  v_exp_f32 v203, v203
  v_cvt_pk_bf16_f32 v228, v200, v201
  v_exp_f32 v204, v204
  v_exp_f32 v205, v205
  v_mfma_f32_32x32x16_bf16 v[128:143], v[232:235], v[224:227], v[128:143]
  v_cvt_pk_bf16_f32 v229, v202, v203
  v_exp_f32 v206, v206
  v_exp_f32 v207, v207
  v_cvt_pk_bf16_f32 v230, v204, v205
  v_exp_f32 v208, v208
  v_cvt_pk_bf16_f32 v231, v206, v207
  v_exp_f32 v209, v209
  v_exp_f32 v210, v210
  v_exp_f32 v211, v211
  v_mfma_f32_32x32x16_bf16 v[128:143], v[236:239], v[228:231], v[128:143]
  v_cvt_pk_bf16_f32 v224, v208, v209
  v_exp_f32 v212, v212
  v_exp_f32 v213, v213
  v_cvt_pk_bf16_f32 v225, v210, v211
  v_exp_f32 v214, v214
  v_exp_f32 v215, v215
  v_cvt_pk_bf16_f32 v226, v212, v213
  v_exp_f32 v216, v216
  v_mfma_f32_32x32x16_bf16 v[192:207], v[20:23], v[56:59], 0
  v_exp_f32 v217, v217
  v_cvt_pk_bf16_f32 v227, v214, v215
  v_exp_f32 v218, v218
  v_exp_f32 v219, v219
  v_cvt_pk_bf16_f32 v228, v216, v217
  v_exp_f32 v220, v220
  v_exp_f32 v221, v221
  v_mfma_f32_32x32x16_bf16 v[144:159], v[232:235], v[224:227], v[144:159]
  v_cvt_pk_bf16_f32 v229, v218, v219
  v_exp_f32 v222, v222
  v_exp_f32 v223, v223
  v_cvt_pk_bf16_f32 v230, v220, v221
  v_exp_f32 v192, v192
  v_cvt_pk_bf16_f32 v231, v222, v223
  v_exp_f32 v193, v193
  v_exp_f32 v194, v194
  v_exp_f32 v195, v195
  v_mfma_f32_32x32x16_bf16 v[144:159], v[236:239], v[228:231], v[144:159]
  v_cvt_pk_bf16_f32 v224, v192, v193
  v_exp_f32 v196, v196
  v_exp_f32 v197, v197
  v_cvt_pk_bf16_f32 v225, v194, v195
  v_exp_f32 v198, v198
  v_exp_f32 v199, v199
  v_cvt_pk_bf16_f32 v226, v196, v197
  v_exp_f32 v200, v200
  v_mfma_f32_32x32x16_bf16 v[208:223], v[20:23], v[60:63], 0
  v_exp_f32 v201, v201
  v_cvt_pk_bf16_f32 v227, v198, v199
  v_exp_f32 v202, v202
  v_exp_f32 v203, v203
  v_cvt_pk_bf16_f32 v228, v200, v201
  v_exp_f32 v204, v204
  v_exp_f32 v205, v205
  v_mfma_f32_32x32x16_bf16 v[160:175], v[232:235], v[224:227], v[160:175]
  v_cvt_pk_bf16_f32 v229, v202, v203
  v_exp_f32 v206, v206
  v_exp_f32 v207, v207
  v_cvt_pk_bf16_f32 v230, v204, v205
  v_exp_f32 v208, v208
  v_cvt_pk_bf16_f32 v231, v206, v207
  v_exp_f32 v209, v209
  v_exp_f32 v210, v210
  v_exp_f32 v211, v211
  v_mfma_f32_32x32x16_bf16 v[160:175], v[236:239], v[228:231], v[160:175]
  v_cvt_pk_bf16_f32 v224, v208, v209
  v_exp_f32 v212, v212
  v_exp_f32 v213, v213
  v_cvt_pk_bf16_f32 v225, v210, v211
  v_exp_f32 v214, v214
  v_exp_f32 v215, v215
  v_cvt_pk_bf16_f32 v226, v212, v213
  v_exp_f32 v216, v216
  s_waitcnt vmcnt(3)
  v_mfma_f32_32x32x16_bf16 v[192:207], v[8:11], v[32:35], 0
  v_exp_f32 v217, v217
  v_cvt_pk_bf16_f32 v227, v214, v215
  v_exp_f32 v218, v218
  v_exp_f32 v219, v219
  v_cvt_pk_bf16_f32 v228, v216, v217
  v_exp_f32 v220, v220
  v_exp_f32 v221, v221
  v_mfma_f32_32x32x16_bf16 v[176:191], v[232:235], v[224:227], v[176:191]
  v_cvt_pk_bf16_f32 v229, v218, v219
  v_exp_f32 v222, v222
  v_exp_f32 v223, v223
  v_cvt_pk_bf16_f32 v230, v220, v221
  v_exp_f32 v192, v192
  v_cvt_pk_bf16_f32 v231, v222, v223
  v_exp_f32 v193, v193
  v_exp_f32 v194, v194
  v_exp_f32 v195, v195
  v_mfma_f32_32x32x16_bf16 v[176:191], v[236:239], v[228:231], v[176:191]
  v_cvt_pk_bf16_f32 v224, v192, v193
  v_exp_f32 v196, v196
  v_exp_f32 v197, v197
  v_cvt_pk_bf16_f32 v225, v194, v195
  v_exp_f32 v198, v198
  v_exp_f32 v199, v199
  v_cvt_pk_bf16_f32 v226, v196, v197
  v_exp_f32 v200, v200
  v_mfma_f32_32x32x16_bf16 v[208:223], v[8:11], v[36:39], 0
  v_exp_f32 v201, v201
  v_cvt_pk_bf16_f32 v227, v198, v199
  v_exp_f32 v202, v202
  v_exp_f32 v203, v203
  v_cvt_pk_bf16_f32 v228, v200, v201
  v_exp_f32 v204, v204
  v_exp_f32 v205, v205
  v_mfma_f32_32x32x16_bf16 v[64:79], v[240:243], v[224:227], v[64:79]
  v_cvt_pk_bf16_f32 v229, v202, v203
  v_exp_f32 v206, v206
  v_exp_f32 v207, v207
  v_cvt_pk_bf16_f32 v230, v204, v205
  v_exp_f32 v208, v208
  v_cvt_pk_bf16_f32 v231, v206, v207
  v_exp_f32 v209, v209
  v_exp_f32 v210, v210
  v_exp_f32 v211, v211
  v_mfma_f32_32x32x16_bf16 v[64:79], v[244:247], v[228:231], v[64:79]
  v_cvt_pk_bf16_f32 v224, v208, v209
  v_exp_f32 v212, v212
  v_exp_f32 v213, v213
  v_cvt_pk_bf16_f32 v225, v210, v211
  v_exp_f32 v214, v214
  v_exp_f32 v215, v215
  v_cvt_pk_bf16_f32 v226, v212, v213
  v_exp_f32 v216, v216
  v_mfma_f32_32x32x16_bf16 v[192:207], v[8:11], v[40:43], 0
  v_exp_f32 v217, v217
  v_cvt_pk_bf16_f32 v227, v214, v215
  v_exp_f32 v218, v218
  v_exp_f32 v219, v219
  v_cvt_pk_bf16_f32 v228, v216, v217
  v_exp_f32 v220, v220
  v_exp_f32 v221, v221
  v_mfma_f32_32x32x16_bf16 v[80:95], v[240:243], v[224:227], v[80:95]
  v_cvt_pk_bf16_f32 v229, v218, v219
  v_exp_f32 v222, v222
  v_exp_f32 v223, v223
  v_cvt_pk_bf16_f32 v230, v220, v221
  v_exp_f32 v192, v192
  v_cvt_pk_bf16_f32 v231, v222, v223
  v_exp_f32 v193, v193
  v_exp_f32 v194, v194
  v_exp_f32 v195, v195
  v_mfma_f32_32x32x16_bf16 v[80:95], v[244:247], v[228:231], v[80:95]
  v_cvt_pk_bf16_f32 v224, v192, v193
  v_exp_f32 v196, v196
  v_exp_f32 v197, v197
  v_cvt_pk_bf16_f32 v225, v194, v195
  v_exp_f32 v198, v198
  v_exp_f32 v199, v199
  v_cvt_pk_bf16_f32 v226, v196, v197
  v_exp_f32 v200, v200
  v_mfma_f32_32x32x16_bf16 v[208:223], v[8:11], v[44:47], 0
  v_exp_f32 v201, v201
  v_cvt_pk_bf16_f32 v227, v198, v199
  v_exp_f32 v202, v202
  v_exp_f32 v203, v203
  v_cvt_pk_bf16_f32 v228, v200, v201
  v_exp_f32 v204, v204
  v_exp_f32 v205, v205
  v_mfma_f32_32x32x16_bf16 v[96:111], v[240:243], v[224:227], v[96:111]
  v_cvt_pk_bf16_f32 v229, v202, v203
  v_exp_f32 v206, v206
  v_exp_f32 v207, v207
  v_cvt_pk_bf16_f32 v230, v204, v205
  v_exp_f32 v208, v208
  v_cvt_pk_bf16_f32 v231, v206, v207
  v_exp_f32 v209, v209
  v_exp_f32 v210, v210
  v_exp_f32 v211, v211
  v_mfma_f32_32x32x16_bf16 v[96:111], v[244:247], v[228:231], v[96:111]
  v_cvt_pk_bf16_f32 v224, v208, v209
  v_exp_f32 v212, v212
  v_exp_f32 v213, v213
  v_cvt_pk_bf16_f32 v225, v210, v211
  v_exp_f32 v214, v214
  v_exp_f32 v215, v215
  v_cvt_pk_bf16_f32 v226, v212, v213
  v_exp_f32 v216, v216
  v_mfma_f32_32x32x16_bf16 v[192:207], v[8:11], v[48:51], 0
  v_exp_f32 v217, v217
  v_cvt_pk_bf16_f32 v227, v214, v215
  v_exp_f32 v218, v218
  v_exp_f32 v219, v219
  v_cvt_pk_bf16_f32 v228, v216, v217
  v_exp_f32 v220, v220
  v_exp_f32 v221, v221
  v_mfma_f32_32x32x16_bf16 v[112:127], v[240:243], v[224:227], v[112:127]
  v_cvt_pk_bf16_f32 v229, v218, v219
  v_exp_f32 v222, v222
  v_exp_f32 v223, v223
  v_cvt_pk_bf16_f32 v230, v220, v221
  v_exp_f32 v192, v192
  v_cvt_pk_bf16_f32 v231, v222, v223
  v_exp_f32 v193, v193
  v_exp_f32 v194, v194
  v_exp_f32 v195, v195
  v_mfma_f32_32x32x16_bf16 v[112:127], v[244:247], v[228:231], v[112:127]
  v_cvt_pk_bf16_f32 v224, v192, v193
  v_exp_f32 v196, v196
  v_exp_f32 v197, v197
  v_cvt_pk_bf16_f32 v225, v194, v195
  v_exp_f32 v198, v198
  v_exp_f32 v199, v199
  v_cvt_pk_bf16_f32 v226, v196, v197
  v_exp_f32 v200, v200
  v_mfma_f32_32x32x16_bf16 v[208:223], v[8:11], v[52:55], 0
  v_exp_f32 v201, v201
  v_cvt_pk_bf16_f32 v227, v198, v199
  v_exp_f32 v202, v202
  v_exp_f32 v203, v203
  v_cvt_pk_bf16_f32 v228, v200, v201
  v_exp_f32 v204, v204
  v_exp_f32 v205, v205
  v_mfma_f32_32x32x16_bf16 v[128:143], v[240:243], v[224:227], v[128:143]
  v_cvt_pk_bf16_f32 v229, v202, v203
  v_exp_f32 v206, v206
  v_exp_f32 v207, v207
  v_cvt_pk_bf16_f32 v230, v204, v205
  v_exp_f32 v208, v208
  v_cvt_pk_bf16_f32 v231, v206, v207
  v_exp_f32 v209, v209
  v_exp_f32 v210, v210
  v_exp_f32 v211, v211
  v_mfma_f32_32x32x16_bf16 v[128:143], v[244:247], v[228:231], v[128:143]
  v_cvt_pk_bf16_f32 v224, v208, v209
  v_exp_f32 v212, v212
  v_exp_f32 v213, v213
  v_cvt_pk_bf16_f32 v225, v210, v211
  v_exp_f32 v214, v214
  v_exp_f32 v215, v215
  v_cvt_pk_bf16_f32 v226, v212, v213
  v_exp_f32 v216, v216
  v_mfma_f32_32x32x16_bf16 v[192:207], v[8:11], v[56:59], 0
  v_exp_f32 v217, v217
  v_cvt_pk_bf16_f32 v227, v214, v215
  v_exp_f32 v218, v218
  v_exp_f32 v219, v219
  v_cvt_pk_bf16_f32 v228, v216, v217
  v_exp_f32 v220, v220
  v_exp_f32 v221, v221
  v_mfma_f32_32x32x16_bf16 v[144:159], v[240:243], v[224:227], v[144:159]
  v_cvt_pk_bf16_f32 v229, v218, v219
  v_exp_f32 v222, v222
  v_exp_f32 v223, v223
  v_cvt_pk_bf16_f32 v230, v220, v221
  v_exp_f32 v192, v192
  v_cvt_pk_bf16_f32 v231, v222, v223
  v_exp_f32 v193, v193
  v_exp_f32 v194, v194
  v_exp_f32 v195, v195
  v_mfma_f32_32x32x16_bf16 v[144:159], v[244:247], v[228:231], v[144:159]
  v_cvt_pk_bf16_f32 v224, v192, v193
  v_exp_f32 v196, v196
  v_exp_f32 v197, v197
  v_cvt_pk_bf16_f32 v225, v194, v195
  v_exp_f32 v198, v198
  v_exp_f32 v199, v199
  v_cvt_pk_bf16_f32 v226, v196, v197
  v_exp_f32 v200, v200
  v_mfma_f32_32x32x16_bf16 v[208:223], v[8:11], v[60:63], 0
  v_exp_f32 v201, v201
  v_cvt_pk_bf16_f32 v227, v198, v199
  v_exp_f32 v202, v202
  v_exp_f32 v203, v203
  v_cvt_pk_bf16_f32 v228, v200, v201
  v_exp_f32 v204, v204
  v_exp_f32 v205, v205
  v_mfma_f32_32x32x16_bf16 v[160:175], v[240:243], v[224:227], v[160:175]
  v_cvt_pk_bf16_f32 v229, v202, v203
  v_exp_f32 v206, v206
  v_exp_f32 v207, v207
  v_cvt_pk_bf16_f32 v230, v204, v205
  v_exp_f32 v208, v208
  v_cvt_pk_bf16_f32 v231, v206, v207
  v_exp_f32 v209, v209
  v_exp_f32 v210, v210
  v_exp_f32 v211, v211
  v_mfma_f32_32x32x16_bf16 v[160:175], v[244:247], v[228:231], v[160:175]
  v_cvt_pk_bf16_f32 v224, v208, v209
  v_exp_f32 v212, v212
  v_exp_f32 v213, v213
  v_cvt_pk_bf16_f32 v225, v210, v211
  v_exp_f32 v214, v214
  v_exp_f32 v215, v215
  v_cvt_pk_bf16_f32 v226, v212, v213
  v_exp_f32 v216, v216
  s_waitcnt vmcnt(0)
  v_mfma_f32_32x32x16_bf16 v[192:207], v[12:15], v[32:35], 0
  v_exp_f32 v217, v217
  v_cvt_pk_bf16_f32 v227, v214, v215
  v_exp_f32 v218, v218
  v_exp_f32 v219, v219
  v_cvt_pk_bf16_f32 v228, v216, v217
  v_exp_f32 v220, v220
  v_exp_f32 v221, v221
  v_mfma_f32_32x32x16_bf16 v[176:191], v[240:243], v[224:227], v[176:191]
  v_cvt_pk_bf16_f32 v229, v218, v219
  v_exp_f32 v222, v222
  v_exp_f32 v223, v223
  v_cvt_pk_bf16_f32 v230, v220, v221
  v_exp_f32 v192, v192
  v_cvt_pk_bf16_f32 v231, v222, v223
  v_exp_f32 v193, v193
  v_exp_f32 v194, v194
  v_exp_f32 v195, v195
  v_mfma_f32_32x32x16_bf16 v[176:191], v[244:247], v[228:231], v[176:191]
  s_mul_i32 s40, s24, 20480
  s_add_u32 s40, s40, 65536
  v_cvt_pk_bf16_f32 v224, v192, v193
  v_exp_f32 v196, v196
  v_exp_f32 v197, v197
  v_cvt_pk_bf16_f32 v225, v194, v195
  v_exp_f32 v198, v198
  v_exp_f32 v199, v199
  v_cvt_pk_bf16_f32 v226, v196, v197
  v_exp_f32 v200, v200
  v_mfma_f32_32x32x16_bf16 v[208:223], v[12:15], v[36:39], 0
  v_add_u32 v16, s40, v1
  v_lshlrev_b32 v17, 3, v0
  v_add_u32 v17, s40, v17
  v_exp_f32 v201, v201
  v_cvt_pk_bf16_f32 v227, v198, v199
  v_exp_f32 v202, v202
  v_exp_f32 v203, v203
  v_cvt_pk_bf16_f32 v228, v200, v201
  v_exp_f32 v204, v204
  v_exp_f32 v205, v205
  v_mfma_f32_32x32x16_bf16 v[64:79], v[248:251], v[224:227], v[64:79]
  v_cvt_pk_bf16_f32 v229, v202, v203
  v_exp_f32 v206, v206
  v_exp_f32 v207, v207
  v_cvt_pk_bf16_f32 v230, v204, v205
  v_exp_f32 v208, v208
  v_cvt_pk_bf16_f32 v231, v206, v207
  v_exp_f32 v209, v209
  v_exp_f32 v210, v210
  v_exp_f32 v211, v211
  v_mfma_f32_32x32x16_bf16 v[64:79], v[252:255], v[228:231], v[64:79]
  v_cvt_pk_bf16_f32 v224, v208, v209
  v_exp_f32 v212, v212
  v_exp_f32 v213, v213
  v_cvt_pk_bf16_f32 v225, v210, v211
  v_exp_f32 v214, v214
  v_exp_f32 v215, v215
  v_cvt_pk_bf16_f32 v226, v212, v213
  v_exp_f32 v216, v216
  v_mfma_f32_32x32x16_bf16 v[192:207], v[12:15], v[40:43], 0
  v_exp_f32 v217, v217
  v_cvt_pk_bf16_f32 v227, v214, v215
  v_exp_f32 v218, v218
  v_exp_f32 v219, v219
  v_cvt_pk_bf16_f32 v228, v216, v217
  v_exp_f32 v220, v220
  v_exp_f32 v221, v221
  v_mfma_f32_32x32x16_bf16 v[80:95], v[248:251], v[224:227], v[80:95]
  ds_write_b128 v16, v[64:67] offset:0
  ds_write_b128 v16, v[68:71] offset:1024
  ds_write_b64 v17, v[72:73] offset:2048
  v_cvt_pk_bf16_f32 v229, v218, v219
  v_exp_f32 v222, v222
  v_exp_f32 v223, v223
  v_cvt_pk_bf16_f32 v230, v220, v221
  v_exp_f32 v192, v192
  v_cvt_pk_bf16_f32 v231, v222, v223
  v_exp_f32 v193, v193
  v_exp_f32 v194, v194
  v_exp_f32 v195, v195
  v_mfma_f32_32x32x16_bf16 v[80:95], v[252:255], v[228:231], v[80:95]
  v_cvt_pk_bf16_f32 v224, v192, v193
  v_exp_f32 v196, v196
  v_exp_f32 v197, v197
  v_cvt_pk_bf16_f32 v225, v194, v195
  v_exp_f32 v198, v198
  v_exp_f32 v199, v199
  v_cvt_pk_bf16_f32 v226, v196, v197
  v_exp_f32 v200, v200
  v_mfma_f32_32x32x16_bf16 v[208:223], v[12:15], v[44:47], 0
  v_exp_f32 v201, v201
  v_cvt_pk_bf16_f32 v227, v198, v199
  v_exp_f32 v202, v202
  v_exp_f32 v203, v203
  v_cvt_pk_bf16_f32 v228, v200, v201
  v_exp_f32 v204, v204
  v_exp_f32 v205, v205
  v_mfma_f32_32x32x16_bf16 v[96:111], v[248:251], v[224:227], v[96:111]
  ds_write_b128 v16, v[80:83] offset:2560
  ds_write_b128 v16, v[84:87] offset:3584
  ds_write_b64 v17, v[88:89] offset:4608
  v_cvt_pk_bf16_f32 v229, v202, v203
  v_exp_f32 v206, v206
  v_exp_f32 v207, v207
  v_cvt_pk_bf16_f32 v230, v204, v205
  v_exp_f32 v208, v208
  v_cvt_pk_bf16_f32 v231, v206, v207
  v_exp_f32 v209, v209
  v_exp_f32 v210, v210
  v_exp_f32 v211, v211
  v_mfma_f32_32x32x16_bf16 v[96:111], v[252:255], v[228:231], v[96:111]
  v_cvt_pk_bf16_f32 v224, v208, v209
  v_exp_f32 v212, v212
  v_exp_f32 v213, v213
  v_cvt_pk_bf16_f32 v225, v210, v211
  v_exp_f32 v214, v214
  v_exp_f32 v215, v215
  v_cvt_pk_bf16_f32 v226, v212, v213
  v_exp_f32 v216, v216
  v_mfma_f32_32x32x16_bf16 v[192:207], v[12:15], v[48:51], 0
  v_exp_f32 v217, v217
  v_cvt_pk_bf16_f32 v227, v214, v215
  v_exp_f32 v218, v218
  v_exp_f32 v219, v219
  v_cvt_pk_bf16_f32 v228, v216, v217
  v_exp_f32 v220, v220
  v_exp_f32 v221, v221
  v_mfma_f32_32x32x16_bf16 v[112:127], v[248:251], v[224:227], v[112:127]
  ds_write_b128 v16, v[96:99] offset:5120
  ds_write_b128 v16, v[100:103] offset:6144
  ds_write_b64 v17, v[104:105] offset:7168
  v_cvt_pk_bf16_f32 v229, v218, v219
  v_exp_f32 v222, v222
  v_exp_f32 v223, v223
  v_cvt_pk_bf16_f32 v230, v220, v221
  v_exp_f32 v192, v192
  v_cvt_pk_bf16_f32 v231, v222, v223
  v_exp_f32 v193, v193
  v_exp_f32 v194, v194
  v_exp_f32 v195, v195
  v_mfma_f32_32x32x16_bf16 v[112:127], v[252:255], v[228:231], v[112:127]
  v_cvt_pk_bf16_f32 v224, v192, v193
  v_exp_f32 v196, v196
  v_exp_f32 v197, v197
  v_cvt_pk_bf16_f32 v225, v194, v195
  v_exp_f32 v198, v198
  v_exp_f32 v199, v199
  v_cvt_pk_bf16_f32 v226, v196, v197
  v_exp_f32 v200, v200
  v_mfma_f32_32x32x16_bf16 v[208:223], v[12:15], v[52:55], 0
  v_exp_f32 v201, v201
  v_cvt_pk_bf16_f32 v227, v198, v199
  v_exp_f32 v202, v202
  v_exp_f32 v203, v203
  v_cvt_pk_bf16_f32 v228, v200, v201
  v_exp_f32 v204, v204
  v_exp_f32 v205, v205
  v_mfma_f32_32x32x16_bf16 v[128:143], v[248:251], v[224:227], v[128:143]
  ds_write_b128 v16, v[112:115] offset:7680
  ds_write_b128 v16, v[116:119] offset:8704
  ds_write_b64 v17, v[120:121] offset:9728
  v_cvt_pk_bf16_f32 v229, v202, v203
  v_exp_f32 v206, v206
  v_exp_f32 v207, v207
  v_cvt_pk_bf16_f32 v230, v204, v205
  v_exp_f32 v208, v208
  v_cvt_pk_bf16_f32 v231, v206, v207
  v_exp_f32 v209, v209
  v_exp_f32 v210, v210
  v_exp_f32 v211, v211
  v_mfma_f32_32x32x16_bf16 v[128:143], v[252:255], v[228:231], v[128:143]
  v_cvt_pk_bf16_f32 v224, v208, v209
  v_exp_f32 v212, v212
  v_exp_f32 v213, v213
  v_cvt_pk_bf16_f32 v225, v210, v211
  v_exp_f32 v214, v214
  v_exp_f32 v215, v215
  v_cvt_pk_bf16_f32 v226, v212, v213
  v_exp_f32 v216, v216
  v_mfma_f32_32x32x16_bf16 v[192:207], v[12:15], v[56:59], 0
  v_exp_f32 v217, v217
  v_cvt_pk_bf16_f32 v227, v214, v215
  v_exp_f32 v218, v218
  v_exp_f32 v219, v219
  v_cvt_pk_bf16_f32 v228, v216, v217
  v_exp_f32 v220, v220
  v_exp_f32 v221, v221
  v_mfma_f32_32x32x16_bf16 v[144:159], v[248:251], v[224:227], v[144:159]
  ds_write_b128 v16, v[128:131] offset:10240
  ds_write_b128 v16, v[132:135] offset:11264
  ds_write_b64 v17, v[136:137] offset:12288
  v_cvt_pk_bf16_f32 v229, v218, v219
  v_exp_f32 v222, v222
  v_exp_f32 v223, v223
  v_cvt_pk_bf16_f32 v230, v220, v221
  v_exp_f32 v192, v192
  v_cvt_pk_bf16_f32 v231, v222, v223
  v_exp_f32 v193, v193
  v_exp_f32 v194, v194
  v_exp_f32 v195, v195
  v_mfma_f32_32x32x16_bf16 v[144:159], v[252:255], v[228:231], v[144:159]
  v_cvt_pk_bf16_f32 v224, v192, v193
  v_exp_f32 v196, v196
  v_exp_f32 v197, v197
  v_cvt_pk_bf16_f32 v225, v194, v195
  v_exp_f32 v198, v198
  v_exp_f32 v199, v199
  v_cvt_pk_bf16_f32 v226, v196, v197
  v_exp_f32 v200, v200
  v_mfma_f32_32x32x16_bf16 v[208:223], v[12:15], v[60:63], 0
  v_exp_f32 v201, v201
  v_cvt_pk_bf16_f32 v227, v198, v199
  v_exp_f32 v202, v202
  v_exp_f32 v203, v203
  v_cvt_pk_bf16_f32 v228, v200, v201
  v_exp_f32 v204, v204
  v_exp_f32 v205, v205
  v_mfma_f32_32x32x16_bf16 v[160:175], v[248:251], v[224:227], v[160:175]
  ds_write_b128 v16, v[144:147] offset:12800
  ds_write_b128 v16, v[148:151] offset:13824
  ds_write_b64 v17, v[152:153] offset:14848
  v_cvt_pk_bf16_f32 v229, v202, v203
  v_exp_f32 v206, v206
  v_exp_f32 v207, v207
  v_cvt_pk_bf16_f32 v230, v204, v205
  v_exp_f32 v208, v208
  v_cvt_pk_bf16_f32 v231, v206, v207
  v_exp_f32 v209, v209
  v_exp_f32 v210, v210
  v_exp_f32 v211, v211
  v_mfma_f32_32x32x16_bf16 v[160:175], v[252:255], v[228:231], v[160:175]
  v_cvt_pk_bf16_f32 v224, v208, v209
  v_exp_f32 v212, v212
  v_exp_f32 v213, v213
  v_cvt_pk_bf16_f32 v225, v210, v211
  v_exp_f32 v214, v214
  v_exp_f32 v215, v215
  v_cvt_pk_bf16_f32 v226, v212, v213
  v_exp_f32 v216, v216
  v_exp_f32 v217, v217
  v_cvt_pk_bf16_f32 v227, v214, v215
  v_exp_f32 v218, v218
  v_exp_f32 v219, v219
  v_cvt_pk_bf16_f32 v228, v216, v217
  v_exp_f32 v220, v220
  v_exp_f32 v221, v221
  v_mfma_f32_32x32x16_bf16 v[176:191], v[248:251], v[224:227], v[176:191]
  ds_write_b128 v16, v[160:163] offset:15360
  ds_write_b128 v16, v[164:167] offset:16384
  ds_write_b64 v17, v[168:169] offset:17408
  v_cvt_pk_bf16_f32 v229, v218, v219
  v_exp_f32 v222, v222
  v_exp_f32 v223, v223
  v_cvt_pk_bf16_f32 v230, v220, v221

  v_cvt_pk_bf16_f32 v231, v222, v223
  s_nop 1
  v_mfma_f32_32x32x16_bf16 v[176:191], v[252:255], v[228:231], v[176:191]
  s_waitcnt vmcnt(0)
  v_mov_b32 v4, 0
  v_mov_b32 v5, 0
  v_mov_b32 v6, 0
  v_mov_b32 v7, 0
  v_pk_fma_f32 v[4:5], v[64:65], v[6:7], v[4:5]
  v_pk_fma_f32 v[4:5], v[66:67], v[6:7], v[4:5]
  v_pk_fma_f32 v[4:5], v[68:69], v[6:7], v[4:5]
  v_pk_fma_f32 v[4:5], v[70:71], v[6:7], v[4:5]
  v_pk_fma_f32 v[4:5], v[80:81], v[6:7], v[4:5]
  v_pk_fma_f32 v[4:5], v[82:83], v[6:7], v[4:5]
  v_pk_fma_f32 v[4:5], v[84:85], v[6:7], v[4:5]
  v_pk_fma_f32 v[4:5], v[86:87], v[6:7], v[4:5]
  v_pk_fma_f32 v[4:5], v[96:97], v[6:7], v[4:5]
  v_pk_fma_f32 v[4:5], v[98:99], v[6:7], v[4:5]
  v_pk_fma_f32 v[4:5], v[100:101], v[6:7], v[4:5]
  v_pk_fma_f32 v[4:5], v[102:103], v[6:7], v[4:5]
  v_pk_fma_f32 v[4:5], v[112:113], v[6:7], v[4:5]
  v_pk_fma_f32 v[4:5], v[114:115], v[6:7], v[4:5]
  v_pk_fma_f32 v[4:5], v[116:117], v[6:7], v[4:5]
  v_pk_fma_f32 v[4:5], v[118:119], v[6:7], v[4:5]
  v_pk_fma_f32 v[4:5], v[128:129], v[6:7], v[4:5]
  v_pk_fma_f32 v[4:5], v[130:131], v[6:7], v[4:5]
  v_pk_fma_f32 v[4:5], v[132:133], v[6:7], v[4:5]
  v_pk_fma_f32 v[4:5], v[134:135], v[6:7], v[4:5]
  v_pk_fma_f32 v[4:5], v[144:145], v[6:7], v[4:5]
  v_pk_fma_f32 v[4:5], v[146:147], v[6:7], v[4:5]
  v_pk_fma_f32 v[4:5], v[148:149], v[6:7], v[4:5]
  v_pk_fma_f32 v[4:5], v[150:151], v[6:7], v[4:5]
  v_pk_fma_f32 v[4:5], v[160:161], v[6:7], v[4:5]
  v_pk_fma_f32 v[4:5], v[162:163], v[6:7], v[4:5]
  v_pk_fma_f32 v[4:5], v[164:165], v[6:7], v[4:5]
  v_pk_fma_f32 v[4:5], v[166:167], v[6:7], v[4:5]
  v_min3_f32 v8, v72, v88, v104
  v_max3_f32 v9, v72, v88, v104
  v_min3_f32 v8, v8, v120, v136
  v_max3_f32 v9, v9, v120, v136
  s_mov_b32 s40, 0x1f800000
  s_mov_b32 s41, 0x5f800000
  v_pk_fma_f32 v[4:5], v[176:177], v[6:7], v[4:5]
  v_pk_fma_f32 v[4:5], v[178:179], v[6:7], v[4:5]
  v_pk_fma_f32 v[4:5], v[180:181], v[6:7], v[4:5]
  v_pk_fma_f32 v[4:5], v[182:183], v[6:7], v[4:5]
  v_min3_f32 v8, v8, v152, v168
  v_max3_f32 v9, v9, v152, v168
  v_min_f32 v8, v8, v184
  v_max_f32 v9, v9, v184
  v_add_f32 v4, v4, v5
  v_cmp_le_f32 s[42:43], s40, v8
  v_cmp_ge_f32 vcc, s41, v9
  s_and_b64 s[42:43], s[42:43], vcc
  v_cmp_eq_f32 vcc, v4, v4
  s_and_b64 s[42:43], s[42:43], vcc
  s_cmp_eq_u64 s[42:43], exec
  s_cbranch_scc0 gated_mix__mha_block__swiglu_ffn__prompt_kernel_fallback

  ds_write_b128 v16, v[176:179] offset:17920
  ds_write_b128 v16, v[180:183] offset:18944
  ds_write_b64 v17, v[184:185] offset:19968
  s_branch gated_mix__mha_block__swiglu_ffn__prompt_kernel_awritten
gated_mix__mha_block__swiglu_ffn__prompt_kernel_fallback:
  v_mov_b32 v240, 0xff800000
  v_mov_b32 v241, 0xff800000
  v_mov_b32 v242, 0xff800000
  v_mov_b32 v243, 0xff800000
  v_mov_b32 v244, 0xff800000
  v_mov_b32 v245, 0xff800000
  v_mov_b32 v246, 0xff800000
  v_mov_b32 v247, 0xff800000

  s_mov_b32 s38, 0
  s_mov_b32 s30, s32
gated_mix__mha_block__swiglu_ffn__prompt_kernel_fb1:
  buffer_load_dwordx4 v[16:19], v1, s[20:23], s30 offen sc1
  s_waitcnt vmcnt(0)
  v_mfma_f32_32x32x16_bf16 v[192:207], v[16:19], v[32:35], 0
  s_nop 7
  s_nop 7
  v_max3_f32 v240, v192, v193, v240
  v_max3_f32 v240, v194, v195, v240
  v_max3_f32 v240, v196, v197, v240
  v_max3_f32 v240, v198, v199, v240
  v_max3_f32 v240, v200, v201, v240
  v_max3_f32 v240, v202, v203, v240
  v_max3_f32 v240, v204, v205, v240
  v_max3_f32 v240, v206, v207, v240
  v_mfma_f32_32x32x16_bf16 v[192:207], v[16:19], v[36:39], 0
  s_nop 7
  s_nop 7
  v_max3_f32 v241, v192, v193, v241
  v_max3_f32 v241, v194, v195, v241
  v_max3_f32 v241, v196, v197, v241
  v_max3_f32 v241, v198, v199, v241
  v_max3_f32 v241, v200, v201, v241
  v_max3_f32 v241, v202, v203, v241
  v_max3_f32 v241, v204, v205, v241
  v_max3_f32 v241, v206, v207, v241
  v_mfma_f32_32x32x16_bf16 v[192:207], v[16:19], v[40:43], 0
  s_nop 7
  s_nop 7
  v_max3_f32 v242, v192, v193, v242
  v_max3_f32 v242, v194, v195, v242
  v_max3_f32 v242, v196, v197, v242
  v_max3_f32 v242, v198, v199, v242
  v_max3_f32 v242, v200, v201, v242
  v_max3_f32 v242, v202, v203, v242
  v_max3_f32 v242, v204, v205, v242
  v_max3_f32 v242, v206, v207, v242
  v_mfma_f32_32x32x16_bf16 v[192:207], v[16:19], v[44:47], 0
  s_nop 7
  s_nop 7
  v_max3_f32 v243, v192, v193, v243
  v_max3_f32 v243, v194, v195, v243
  v_max3_f32 v243, v196, v197, v243
  v_max3_f32 v243, v198, v199, v243
  v_max3_f32 v243, v200, v201, v243
  v_max3_f32 v243, v202, v203, v243
  v_max3_f32 v243, v204, v205, v243
  v_max3_f32 v243, v206, v207, v243
  v_mfma_f32_32x32x16_bf16 v[192:207], v[16:19], v[48:51], 0
  s_nop 7
  s_nop 7
  v_max3_f32 v244, v192, v193, v244
  v_max3_f32 v244, v194, v195, v244
  v_max3_f32 v244, v196, v197, v244
  v_max3_f32 v244, v198, v199, v244
  v_max3_f32 v244, v200, v201, v244
  v_max3_f32 v244, v202, v203, v244
  v_max3_f32 v244, v204, v205, v244
  v_max3_f32 v244, v206, v207, v244
  v_mfma_f32_32x32x16_bf16 v[192:207], v[16:19], v[52:55], 0
  s_nop 7
  s_nop 7
  v_max3_f32 v245, v192, v193, v245
  v_max3_f32 v245, v194, v195, v245
  v_max3_f32 v245, v196, v197, v245
  v_max3_f32 v245, v198, v199, v245
  v_max3_f32 v245, v200, v201, v245
  v_max3_f32 v245, v202, v203, v245
  v_max3_f32 v245, v204, v205, v245
  v_max3_f32 v245, v206, v207, v245
  v_mfma_f32_32x32x16_bf16 v[192:207], v[16:19], v[56:59], 0
  s_nop 7
  s_nop 7
  v_max3_f32 v246, v192, v193, v246
  v_max3_f32 v246, v194, v195, v246
  v_max3_f32 v246, v196, v197, v246
  v_max3_f32 v246, v198, v199, v246
  v_max3_f32 v246, v200, v201, v246
  v_max3_f32 v246, v202, v203, v246
  v_max3_f32 v246, v204, v205, v246
  v_max3_f32 v246, v206, v207, v246
  v_mfma_f32_32x32x16_bf16 v[192:207], v[16:19], v[60:63], 0
  s_nop 7
  s_nop 7
  v_max3_f32 v247, v192, v193, v247
  v_max3_f32 v247, v194, v195, v247
  v_max3_f32 v247, v196, v197, v247
  v_max3_f32 v247, v198, v199, v247
  v_max3_f32 v247, v200, v201, v247
  v_max3_f32 v247, v202, v203, v247
  v_max3_f32 v247, v204, v205, v247
  v_max3_f32 v247, v206, v207, v247

  s_add_u32 s30, s30, 1024
  s_add_u32 s38, s38, 1
  s_cmp_lt_u32 s38, 16
  s_cbranch_scc1 gated_mix__mha_block__swiglu_ffn__prompt_kernel_fb1
  v_mov_b32 v4, v240
  s_nop 1
  v_permlane32_swap_b32 v4, v240
  s_nop 1
  v_max_f32 v240, v4, v240
  v_mov_b32 v4, v241
  s_nop 1
  v_permlane32_swap_b32 v4, v241
  s_nop 1
  v_max_f32 v241, v4, v241
  v_mov_b32 v4, v242
  s_nop 1
  v_permlane32_swap_b32 v4, v242
  s_nop 1
  v_max_f32 v242, v4, v242
  v_mov_b32 v4, v243
  s_nop 1
  v_permlane32_swap_b32 v4, v243
  s_nop 1
  v_max_f32 v243, v4, v243
  v_mov_b32 v4, v244
  s_nop 1
  v_permlane32_swap_b32 v4, v244
  s_nop 1
  v_max_f32 v244, v4, v244
  v_mov_b32 v4, v245
  s_nop 1
  v_permlane32_swap_b32 v4, v245
  s_nop 1
  v_max_f32 v245, v4, v245
  v_mov_b32 v4, v246
  s_nop 1
  v_permlane32_swap_b32 v4, v246
  s_nop 1
  v_max_f32 v246, v4, v246
  v_mov_b32 v4, v247
  s_nop 1
  v_permlane32_swap_b32 v4, v247
  s_nop 1
  v_max_f32 v247, v4, v247
  v_mov_b32 v64, 0
  v_mov_b32 v65, 0
  v_mov_b32 v66, 0
  v_mov_b32 v67, 0
  v_mov_b32 v68, 0
  v_mov_b32 v69, 0
  v_mov_b32 v70, 0
  v_mov_b32 v71, 0
  v_mov_b32 v72, 0
  v_mov_b32 v73, 0
  v_mov_b32 v74, 0
  v_mov_b32 v75, 0
  v_mov_b32 v76, 0
  v_mov_b32 v77, 0
  v_mov_b32 v78, 0
  v_mov_b32 v79, 0
  v_mov_b32 v80, 0
  v_mov_b32 v81, 0
  v_mov_b32 v82, 0
  v_mov_b32 v83, 0
  v_mov_b32 v84, 0
  v_mov_b32 v85, 0
  v_mov_b32 v86, 0
  v_mov_b32 v87, 0
  v_mov_b32 v88, 0
  v_mov_b32 v89, 0
  v_mov_b32 v90, 0
  v_mov_b32 v91, 0
  v_mov_b32 v92, 0
  v_mov_b32 v93, 0
  v_mov_b32 v94, 0
  v_mov_b32 v95, 0
  v_mov_b32 v96, 0
  v_mov_b32 v97, 0
  v_mov_b32 v98, 0
  v_mov_b32 v99, 0
  v_mov_b32 v100, 0
  v_mov_b32 v101, 0
  v_mov_b32 v102, 0
  v_mov_b32 v103, 0
  v_mov_b32 v104, 0
  v_mov_b32 v105, 0
  v_mov_b32 v106, 0
  v_mov_b32 v107, 0
  v_mov_b32 v108, 0
  v_mov_b32 v109, 0
  v_mov_b32 v110, 0
  v_mov_b32 v111, 0
  v_mov_b32 v112, 0
  v_mov_b32 v113, 0
  v_mov_b32 v114, 0
  v_mov_b32 v115, 0
  v_mov_b32 v116, 0
  v_mov_b32 v117, 0
  v_mov_b32 v118, 0
  v_mov_b32 v119, 0
  v_mov_b32 v120, 0
  v_mov_b32 v121, 0
  v_mov_b32 v122, 0
  v_mov_b32 v123, 0
  v_mov_b32 v124, 0
  v_mov_b32 v125, 0
  v_mov_b32 v126, 0
  v_mov_b32 v127, 0
  v_mov_b32 v128, 0
  v_mov_b32 v129, 0
  v_mov_b32 v130, 0
  v_mov_b32 v131, 0
  v_mov_b32 v132, 0
  v_mov_b32 v133, 0
  v_mov_b32 v134, 0
  v_mov_b32 v135, 0
  v_mov_b32 v136, 0
  v_mov_b32 v137, 0
  v_mov_b32 v138, 0
  v_mov_b32 v139, 0
  v_mov_b32 v140, 0
  v_mov_b32 v141, 0
  v_mov_b32 v142, 0
  v_mov_b32 v143, 0
  v_mov_b32 v144, 0
  v_mov_b32 v145, 0
  v_mov_b32 v146, 0
  v_mov_b32 v147, 0
  v_mov_b32 v148, 0
  v_mov_b32 v149, 0
  v_mov_b32 v150, 0
  v_mov_b32 v151, 0
  v_mov_b32 v152, 0
  v_mov_b32 v153, 0
  v_mov_b32 v154, 0
  v_mov_b32 v155, 0
  v_mov_b32 v156, 0
  v_mov_b32 v157, 0
  v_mov_b32 v158, 0
  v_mov_b32 v159, 0
  v_mov_b32 v160, 0
  v_mov_b32 v161, 0
  v_mov_b32 v162, 0
  v_mov_b32 v163, 0
  v_mov_b32 v164, 0
  v_mov_b32 v165, 0
  v_mov_b32 v166, 0
  v_mov_b32 v167, 0
  v_mov_b32 v168, 0
  v_mov_b32 v169, 0
  v_mov_b32 v170, 0
  v_mov_b32 v171, 0
  v_mov_b32 v172, 0
  v_mov_b32 v173, 0
  v_mov_b32 v174, 0
  v_mov_b32 v175, 0
  v_mov_b32 v176, 0
  v_mov_b32 v177, 0
  v_mov_b32 v178, 0
  v_mov_b32 v179, 0
  v_mov_b32 v180, 0
  v_mov_b32 v181, 0
  v_mov_b32 v182, 0
  v_mov_b32 v183, 0
  v_mov_b32 v184, 0
  v_mov_b32 v185, 0
  v_mov_b32 v186, 0
  v_mov_b32 v187, 0
  v_mov_b32 v188, 0
  v_mov_b32 v189, 0
  v_mov_b32 v190, 0
  v_mov_b32 v191, 0

  s_mov_b32 s38, 0
  s_mov_b32 s30, s32
  s_mov_b32 s31, s35
gated_mix__mha_block__swiglu_ffn__prompt_kernel_fb2:
  buffer_load_dwordx4 v[16:19], v1, s[20:23], s30 offen sc1
  s_mov_b64 exec, s[36:37]
  buffer_load_dwordx4 v[24:27], v2, s[20:23], s31 offen sc1
  buffer_load_dwordx4 v[28:31], v2, s[20:23], s31 offen offset:512 sc1
  s_mov_b64 exec, -1
  s_waitcnt vmcnt(0)
  v_mfma_f32_32x32x16_bf16 v[192:207], v[16:19], v[32:35], 0
  s_nop 7
  s_nop 7
  v_sub_f32 v192, v192, v240
  v_sub_f32 v193, v193, v240
  v_sub_f32 v194, v194, v240
  v_sub_f32 v195, v195, v240
  v_sub_f32 v196, v196, v240
  v_sub_f32 v197, v197, v240
  v_sub_f32 v198, v198, v240
  v_sub_f32 v199, v199, v240
  v_sub_f32 v200, v200, v240
  v_sub_f32 v201, v201, v240
  v_sub_f32 v202, v202, v240
  v_sub_f32 v203, v203, v240
  v_sub_f32 v204, v204, v240
  v_sub_f32 v205, v205, v240
  v_sub_f32 v206, v206, v240
  v_sub_f32 v207, v207, v240
  v_exp_f32 v192, v192
  v_exp_f32 v193, v193
  v_exp_f32 v194, v194
  v_exp_f32 v195, v195
  v_exp_f32 v196, v196
  v_exp_f32 v197, v197
  v_exp_f32 v198, v198
  v_exp_f32 v199, v199
  v_exp_f32 v200, v200
  v_exp_f32 v201, v201
  v_exp_f32 v202, v202
  v_exp_f32 v203, v203
  v_exp_f32 v204, v204
  v_exp_f32 v205, v205
  v_exp_f32 v206, v206
  v_exp_f32 v207, v207
  s_nop 0
  v_cvt_pk_bf16_f32 v224, v192, v193
  v_cvt_pk_bf16_f32 v225, v194, v195
  v_cvt_pk_bf16_f32 v226, v196, v197
  v_cvt_pk_bf16_f32 v227, v198, v199
  v_cvt_pk_bf16_f32 v228, v200, v201
  v_cvt_pk_bf16_f32 v229, v202, v203
  v_cvt_pk_bf16_f32 v230, v204, v205
  v_cvt_pk_bf16_f32 v231, v206, v207
  s_nop 1
  v_mfma_f32_32x32x16_bf16 v[64:79], v[24:27], v[224:227], v[64:79]
  v_mfma_f32_32x32x16_bf16 v[64:79], v[28:31], v[228:231], v[64:79]
  v_mfma_f32_32x32x16_bf16 v[192:207], v[16:19], v[36:39], 0
  s_nop 7
  s_nop 7
  v_sub_f32 v192, v192, v241
  v_sub_f32 v193, v193, v241
  v_sub_f32 v194, v194, v241
  v_sub_f32 v195, v195, v241
  v_sub_f32 v196, v196, v241
  v_sub_f32 v197, v197, v241
  v_sub_f32 v198, v198, v241
  v_sub_f32 v199, v199, v241
  v_sub_f32 v200, v200, v241
  v_sub_f32 v201, v201, v241
  v_sub_f32 v202, v202, v241
  v_sub_f32 v203, v203, v241
  v_sub_f32 v204, v204, v241
  v_sub_f32 v205, v205, v241
  v_sub_f32 v206, v206, v241
  v_sub_f32 v207, v207, v241
  v_exp_f32 v192, v192
  v_exp_f32 v193, v193
  v_exp_f32 v194, v194
  v_exp_f32 v195, v195
  v_exp_f32 v196, v196
  v_exp_f32 v197, v197
  v_exp_f32 v198, v198
  v_exp_f32 v199, v199
  v_exp_f32 v200, v200
  v_exp_f32 v201, v201
  v_exp_f32 v202, v202
  v_exp_f32 v203, v203
  v_exp_f32 v204, v204
  v_exp_f32 v205, v205
  v_exp_f32 v206, v206
  v_exp_f32 v207, v207
  s_nop 0
  v_cvt_pk_bf16_f32 v224, v192, v193
  v_cvt_pk_bf16_f32 v225, v194, v195
  v_cvt_pk_bf16_f32 v226, v196, v197
  v_cvt_pk_bf16_f32 v227, v198, v199
  v_cvt_pk_bf16_f32 v228, v200, v201
  v_cvt_pk_bf16_f32 v229, v202, v203
  v_cvt_pk_bf16_f32 v230, v204, v205
  v_cvt_pk_bf16_f32 v231, v206, v207
  s_nop 1
  v_mfma_f32_32x32x16_bf16 v[80:95], v[24:27], v[224:227], v[80:95]
  v_mfma_f32_32x32x16_bf16 v[80:95], v[28:31], v[228:231], v[80:95]
  v_mfma_f32_32x32x16_bf16 v[192:207], v[16:19], v[40:43], 0
  s_nop 7
  s_nop 7
  v_sub_f32 v192, v192, v242
  v_sub_f32 v193, v193, v242
  v_sub_f32 v194, v194, v242
  v_sub_f32 v195, v195, v242
  v_sub_f32 v196, v196, v242
  v_sub_f32 v197, v197, v242
  v_sub_f32 v198, v198, v242
  v_sub_f32 v199, v199, v242
  v_sub_f32 v200, v200, v242
  v_sub_f32 v201, v201, v242
  v_sub_f32 v202, v202, v242
  v_sub_f32 v203, v203, v242
  v_sub_f32 v204, v204, v242
  v_sub_f32 v205, v205, v242
  v_sub_f32 v206, v206, v242
  v_sub_f32 v207, v207, v242
  v_exp_f32 v192, v192
  v_exp_f32 v193, v193
  v_exp_f32 v194, v194
  v_exp_f32 v195, v195
  v_exp_f32 v196, v196
  v_exp_f32 v197, v197
  v_exp_f32 v198, v198
  v_exp_f32 v199, v199
  v_exp_f32 v200, v200
  v_exp_f32 v201, v201
  v_exp_f32 v202, v202
  v_exp_f32 v203, v203
  v_exp_f32 v204, v204
  v_exp_f32 v205, v205
  v_exp_f32 v206, v206
  v_exp_f32 v207, v207
  s_nop 0
  v_cvt_pk_bf16_f32 v224, v192, v193
  v_cvt_pk_bf16_f32 v225, v194, v195
  v_cvt_pk_bf16_f32 v226, v196, v197
  v_cvt_pk_bf16_f32 v227, v198, v199
  v_cvt_pk_bf16_f32 v228, v200, v201
  v_cvt_pk_bf16_f32 v229, v202, v203
  v_cvt_pk_bf16_f32 v230, v204, v205
  v_cvt_pk_bf16_f32 v231, v206, v207
  s_nop 1
  v_mfma_f32_32x32x16_bf16 v[96:111], v[24:27], v[224:227], v[96:111]
  v_mfma_f32_32x32x16_bf16 v[96:111], v[28:31], v[228:231], v[96:111]
  v_mfma_f32_32x32x16_bf16 v[192:207], v[16:19], v[44:47], 0
  s_nop 7
  s_nop 7
  v_sub_f32 v192, v192, v243
  v_sub_f32 v193, v193, v243
  v_sub_f32 v194, v194, v243
  v_sub_f32 v195, v195, v243
  v_sub_f32 v196, v196, v243
  v_sub_f32 v197, v197, v243
  v_sub_f32 v198, v198, v243
  v_sub_f32 v199, v199, v243
  v_sub_f32 v200, v200, v243
  v_sub_f32 v201, v201, v243
  v_sub_f32 v202, v202, v243
  v_sub_f32 v203, v203, v243
  v_sub_f32 v204, v204, v243
  v_sub_f32 v205, v205, v243
  v_sub_f32 v206, v206, v243
  v_sub_f32 v207, v207, v243
  v_exp_f32 v192, v192
  v_exp_f32 v193, v193
  v_exp_f32 v194, v194
  v_exp_f32 v195, v195
  v_exp_f32 v196, v196
  v_exp_f32 v197, v197
  v_exp_f32 v198, v198
  v_exp_f32 v199, v199
  v_exp_f32 v200, v200
  v_exp_f32 v201, v201
  v_exp_f32 v202, v202
  v_exp_f32 v203, v203
  v_exp_f32 v204, v204
  v_exp_f32 v205, v205
  v_exp_f32 v206, v206
  v_exp_f32 v207, v207
  s_nop 0
  v_cvt_pk_bf16_f32 v224, v192, v193
  v_cvt_pk_bf16_f32 v225, v194, v195
  v_cvt_pk_bf16_f32 v226, v196, v197
  v_cvt_pk_bf16_f32 v227, v198, v199
  v_cvt_pk_bf16_f32 v228, v200, v201
  v_cvt_pk_bf16_f32 v229, v202, v203
  v_cvt_pk_bf16_f32 v230, v204, v205
  v_cvt_pk_bf16_f32 v231, v206, v207
  s_nop 1
  v_mfma_f32_32x32x16_bf16 v[112:127], v[24:27], v[224:227], v[112:127]
  v_mfma_f32_32x32x16_bf16 v[112:127], v[28:31], v[228:231], v[112:127]
  v_mfma_f32_32x32x16_bf16 v[192:207], v[16:19], v[48:51], 0
  s_nop 7
  s_nop 7
  v_sub_f32 v192, v192, v244
  v_sub_f32 v193, v193, v244
  v_sub_f32 v194, v194, v244
  v_sub_f32 v195, v195, v244
  v_sub_f32 v196, v196, v244
  v_sub_f32 v197, v197, v244
  v_sub_f32 v198, v198, v244
  v_sub_f32 v199, v199, v244
  v_sub_f32 v200, v200, v244
  v_sub_f32 v201, v201, v244
  v_sub_f32 v202, v202, v244
  v_sub_f32 v203, v203, v244
  v_sub_f32 v204, v204, v244
  v_sub_f32 v205, v205, v244
  v_sub_f32 v206, v206, v244
  v_sub_f32 v207, v207, v244
  v_exp_f32 v192, v192
  v_exp_f32 v193, v193
  v_exp_f32 v194, v194
  v_exp_f32 v195, v195
  v_exp_f32 v196, v196
  v_exp_f32 v197, v197
  v_exp_f32 v198, v198
  v_exp_f32 v199, v199
  v_exp_f32 v200, v200
  v_exp_f32 v201, v201
  v_exp_f32 v202, v202
  v_exp_f32 v203, v203
  v_exp_f32 v204, v204
  v_exp_f32 v205, v205
  v_exp_f32 v206, v206
  v_exp_f32 v207, v207
  s_nop 0
  v_cvt_pk_bf16_f32 v224, v192, v193
  v_cvt_pk_bf16_f32 v225, v194, v195
  v_cvt_pk_bf16_f32 v226, v196, v197
  v_cvt_pk_bf16_f32 v227, v198, v199
  v_cvt_pk_bf16_f32 v228, v200, v201
  v_cvt_pk_bf16_f32 v229, v202, v203
  v_cvt_pk_bf16_f32 v230, v204, v205
  v_cvt_pk_bf16_f32 v231, v206, v207
  s_nop 1
  v_mfma_f32_32x32x16_bf16 v[128:143], v[24:27], v[224:227], v[128:143]
  v_mfma_f32_32x32x16_bf16 v[128:143], v[28:31], v[228:231], v[128:143]
  v_mfma_f32_32x32x16_bf16 v[192:207], v[16:19], v[52:55], 0
  s_nop 7
  s_nop 7
  v_sub_f32 v192, v192, v245
  v_sub_f32 v193, v193, v245
  v_sub_f32 v194, v194, v245
  v_sub_f32 v195, v195, v245
  v_sub_f32 v196, v196, v245
  v_sub_f32 v197, v197, v245
  v_sub_f32 v198, v198, v245
  v_sub_f32 v199, v199, v245
  v_sub_f32 v200, v200, v245
  v_sub_f32 v201, v201, v245
  v_sub_f32 v202, v202, v245
  v_sub_f32 v203, v203, v245
  v_sub_f32 v204, v204, v245
  v_sub_f32 v205, v205, v245
  v_sub_f32 v206, v206, v245
  v_sub_f32 v207, v207, v245
  v_exp_f32 v192, v192
  v_exp_f32 v193, v193
  v_exp_f32 v194, v194
  v_exp_f32 v195, v195
  v_exp_f32 v196, v196
  v_exp_f32 v197, v197
  v_exp_f32 v198, v198
  v_exp_f32 v199, v199
  v_exp_f32 v200, v200
  v_exp_f32 v201, v201
  v_exp_f32 v202, v202
  v_exp_f32 v203, v203
  v_exp_f32 v204, v204
  v_exp_f32 v205, v205
  v_exp_f32 v206, v206
  v_exp_f32 v207, v207
  s_nop 0
  v_cvt_pk_bf16_f32 v224, v192, v193
  v_cvt_pk_bf16_f32 v225, v194, v195
  v_cvt_pk_bf16_f32 v226, v196, v197
  v_cvt_pk_bf16_f32 v227, v198, v199
  v_cvt_pk_bf16_f32 v228, v200, v201
  v_cvt_pk_bf16_f32 v229, v202, v203
  v_cvt_pk_bf16_f32 v230, v204, v205
  v_cvt_pk_bf16_f32 v231, v206, v207
  s_nop 1
  v_mfma_f32_32x32x16_bf16 v[144:159], v[24:27], v[224:227], v[144:159]
  v_mfma_f32_32x32x16_bf16 v[144:159], v[28:31], v[228:231], v[144:159]
  v_mfma_f32_32x32x16_bf16 v[192:207], v[16:19], v[56:59], 0
  s_nop 7
  s_nop 7
  v_sub_f32 v192, v192, v246
  v_sub_f32 v193, v193, v246
  v_sub_f32 v194, v194, v246
  v_sub_f32 v195, v195, v246
  v_sub_f32 v196, v196, v246
  v_sub_f32 v197, v197, v246
  v_sub_f32 v198, v198, v246
  v_sub_f32 v199, v199, v246
  v_sub_f32 v200, v200, v246
  v_sub_f32 v201, v201, v246
  v_sub_f32 v202, v202, v246
  v_sub_f32 v203, v203, v246
  v_sub_f32 v204, v204, v246
  v_sub_f32 v205, v205, v246
  v_sub_f32 v206, v206, v246
  v_sub_f32 v207, v207, v246
  v_exp_f32 v192, v192
  v_exp_f32 v193, v193
  v_exp_f32 v194, v194
  v_exp_f32 v195, v195
  v_exp_f32 v196, v196
  v_exp_f32 v197, v197
  v_exp_f32 v198, v198
  v_exp_f32 v199, v199
  v_exp_f32 v200, v200
  v_exp_f32 v201, v201
  v_exp_f32 v202, v202
  v_exp_f32 v203, v203
  v_exp_f32 v204, v204
  v_exp_f32 v205, v205
  v_exp_f32 v206, v206
  v_exp_f32 v207, v207
  s_nop 0
  v_cvt_pk_bf16_f32 v224, v192, v193
  v_cvt_pk_bf16_f32 v225, v194, v195
  v_cvt_pk_bf16_f32 v226, v196, v197
  v_cvt_pk_bf16_f32 v227, v198, v199
  v_cvt_pk_bf16_f32 v228, v200, v201
  v_cvt_pk_bf16_f32 v229, v202, v203
  v_cvt_pk_bf16_f32 v230, v204, v205
  v_cvt_pk_bf16_f32 v231, v206, v207
  s_nop 1
  v_mfma_f32_32x32x16_bf16 v[160:175], v[24:27], v[224:227], v[160:175]
  v_mfma_f32_32x32x16_bf16 v[160:175], v[28:31], v[228:231], v[160:175]
  v_mfma_f32_32x32x16_bf16 v[192:207], v[16:19], v[60:63], 0
  s_nop 7
  s_nop 7
  v_sub_f32 v192, v192, v247
  v_sub_f32 v193, v193, v247
  v_sub_f32 v194, v194, v247
  v_sub_f32 v195, v195, v247
  v_sub_f32 v196, v196, v247
  v_sub_f32 v197, v197, v247
  v_sub_f32 v198, v198, v247
  v_sub_f32 v199, v199, v247
  v_sub_f32 v200, v200, v247
  v_sub_f32 v201, v201, v247
  v_sub_f32 v202, v202, v247
  v_sub_f32 v203, v203, v247
  v_sub_f32 v204, v204, v247
  v_sub_f32 v205, v205, v247
  v_sub_f32 v206, v206, v247
  v_sub_f32 v207, v207, v247
  v_exp_f32 v192, v192
  v_exp_f32 v193, v193
  v_exp_f32 v194, v194
  v_exp_f32 v195, v195
  v_exp_f32 v196, v196
  v_exp_f32 v197, v197
  v_exp_f32 v198, v198
  v_exp_f32 v199, v199
  v_exp_f32 v200, v200
  v_exp_f32 v201, v201
  v_exp_f32 v202, v202
  v_exp_f32 v203, v203
  v_exp_f32 v204, v204
  v_exp_f32 v205, v205
  v_exp_f32 v206, v206
  v_exp_f32 v207, v207
  s_nop 0
  v_cvt_pk_bf16_f32 v224, v192, v193
  v_cvt_pk_bf16_f32 v225, v194, v195
  v_cvt_pk_bf16_f32 v226, v196, v197
  v_cvt_pk_bf16_f32 v227, v198, v199
  v_cvt_pk_bf16_f32 v228, v200, v201
  v_cvt_pk_bf16_f32 v229, v202, v203
  v_cvt_pk_bf16_f32 v230, v204, v205
  v_cvt_pk_bf16_f32 v231, v206, v207
  s_nop 1
  v_mfma_f32_32x32x16_bf16 v[176:191], v[24:27], v[224:227], v[176:191]
  v_mfma_f32_32x32x16_bf16 v[176:191], v[28:31], v[228:231], v[176:191]

  s_add_u32 s30, s30, 1024
  s_add_u32 s31, s31, 1024
  s_add_u32 s38, s38, 1
  s_cmp_lt_u32 s38, 16
  s_cbranch_scc1 gated_mix__mha_block__swiglu_ffn__prompt_kernel_fb2
  s_nop 7
  s_nop 7
  v_mov_b32 v73, v240
  v_mov_b32 v89, v241
  v_mov_b32 v105, v242
  v_mov_b32 v121, v243
  v_mov_b32 v137, v244
  v_mov_b32 v153, v245
  v_mov_b32 v169, v246
  v_mov_b32 v185, v247

gated_mix__mha_block__swiglu_ffn__prompt_kernel_adone:

  s_mul_i32 s40, s24, 20480
  s_add_u32 s40, s40, 65536
  v_add_u32 v4, s40, v1
  v_lshlrev_b32 v5, 3, v0
  v_add_u32 v5, s40, v5
  ds_write_b128 v4, v[64:67] offset:0
  ds_write_b128 v4, v[68:71] offset:1024
  ds_write_b64 v5, v[72:73] offset:2048
  ds_write_b128 v4, v[80:83] offset:2560
  ds_write_b128 v4, v[84:87] offset:3584
  ds_write_b64 v5, v[88:89] offset:4608
  ds_write_b128 v4, v[96:99] offset:5120
  ds_write_b128 v4, v[100:103] offset:6144
  ds_write_b64 v5, v[104:105] offset:7168
  ds_write_b128 v4, v[112:115] offset:7680
  ds_write_b128 v4, v[116:119] offset:8704
  ds_write_b64 v5, v[120:121] offset:9728
  ds_write_b128 v4, v[128:131] offset:10240
  ds_write_b128 v4, v[132:135] offset:11264
  ds_write_b64 v5, v[136:137] offset:12288
  ds_write_b128 v4, v[144:147] offset:12800
  ds_write_b128 v4, v[148:151] offset:13824
  ds_write_b64 v5, v[152:153] offset:14848
  ds_write_b128 v4, v[160:163] offset:15360
  ds_write_b128 v4, v[164:167] offset:16384
  ds_write_b64 v5, v[168:169] offset:17408
  ds_write_b128 v4, v[176:179] offset:17920
  ds_write_b128 v4, v[180:183] offset:18944
  ds_write_b64 v5, v[184:185] offset:19968
gated_mix__mha_block__swiglu_ffn__prompt_kernel_awritten:
  s_waitcnt lgkmcnt(0)
  s_barrier

  s_mul_i32 s40, s24, 2560
  s_add_u32 s40, s40, 65536
  v_add_u32 v16, s40, v1
  v_lshrrev_b32 v17, 1, v1
  v_add_u32 v17, s40, v17
  v_add_u32 v18, 40960, v16
  v_add_u32 v19, 40960, v17
  ds_read_b64 v[72:73], v17 offset:2048
  ds_read_b64 v[82:83], v17 offset:22528
  ds_read_b64 v[92:93], v19 offset:2048
  ds_read_b64 v[102:103], v19 offset:22528
  ds_read_b128 v[64:67], v16 offset:0
  ds_read_b128 v[68:71], v16 offset:1024
  ds_read_b128 v[74:77], v16 offset:20480
  ds_read_b128 v[78:81], v16 offset:21504
  ds_read_b128 v[84:87], v18 offset:0
  ds_read_b128 v[88:91], v18 offset:1024
  ds_read_b128 v[94:97], v18 offset:20480
  ds_read_b128 v[98:101], v18 offset:21504

  s_lshl_b32 s41, s29, 3
  s_add_u32 s41, s41, s24
  s_lshl_b32 s41, s41, 5
  s_add_u32 s41, s41, s28
  s_lshl_b32 s41, s41, 10
  s_add_u32 s41, s41, 0x700000
  s_waitcnt lgkmcnt(8)
  v_max3_f32 v16, v73, v83, v93
  v_max_f32 v16, v16, v103
  v_sub_f32 v17, v73, v16
  v_sub_f32 v18, v83, v16
  v_sub_f32 v19, v93, v16
  v_sub_f32 v20, v103, v16
  v_exp_f32 v17, v17
  v_exp_f32 v18, v18
  v_exp_f32 v19, v19
  v_exp_f32 v20, v20
  s_nop 0
  v_mul_f32 v21, v17, v72
  v_fmac_f32 v21, v18, v82
  v_fmac_f32 v21, v19, v92
  v_fmac_f32 v21, v20, v102
  v_rcp_f32 v21, v21
  s_nop 0
  v_mul_f32 v17, v21, v17
  v_mul_f32 v18, v21, v18
  v_mul_f32 v19, v21, v19
  v_mul_f32 v20, v21, v20
  s_waitcnt lgkmcnt(0)
  v_mul_f32 v22, v17, v64
  v_fmac_f32 v22, v18, v74
  v_fmac_f32 v22, v19, v84
  v_fmac_f32 v22, v20, v94
  v_mul_f32 v23, v17, v65
  v_fmac_f32 v23, v18, v75
  v_fmac_f32 v23, v19, v85
  v_fmac_f32 v23, v20, v95
  v_mul_f32 v24, v17, v66
  v_fmac_f32 v24, v18, v76
  v_fmac_f32 v24, v19, v86
  v_fmac_f32 v24, v20, v96
  v_mul_f32 v25, v17, v67
  v_fmac_f32 v25, v18, v77
  v_fmac_f32 v25, v19, v87
  v_fmac_f32 v25, v20, v97
  v_mul_f32 v26, v17, v68
  v_fmac_f32 v26, v18, v78
  v_fmac_f32 v26, v19, v88
  v_fmac_f32 v26, v20, v98
  v_mul_f32 v27, v17, v69
  v_fmac_f32 v27, v18, v79
  v_fmac_f32 v27, v19, v89
  v_fmac_f32 v27, v20, v99
  v_mul_f32 v28, v17, v70
  v_fmac_f32 v28, v18, v80
  v_fmac_f32 v28, v19, v90
  v_fmac_f32 v28, v20, v100
  v_mul_f32 v29, v17, v71
  v_fmac_f32 v29, v18, v81
  v_fmac_f32 v29, v19, v91
  v_fmac_f32 v29, v20, v101
  v_cvt_pk_bf16_f32 v64, v22, v23
  v_cvt_pk_bf16_f32 v65, v24, v25
  v_cvt_pk_bf16_f32 v66, v26, v27
  v_cvt_pk_bf16_f32 v67, v28, v29
  buffer_store_dwordx4 v[64:67], v1, s[20:23], s41 offen sc1
  s_waitcnt vmcnt(0)
  s_barrier
  s_endpgm
gated_mix__mha_block__swiglu_ffn__prompt_kernel_end:
  s_endpgm
.section .rodata,"a"
.p2align 6
.amdhsa_kernel gated_mix__mha_block__swiglu_ffn__prompt_kernel
  .amdhsa_next_free_vgpr 256
  .amdhsa_next_free_sgpr 96
  .amdhsa_accum_offset 256
  .amdhsa_group_segment_fixed_size 0
  .amdhsa_kernarg_size 88
  .amdhsa_user_sgpr_count 2
  .amdhsa_user_sgpr_kernarg_segment_ptr 1
  .amdhsa_system_sgpr_workgroup_id_x 1
  .amdhsa_float_denorm_mode_32 3
.end_amdhsa_kernel
```
